```python
import torch

def _softmax(x, axis=-1):
    return torch.softmax(x, dim=axis)
def _gelu(x):
    return torch.nn.functional.gelu(x, approximate="tanh")
def _silu(x):
    return torch.nn.functional.silu(x)
def _sigmoid(x):
    return torch.sigmoid(x)
def _layernorm(x, axis=-1, eps=1e-5):
    m = x.mean(dim=axis, keepdim=True)
    v = x.var(dim=axis, keepdim=True, unbiased=False)
    return (x - m) / torch.sqrt(v + eps)
def _scatter_add(tgt, idx, src, axis=0):
    return tgt.clone().index_add_(axis, idx, src)
def _segment_sum(src, seg, n):
    out = torch.zeros((n,) + src.shape[1:], dtype=src.dtype)
    return out.index_add_(0, seg, src)
def _pad(x, pw):
    flat = tuple(v for pair in reversed(pw) for v in pair)
    return torch.nn.functional.pad(x, flat)

kernel_name = 'recurrent_scan__linear_kernel_hedgehog__dense_activation_silu__prompt'

def setup_inputs():

    _w = (lambda a: (lambda t: t.to(torch.bfloat16) if t.is_floating_point() else t)(torch.as_tensor(a)))
    def _A_setup():
        B, S, D, H = 1, 2048, 448, 16
        Dh = D // H
        return {
            "x": _w((lambda *s: torch.randn(*s, dtype=torch.bfloat16) * 0.05)(B, S, D)),
            "wqkv": _w((lambda *s: torch.randn(*s, dtype=torch.bfloat16) * 0.4)(D, 3 * D)),
            "w_phi": _w((lambda *s: torch.randn(*s, dtype=torch.bfloat16) * 0.4)(H, Dh, Dh) * (Dh ** -0.5)),
            "wo": _w((lambda *s: torch.randn(*s, dtype=torch.bfloat16) * 0.2)(D, D)),
        }
    _A_in = _A_setup()

    def _B_setup():
        B, S, D, F = 1, 2048, 448, 1792
        return {
            "x": _w((lambda *s: torch.randn(*s, dtype=torch.bfloat16) * 0.05)(B, S, D)),
            "w1": _w((lambda *s: torch.randn(*s, dtype=torch.bfloat16) * 0.4)(D, F) * (D ** -0.5)),
            "w2": _w((lambda *s: torch.randn(*s, dtype=torch.bfloat16) * 0.1)(F, D) * (F ** -0.5)),
        }
    _B_in = _B_setup()

    return {
        "A_x": _A_in["x"],
        "A_wqkv": _A_in["wqkv"],
        "A_w_phi": _A_in["w_phi"],
        "A_wo": _A_in["wo"],
        "B_x": _B_in["x"],
        "B_w1": _B_in["w1"],
        "B_w2": _B_in["w2"],
    }

def reference(A_x, A_wqkv, A_w_phi, A_wo, B_x, B_w1, B_w2):
    def _A_ref(x, wqkv, w_phi, wo):
        B, S, D = x.shape
        H = 16; Dh = D // H
        qkv = (lambda x, *d: x.permute(*d))((x @ wqkv).reshape(B, S, 3, H, Dh), 2, 0, 3, 1, 4)
        q, k, v = qkv[0], qkv[1], qkv[2]
        pq = torch.einsum("bhsd,hdf->bhsf", q, w_phi)
        pk = torch.einsum("bhsd,hdf->bhsf", k, w_phi)
        phi_q = torch.concatenate([_softmax(pq, axis=-1), _softmax(-pq, axis=-1)], axis=-1)
        phi_k = torch.concatenate([_softmax(pk, axis=-1), _softmax(-pk, axis=-1)], axis=-1)
        kv = torch.einsum("bhsf,bhsd->bhfd", phi_k, v)
        z  = torch.einsum("bhsf->bhf", phi_k)
        num = torch.einsum("bhqf,bhfd->bhqd", phi_q, kv)
        den = torch.einsum("bhqf,bhf->bhq", phi_q, z)[..., None] + 1e-6
        o = num / den
        return (lambda x, *d: x.permute(*d))(o, 0, 2, 1, 3).reshape(B, S, D) @ wo

    def _B_ref(x, w1, w2):
        h = torch.einsum("bsd,df->bsf", x, w1)
        h = _silu(h)
        out = torch.einsum("bsf,fd->bsd", h, w2)
        return out

    x = A_x
    xn = _layernorm(x, axis=-1)
    s = _A_ref(xn, A_wqkv, A_w_phi, A_wo)
    g = _silu(_B_ref(xn, B_w1, B_w2))
    return x + s * g
```

```asm
; @launch grid=(256,1,1) block=(512,1,1) lds=163840
.amdgcn_target "amdgcn-amd-amdhsa--gfx950"
.text
.globl recurrent_scan__linear_kernel_hedgehog__dense_activation_silu__prompt_kernel
.p2align 8
.type recurrent_scan__linear_kernel_hedgehog__dense_activation_silu__prompt_kernel,@function
recurrent_scan__linear_kernel_hedgehog__dense_activation_silu__prompt_kernel:
    s_cmp_ge_u32 s2, 256
    s_cbranch_scc1 L_end
    s_load_dwordx16 s[64:79], s[0:1], 0
    s_load_dwordx4 s[80:83], s[0:1], 64
    v_lshrrev_b32 v3, 6, v0
    v_and_b32 v1, 63, v0
    v_readfirstlane_b32 s3, v3
    v_lshlrev_b32 v2, 4, v1
    s_and_b32 s4, s2, 7
    s_lshr_b32 s5, s2, 3
    s_and_b32 s53, s5, 3
    s_lshr_b32 s52, s5, 2
    s_xor_b32 s52, s52, 4
    s_lshr_b32 s6, s4, 1
    s_lshl_b32 s6, s6, 2
    s_add_u32 s6, s6, s53
    s_lshl_b32 s1, s53, 1
    s_add_u32 s1, s1, s52
    s_sub_u32 s50, s1, 7
    s_cmp_ge_u32 s1, 7
    s_cselect_b32 s1, s50, s1
    s_and_b32 s59, s3, 3
    s_cmp_ge_u32 s3, 4
    s_cbranch_scc1 L_lwave
    v_lshrrev_b32 v242, 3, v1
    v_mul_u32_u24 v240, 896, v242
    v_lshrrev_b32 v242, 4, v1
    v_and_b32 v243, 7, v1
    v_xor_b32 v242, v242, v243
    v_lshl_add_u32 v240, v242, 4, v240
    v_xor_b32 v241, 64, v240
    v_add_u32 v241, 7168, v241
    v_add_u32 v242, 14336, v240
    v_add_u32 v243, 14336, v241
    s_lshl_b32 s60, s6, 2
    s_add_u32 s60, s60, s3
    s_mul_i32 s60, s60, 28672
    s_mul_i32 s61, s3, 28672
    s_lshl_b32 s45, s1, 7
    s_mov_b32 s10, 1835008
    s_mov_b32 s11, 0x20000
    s_waitcnt lgkmcnt(0)
    s_mov_b64 s[8:9], s[64:65]
    s_add_u32 s46, s60, s45
    s_add_u32 m0, s61, 0
    s_add_u32 s45, s45, 128
    s_cmp_eq_u32 s45, 896
    s_cselect_b32 s45, 0, s45
    buffer_load_dwordx4 v240, s[8:11], s46 offen lds
    s_add_u32 m0, s61, 1024
    s_nop 0
    buffer_load_dwordx4 v241, s[8:11], s46 offen lds
    s_add_u32 m0, s61, 2048
    s_nop 0
    buffer_load_dwordx4 v242, s[8:11], s46 offen lds
    s_add_u32 m0, s61, 3072
    s_nop 0
    buffer_load_dwordx4 v243, s[8:11], s46 offen lds
    s_add_u32 s46, s60, s45
    s_add_u32 m0, s61, 4096
    s_add_u32 s45, s45, 128
    s_cmp_eq_u32 s45, 896
    s_cselect_b32 s45, 0, s45
    buffer_load_dwordx4 v240, s[8:11], s46 offen lds
    s_add_u32 m0, s61, 5120
    s_nop 0
    buffer_load_dwordx4 v241, s[8:11], s46 offen lds
    s_add_u32 m0, s61, 6144
    s_nop 0
    buffer_load_dwordx4 v242, s[8:11], s46 offen lds
    s_add_u32 m0, s61, 7168
    s_nop 0
    buffer_load_dwordx4 v243, s[8:11], s46 offen lds
    s_add_u32 s46, s60, s45
    s_add_u32 m0, s61, 8192
    s_add_u32 s45, s45, 128
    s_cmp_eq_u32 s45, 896
    s_cselect_b32 s45, 0, s45
    buffer_load_dwordx4 v240, s[8:11], s46 offen lds
    s_add_u32 m0, s61, 9216
    s_nop 0
    buffer_load_dwordx4 v241, s[8:11], s46 offen lds
    s_add_u32 m0, s61, 10240
    s_nop 0
    buffer_load_dwordx4 v242, s[8:11], s46 offen lds
    s_add_u32 m0, s61, 11264
    s_nop 0
    buffer_load_dwordx4 v243, s[8:11], s46 offen lds
    s_add_u32 s46, s60, s45
    s_add_u32 m0, s61, 12288
    s_add_u32 s45, s45, 128
    s_cmp_eq_u32 s45, 896
    s_cselect_b32 s45, 0, s45
    buffer_load_dwordx4 v240, s[8:11], s46 offen lds
    s_add_u32 m0, s61, 13312
    s_nop 0
    buffer_load_dwordx4 v241, s[8:11], s46 offen lds
    s_add_u32 m0, s61, 14336
    s_nop 0
    buffer_load_dwordx4 v242, s[8:11], s46 offen lds
    s_add_u32 m0, s61, 15360
    s_nop 0
    buffer_load_dwordx4 v243, s[8:11], s46 offen lds
    s_mov_b32 s41, s1
    s_lshl_b32 s40, s4, 2
    s_add_u32 s40, s40, s53
    s_and_b32 s42, s4, 1
    s_lshl_b32 s42, s42, 2
    s_and_b32 s50, s52, 3
    s_add_u32 s42, s42, s50
    s_and_b32 s50, s52, 4
    s_lshl_b32 s50, s50, 1
    s_add_u32 s7, s42, s50
    s_mul_i32 s57, s53, 7
    s_lshl_b32 s50, s41, 2
    s_add_u32 s57, s57, s50
    s_sub_u32 s50, s57, 28
    s_cmp_ge_u32 s57, 28
    s_cselect_b32 s57, s50, s57
    s_lshl_b32 s50, s59, 2
    s_add_u32 s50, s50, 163328
    v_mov_b32 v0, s50
    s_mov_b32 s54, 0
    s_mov_b32 s55, -1
    s_mov_b32 s62, 0x3fb8aa3b
    s_movk_i32 s56, 0x70
    s_mov_b64 s[16:17], s[82:83]
    s_mov_b32 s18, 14979072
    s_mov_b32 s19, 0x20000
    s_mov_b64 s[28:29], s[78:79]
    s_mov_b32 s30, 1835008
    s_mov_b32 s31, 0x20000
    s_mov_b64 s[24:25], s[70:71]
    s_mov_b32 s26, 401408
    s_mov_b32 s27, 0x20000
    v_and_b32 v248, 31, v1
    v_bfe_u32 v249, v1, 1, 3
    v_lshrrev_b32 v244, 5, v1
    v_xor_b32 v249, v249, v244
    v_lshlrev_b32 v249, 4, v249
    v_lshl_add_u32 v244, v248, 7, v249
    v_add_u32 v244, s61, v244
    v_xor_b32 v245, 32, v244
    v_xor_b32 v246, 64, v244
    v_xor_b32 v247, 96, v244
    s_mov_b32 s49, 0x00003f80
    s_mov_b32 s63, 0x3f800000
    s_cmp_ge_u32 s7, 8
    s_cselect_b32 s50, 56, 64
    v_bfe_u32 v248, v1, 2, 2
    v_lshrrev_b32 v249, 5, v1
    v_lshlrev_b32 v249, 10, v249
    v_lshl_add_u32 v249, v248, 7, v249
    v_bfe_u32 v248, v1, 3, 1
    v_lshlrev_b32 v248, 6, v248
    v_bfe_u32 v250, v1, 4, 1
    v_lshlrev_b32 v250, 5, v250
    v_and_b32 v3, 3, v1
    v_lshl_add_u32 v250, v3, 3, v250
    v_xor_b32 v3, v250, v248
    v_add_u32 v3, v3, v249
    v_add_u32 v250, s50, v250
    v_xor_b32 v4, v250, v248
    v_add_u32 v4, v4, v249
    v_mov_b32 v224, 0
    v_mov_b32 v225, 0
    v_mov_b32 v226, 0
    v_mov_b32 v227, 0
    v_mov_b32 v228, 0x3f803f80
    s_waitcnt vmcnt(12)
    ds_read_b128 v[16:19], v244 offset:0
    ds_read_b128 v[20:23], v245 offset:0
    ds_read_b128 v[24:27], v246 offset:0
    ds_read_b128 v[28:31], v247 offset:0
    s_add_u32 s46, s60, s45
    s_add_u32 m0, s61, 16384
    s_add_u32 s45, s45, 128
    s_cmp_eq_u32 s45, 896
    s_cselect_b32 s45, 0, s45
    buffer_load_dwordx4 v240, s[8:11], s46 offen lds
    s_add_u32 m0, s61, 17408
    s_nop 0
    buffer_load_dwordx4 v241, s[8:11], s46 offen lds
    s_add_u32 m0, s61, 18432
    s_nop 0
    buffer_load_dwordx4 v242, s[8:11], s46 offen lds
    s_add_u32 m0, s61, 19456
    s_nop 0
    buffer_load_dwordx4 v243, s[8:11], s46 offen lds
    s_waitcnt vmcnt(12)
    ds_read_b128 v[32:35], v244 offset:4096
    ds_read_b128 v[36:39], v245 offset:4096
    ds_read_b128 v[40:43], v246 offset:4096
    ds_read_b128 v[44:47], v247 offset:4096
    s_add_u32 s46, s60, s45
    s_add_u32 m0, s61, 20480
    s_add_u32 s45, s45, 128
    s_cmp_eq_u32 s45, 896
    s_cselect_b32 s45, 0, s45
    buffer_load_dwordx4 v240, s[8:11], s46 offen lds
    s_add_u32 m0, s61, 21504
    s_nop 0
    buffer_load_dwordx4 v241, s[8:11], s46 offen lds
    s_add_u32 m0, s61, 22528
    s_nop 0
    buffer_load_dwordx4 v242, s[8:11], s46 offen lds
    s_add_u32 m0, s61, 23552
    s_nop 0
    buffer_load_dwordx4 v243, s[8:11], s46 offen lds
    s_waitcnt lgkmcnt(7)
    v_dot2c_f32_bf16 v224, v16, v228
    v_dot2c_f32_bf16 v226, v16, v16
    v_dot2c_f32_bf16 v225, v17, v228
    v_dot2c_f32_bf16 v227, v17, v17
    v_dot2c_f32_bf16 v224, v18, v228
    v_dot2c_f32_bf16 v226, v18, v18
    v_dot2c_f32_bf16 v225, v19, v228
    v_dot2c_f32_bf16 v227, v19, v19
    s_waitcnt lgkmcnt(6)
    v_dot2c_f32_bf16 v224, v20, v228
    v_dot2c_f32_bf16 v226, v20, v20
    v_dot2c_f32_bf16 v225, v21, v228
    v_dot2c_f32_bf16 v227, v21, v21
    v_dot2c_f32_bf16 v224, v22, v228
    v_dot2c_f32_bf16 v226, v22, v22
    v_dot2c_f32_bf16 v225, v23, v228
    v_dot2c_f32_bf16 v227, v23, v23
    s_waitcnt lgkmcnt(5)
    v_dot2c_f32_bf16 v224, v24, v228
    v_dot2c_f32_bf16 v226, v24, v24
    v_dot2c_f32_bf16 v225, v25, v228
    v_dot2c_f32_bf16 v227, v25, v25
    v_dot2c_f32_bf16 v224, v26, v228
    v_dot2c_f32_bf16 v226, v26, v26
    v_dot2c_f32_bf16 v225, v27, v228
    v_dot2c_f32_bf16 v227, v27, v27
    s_waitcnt lgkmcnt(4)
    v_dot2c_f32_bf16 v224, v28, v228
    v_dot2c_f32_bf16 v226, v28, v28
    v_dot2c_f32_bf16 v225, v29, v228
    v_dot2c_f32_bf16 v227, v29, v29
    v_dot2c_f32_bf16 v224, v30, v228
    v_dot2c_f32_bf16 v226, v30, v30
    v_dot2c_f32_bf16 v225, v31, v228
    v_dot2c_f32_bf16 v227, v31, v31
    s_waitcnt vmcnt(12)
    ds_read_b128 v[48:51], v244 offset:8192
    ds_read_b128 v[52:55], v245 offset:8192
    ds_read_b128 v[56:59], v246 offset:8192
    ds_read_b128 v[60:63], v247 offset:8192
    s_add_u32 s46, s60, s45
    s_add_u32 m0, s61, 24576
    s_nop 0
    buffer_load_dwordx4 v240, s[8:11], s46 offen lds
    s_add_u32 m0, s61, 25600
    s_nop 0
    buffer_load_dwordx4 v241, s[8:11], s46 offen lds
    s_add_u32 m0, s61, 26624
    s_nop 0
    buffer_load_dwordx4 v242, s[8:11], s46 offen lds
    s_add_u32 m0, s61, 27648
    s_nop 0
    buffer_load_dwordx4 v243, s[8:11], s46 offen lds
    s_barrier
    s_waitcnt lgkmcnt(7)
    v_dot2c_f32_bf16 v224, v32, v228
    v_dot2c_f32_bf16 v226, v32, v32
    v_dot2c_f32_bf16 v225, v33, v228
    v_dot2c_f32_bf16 v227, v33, v33
    v_dot2c_f32_bf16 v224, v34, v228
    v_dot2c_f32_bf16 v226, v34, v34
    v_dot2c_f32_bf16 v225, v35, v228
    v_dot2c_f32_bf16 v227, v35, v35
    s_waitcnt lgkmcnt(6)
    v_dot2c_f32_bf16 v224, v36, v228
    v_dot2c_f32_bf16 v226, v36, v36
    v_dot2c_f32_bf16 v225, v37, v228
    v_dot2c_f32_bf16 v227, v37, v37
    v_dot2c_f32_bf16 v224, v38, v228
    v_dot2c_f32_bf16 v226, v38, v38
    v_dot2c_f32_bf16 v225, v39, v228
    v_dot2c_f32_bf16 v227, v39, v39
    s_waitcnt lgkmcnt(5)
    v_dot2c_f32_bf16 v224, v40, v228
    v_dot2c_f32_bf16 v226, v40, v40
    v_dot2c_f32_bf16 v225, v41, v228
    v_dot2c_f32_bf16 v227, v41, v41
    v_dot2c_f32_bf16 v224, v42, v228
    v_dot2c_f32_bf16 v226, v42, v42
    v_dot2c_f32_bf16 v225, v43, v228
    v_dot2c_f32_bf16 v227, v43, v43
    s_waitcnt lgkmcnt(4)
    v_dot2c_f32_bf16 v224, v44, v228
    v_dot2c_f32_bf16 v226, v44, v44
    v_dot2c_f32_bf16 v225, v45, v228
    v_dot2c_f32_bf16 v227, v45, v45
    v_dot2c_f32_bf16 v224, v46, v228
    v_dot2c_f32_bf16 v226, v46, v46
    v_dot2c_f32_bf16 v225, v47, v228
    v_dot2c_f32_bf16 v227, v47, v47
    s_waitcnt vmcnt(12)
    ds_read_b128 v[64:67], v244 offset:12288
    ds_read_b128 v[68:71], v245 offset:12288
    ds_read_b128 v[72:75], v246 offset:12288
    ds_read_b128 v[76:79], v247 offset:12288
    s_waitcnt lgkmcnt(7)
    v_dot2c_f32_bf16 v224, v48, v228
    v_dot2c_f32_bf16 v226, v48, v48
    v_dot2c_f32_bf16 v225, v49, v228
    v_dot2c_f32_bf16 v227, v49, v49
    v_dot2c_f32_bf16 v224, v50, v228
    v_dot2c_f32_bf16 v226, v50, v50
    v_dot2c_f32_bf16 v225, v51, v228
    v_dot2c_f32_bf16 v227, v51, v51
    s_waitcnt lgkmcnt(6)
    v_dot2c_f32_bf16 v224, v52, v228
    v_dot2c_f32_bf16 v226, v52, v52
    v_dot2c_f32_bf16 v225, v53, v228
    v_dot2c_f32_bf16 v227, v53, v53
    v_dot2c_f32_bf16 v224, v54, v228
    v_dot2c_f32_bf16 v226, v54, v54
    v_dot2c_f32_bf16 v225, v55, v228
    v_dot2c_f32_bf16 v227, v55, v55
    s_waitcnt lgkmcnt(5)
    v_dot2c_f32_bf16 v224, v56, v228
    v_dot2c_f32_bf16 v226, v56, v56
    v_dot2c_f32_bf16 v225, v57, v228
    v_dot2c_f32_bf16 v227, v57, v57
    v_dot2c_f32_bf16 v224, v58, v228
    v_dot2c_f32_bf16 v226, v58, v58
    v_dot2c_f32_bf16 v225, v59, v228
    v_dot2c_f32_bf16 v227, v59, v59
    s_waitcnt lgkmcnt(4)
    v_dot2c_f32_bf16 v224, v60, v228
    v_dot2c_f32_bf16 v226, v60, v60
    v_dot2c_f32_bf16 v225, v61, v228
    v_dot2c_f32_bf16 v227, v61, v61
    v_dot2c_f32_bf16 v224, v62, v228
    v_dot2c_f32_bf16 v226, v62, v62
    v_dot2c_f32_bf16 v225, v63, v228
    v_dot2c_f32_bf16 v227, v63, v63
    s_waitcnt vmcnt(8)
    ds_read_b128 v[80:83], v244 offset:16384
    ds_read_b128 v[84:87], v245 offset:16384
    ds_read_b128 v[88:91], v246 offset:16384
    ds_read_b128 v[92:95], v247 offset:16384
    s_waitcnt lgkmcnt(7)
    v_dot2c_f32_bf16 v224, v64, v228
    v_dot2c_f32_bf16 v226, v64, v64
    v_dot2c_f32_bf16 v225, v65, v228
    v_dot2c_f32_bf16 v227, v65, v65
    v_dot2c_f32_bf16 v224, v66, v228
    v_dot2c_f32_bf16 v226, v66, v66
    v_dot2c_f32_bf16 v225, v67, v228
    v_dot2c_f32_bf16 v227, v67, v67
    s_waitcnt lgkmcnt(6)
    v_dot2c_f32_bf16 v224, v68, v228
    v_dot2c_f32_bf16 v226, v68, v68
    v_dot2c_f32_bf16 v225, v69, v228
    v_dot2c_f32_bf16 v227, v69, v69
    v_dot2c_f32_bf16 v224, v70, v228
    v_dot2c_f32_bf16 v226, v70, v70
    v_dot2c_f32_bf16 v225, v71, v228
    v_dot2c_f32_bf16 v227, v71, v71
    s_waitcnt lgkmcnt(5)
    v_dot2c_f32_bf16 v224, v72, v228
    v_dot2c_f32_bf16 v226, v72, v72
    v_dot2c_f32_bf16 v225, v73, v228
    v_dot2c_f32_bf16 v227, v73, v73
    v_dot2c_f32_bf16 v224, v74, v228
    v_dot2c_f32_bf16 v226, v74, v74
    v_dot2c_f32_bf16 v225, v75, v228
    v_dot2c_f32_bf16 v227, v75, v75
    s_waitcnt lgkmcnt(4)
    v_dot2c_f32_bf16 v224, v76, v228
    v_dot2c_f32_bf16 v226, v76, v76
    v_dot2c_f32_bf16 v225, v77, v228
    v_dot2c_f32_bf16 v227, v77, v77
    v_dot2c_f32_bf16 v224, v78, v228
    v_dot2c_f32_bf16 v226, v78, v78
    v_dot2c_f32_bf16 v225, v79, v228
    v_dot2c_f32_bf16 v227, v79, v79
    s_waitcnt vmcnt(4)
    ds_read_b128 v[96:99], v244 offset:20480
    ds_read_b128 v[100:103], v245 offset:20480
    ds_read_b128 v[104:107], v246 offset:20480
    ds_read_b128 v[108:111], v247 offset:20480
    s_waitcnt lgkmcnt(7)
    v_dot2c_f32_bf16 v224, v80, v228
    v_dot2c_f32_bf16 v226, v80, v80
    v_dot2c_f32_bf16 v225, v81, v228
    v_dot2c_f32_bf16 v227, v81, v81
    v_dot2c_f32_bf16 v224, v82, v228
    v_dot2c_f32_bf16 v226, v82, v82
    v_dot2c_f32_bf16 v225, v83, v228
    v_dot2c_f32_bf16 v227, v83, v83
    s_waitcnt lgkmcnt(6)
    v_dot2c_f32_bf16 v224, v84, v228
    v_dot2c_f32_bf16 v226, v84, v84
    v_dot2c_f32_bf16 v225, v85, v228
    v_dot2c_f32_bf16 v227, v85, v85
    v_dot2c_f32_bf16 v224, v86, v228
    v_dot2c_f32_bf16 v226, v86, v86
    v_dot2c_f32_bf16 v225, v87, v228
    v_dot2c_f32_bf16 v227, v87, v87
    s_waitcnt lgkmcnt(5)
    v_dot2c_f32_bf16 v224, v88, v228
    v_dot2c_f32_bf16 v226, v88, v88
    v_dot2c_f32_bf16 v225, v89, v228
    v_dot2c_f32_bf16 v227, v89, v89
    v_dot2c_f32_bf16 v224, v90, v228
    v_dot2c_f32_bf16 v226, v90, v90
    v_dot2c_f32_bf16 v225, v91, v228
    v_dot2c_f32_bf16 v227, v91, v91
    s_waitcnt lgkmcnt(4)
    v_dot2c_f32_bf16 v224, v92, v228
    v_dot2c_f32_bf16 v226, v92, v92
    v_dot2c_f32_bf16 v225, v93, v228
    v_dot2c_f32_bf16 v227, v93, v93
    v_dot2c_f32_bf16 v224, v94, v228
    v_dot2c_f32_bf16 v226, v94, v94
    v_dot2c_f32_bf16 v225, v95, v228
    v_dot2c_f32_bf16 v227, v95, v95
    s_waitcnt vmcnt(0)
    ds_read_b128 v[112:115], v244 offset:24576
    ds_read_b128 v[116:119], v245 offset:24576
    ds_read_b128 v[120:123], v246 offset:24576
    ds_read_b128 v[124:127], v247 offset:24576
    ds_write_b32 v0, v0 offset:0
    s_waitcnt lgkmcnt(8)
    v_dot2c_f32_bf16 v224, v96, v228
    v_dot2c_f32_bf16 v226, v96, v96
    v_dot2c_f32_bf16 v225, v97, v228
    v_dot2c_f32_bf16 v227, v97, v97
    v_dot2c_f32_bf16 v224, v98, v228
    v_dot2c_f32_bf16 v226, v98, v98
    v_dot2c_f32_bf16 v225, v99, v228
    v_dot2c_f32_bf16 v227, v99, v99
    s_waitcnt lgkmcnt(7)
    v_dot2c_f32_bf16 v224, v100, v228
    v_dot2c_f32_bf16 v226, v100, v100
    v_dot2c_f32_bf16 v225, v101, v228
    v_dot2c_f32_bf16 v227, v101, v101
    v_dot2c_f32_bf16 v224, v102, v228
    v_dot2c_f32_bf16 v226, v102, v102
    v_dot2c_f32_bf16 v225, v103, v228
    v_dot2c_f32_bf16 v227, v103, v103
    s_waitcnt lgkmcnt(6)
    v_dot2c_f32_bf16 v224, v104, v228
    v_dot2c_f32_bf16 v226, v104, v104
    v_dot2c_f32_bf16 v225, v105, v228
    v_dot2c_f32_bf16 v227, v105, v105
    v_dot2c_f32_bf16 v224, v106, v228
    v_dot2c_f32_bf16 v226, v106, v106
    v_dot2c_f32_bf16 v225, v107, v228
    v_dot2c_f32_bf16 v227, v107, v107
    s_waitcnt lgkmcnt(5)
    v_dot2c_f32_bf16 v224, v108, v228
    v_dot2c_f32_bf16 v226, v108, v108
    v_dot2c_f32_bf16 v225, v109, v228
    v_dot2c_f32_bf16 v227, v109, v109
    v_dot2c_f32_bf16 v224, v110, v228
    v_dot2c_f32_bf16 v226, v110, v110
    v_dot2c_f32_bf16 v225, v111, v228
    v_dot2c_f32_bf16 v227, v111, v111
    s_waitcnt lgkmcnt(4)
    v_dot2c_f32_bf16 v224, v112, v228
    v_dot2c_f32_bf16 v226, v112, v112
    v_dot2c_f32_bf16 v225, v113, v228
    v_dot2c_f32_bf16 v227, v113, v113
    v_dot2c_f32_bf16 v224, v114, v228
    v_dot2c_f32_bf16 v226, v114, v114
    v_dot2c_f32_bf16 v225, v115, v228
    v_dot2c_f32_bf16 v227, v115, v115
    s_waitcnt lgkmcnt(3)
    v_dot2c_f32_bf16 v224, v116, v228
    v_dot2c_f32_bf16 v226, v116, v116
    v_dot2c_f32_bf16 v225, v117, v228
    v_dot2c_f32_bf16 v227, v117, v117
    v_dot2c_f32_bf16 v224, v118, v228
    v_dot2c_f32_bf16 v226, v118, v118
    v_dot2c_f32_bf16 v225, v119, v228
    v_dot2c_f32_bf16 v227, v119, v119
    s_waitcnt lgkmcnt(2)
    v_dot2c_f32_bf16 v224, v120, v228
    v_dot2c_f32_bf16 v226, v120, v120
    v_dot2c_f32_bf16 v225, v121, v228
    v_dot2c_f32_bf16 v227, v121, v121
    v_dot2c_f32_bf16 v224, v122, v228
    v_dot2c_f32_bf16 v226, v122, v122
    v_dot2c_f32_bf16 v225, v123, v228
    v_dot2c_f32_bf16 v227, v123, v123
    s_waitcnt lgkmcnt(1)
    v_dot2c_f32_bf16 v224, v124, v228
    v_dot2c_f32_bf16 v226, v124, v124
    v_dot2c_f32_bf16 v225, v125, v228
    v_dot2c_f32_bf16 v227, v125, v125
    v_dot2c_f32_bf16 v224, v126, v228
    v_dot2c_f32_bf16 v226, v126, v126
    v_dot2c_f32_bf16 v225, v127, v228
    v_dot2c_f32_bf16 v227, v127, v127
    s_nop 1
    v_add_f32 v224, v224, v225
    v_add_f32 v226, v226, v227
    v_mov_b32 v225, v224
    v_mov_b32 v227, v226
    s_nop 0
    v_permlane32_swap_b32 v224, v225
    v_permlane32_swap_b32 v226, v227
    v_add_f32 v224, v224, v225
    v_add_f32 v226, v226, v227
    v_mul_f32 v224, 0x3b124925, v224
    v_mul_f32 v226, 0x3b124925, v226
    v_fma_f32 v226, -v224, v224, v226
    v_max_f32 v226, 0, v226
    v_cvt_pk_bf16_f32 v229, v224, v226
    v_lshlrev_b32 v13, 16, v229
    v_xor_b32 v13, 0x80000000, v13
    ds_read_b32 v12, v0 offset:128
    v_dot2_f32_bf16 v248, v16, s49, v13
    v_dot2_f32_bf16 v249, v16, s63, v13
    v_dot2_f32_bf16 v250, v17, s49, v13
    v_dot2_f32_bf16 v251, v17, s63, v13
    v_dot2_f32_bf16 v252, v18, s49, v13
    v_dot2_f32_bf16 v253, v18, s63, v13
    v_dot2_f32_bf16 v254, v19, s49, v13
    v_dot2_f32_bf16 v255, v19, s63, v13
    v_cvt_pk_bf16_f32 v16, v248, v249
    v_cvt_pk_bf16_f32 v17, v250, v251
    v_cvt_pk_bf16_f32 v18, v252, v253
    v_cvt_pk_bf16_f32 v19, v254, v255
    v_dot2_f32_bf16 v248, v20, s49, v13
    v_dot2_f32_bf16 v249, v20, s63, v13
    v_dot2_f32_bf16 v250, v21, s49, v13
    v_dot2_f32_bf16 v251, v21, s63, v13
    v_dot2_f32_bf16 v252, v22, s49, v13
    v_dot2_f32_bf16 v253, v22, s63, v13
    v_dot2_f32_bf16 v254, v23, s49, v13
    v_dot2_f32_bf16 v255, v23, s63, v13
    v_cvt_pk_bf16_f32 v20, v248, v249
    v_cvt_pk_bf16_f32 v21, v250, v251
    v_cvt_pk_bf16_f32 v22, v252, v253
    v_cvt_pk_bf16_f32 v23, v254, v255
    v_dot2_f32_bf16 v248, v24, s49, v13
    v_dot2_f32_bf16 v249, v24, s63, v13
    v_dot2_f32_bf16 v250, v25, s49, v13
    v_dot2_f32_bf16 v251, v25, s63, v13
    v_dot2_f32_bf16 v252, v26, s49, v13
    v_dot2_f32_bf16 v253, v26, s63, v13
    v_dot2_f32_bf16 v254, v27, s49, v13
    v_dot2_f32_bf16 v255, v27, s63, v13
    v_cvt_pk_bf16_f32 v24, v248, v249
    v_cvt_pk_bf16_f32 v25, v250, v251
    v_cvt_pk_bf16_f32 v26, v252, v253
    v_cvt_pk_bf16_f32 v27, v254, v255
    v_dot2_f32_bf16 v248, v28, s49, v13
    v_dot2_f32_bf16 v249, v28, s63, v13
    v_dot2_f32_bf16 v250, v29, s49, v13
    v_dot2_f32_bf16 v251, v29, s63, v13
    v_dot2_f32_bf16 v252, v30, s49, v13
    v_dot2_f32_bf16 v253, v30, s63, v13
    v_dot2_f32_bf16 v254, v31, s49, v13
    v_dot2_f32_bf16 v255, v31, s63, v13
    v_cvt_pk_bf16_f32 v28, v248, v249
    v_cvt_pk_bf16_f32 v29, v250, v251
    v_cvt_pk_bf16_f32 v30, v252, v253
    v_cvt_pk_bf16_f32 v31, v254, v255
    v_dot2_f32_bf16 v248, v32, s49, v13
    v_dot2_f32_bf16 v249, v32, s63, v13
    v_dot2_f32_bf16 v250, v33, s49, v13
    v_dot2_f32_bf16 v251, v33, s63, v13
    v_dot2_f32_bf16 v252, v34, s49, v13
    v_dot2_f32_bf16 v253, v34, s63, v13
    v_dot2_f32_bf16 v254, v35, s49, v13
    v_dot2_f32_bf16 v255, v35, s63, v13
    v_cvt_pk_bf16_f32 v32, v248, v249
    v_cvt_pk_bf16_f32 v33, v250, v251
    v_cvt_pk_bf16_f32 v34, v252, v253
    v_cvt_pk_bf16_f32 v35, v254, v255
    v_dot2_f32_bf16 v248, v36, s49, v13
    v_dot2_f32_bf16 v249, v36, s63, v13
    v_dot2_f32_bf16 v250, v37, s49, v13
    v_dot2_f32_bf16 v251, v37, s63, v13
    v_dot2_f32_bf16 v252, v38, s49, v13
    v_dot2_f32_bf16 v253, v38, s63, v13
    v_dot2_f32_bf16 v254, v39, s49, v13
    v_dot2_f32_bf16 v255, v39, s63, v13
    v_cvt_pk_bf16_f32 v36, v248, v249
    v_cvt_pk_bf16_f32 v37, v250, v251
    v_cvt_pk_bf16_f32 v38, v252, v253
    v_cvt_pk_bf16_f32 v39, v254, v255
    v_dot2_f32_bf16 v248, v40, s49, v13
    v_dot2_f32_bf16 v249, v40, s63, v13
    v_dot2_f32_bf16 v250, v41, s49, v13
    v_dot2_f32_bf16 v251, v41, s63, v13
    v_dot2_f32_bf16 v252, v42, s49, v13
    v_dot2_f32_bf16 v253, v42, s63, v13
    v_dot2_f32_bf16 v254, v43, s49, v13
    v_dot2_f32_bf16 v255, v43, s63, v13
    v_cvt_pk_bf16_f32 v40, v248, v249
    v_cvt_pk_bf16_f32 v41, v250, v251
    v_cvt_pk_bf16_f32 v42, v252, v253
    v_cvt_pk_bf16_f32 v43, v254, v255
    v_dot2_f32_bf16 v248, v44, s49, v13
    v_dot2_f32_bf16 v249, v44, s63, v13
    v_dot2_f32_bf16 v250, v45, s49, v13
    v_dot2_f32_bf16 v251, v45, s63, v13
    v_dot2_f32_bf16 v252, v46, s49, v13
    v_dot2_f32_bf16 v253, v46, s63, v13
    v_dot2_f32_bf16 v254, v47, s49, v13
    v_dot2_f32_bf16 v255, v47, s63, v13
    v_cvt_pk_bf16_f32 v44, v248, v249
    v_cvt_pk_bf16_f32 v45, v250, v251
    v_cvt_pk_bf16_f32 v46, v252, v253
    v_cvt_pk_bf16_f32 v47, v254, v255
    v_dot2_f32_bf16 v248, v48, s49, v13
    v_dot2_f32_bf16 v249, v48, s63, v13
    v_dot2_f32_bf16 v250, v49, s49, v13
    v_dot2_f32_bf16 v251, v49, s63, v13
    v_dot2_f32_bf16 v252, v50, s49, v13
    v_dot2_f32_bf16 v253, v50, s63, v13
    v_dot2_f32_bf16 v254, v51, s49, v13
    v_dot2_f32_bf16 v255, v51, s63, v13
    v_cvt_pk_bf16_f32 v48, v248, v249
    v_cvt_pk_bf16_f32 v49, v250, v251
    v_cvt_pk_bf16_f32 v50, v252, v253
    v_cvt_pk_bf16_f32 v51, v254, v255
    v_dot2_f32_bf16 v248, v52, s49, v13
    v_dot2_f32_bf16 v249, v52, s63, v13
    v_dot2_f32_bf16 v250, v53, s49, v13
    v_dot2_f32_bf16 v251, v53, s63, v13
    v_dot2_f32_bf16 v252, v54, s49, v13
    v_dot2_f32_bf16 v253, v54, s63, v13
    v_dot2_f32_bf16 v254, v55, s49, v13
    v_dot2_f32_bf16 v255, v55, s63, v13
    v_cvt_pk_bf16_f32 v52, v248, v249
    v_cvt_pk_bf16_f32 v53, v250, v251
    v_cvt_pk_bf16_f32 v54, v252, v253
    v_cvt_pk_bf16_f32 v55, v254, v255
    v_dot2_f32_bf16 v248, v56, s49, v13
    v_dot2_f32_bf16 v249, v56, s63, v13
    v_dot2_f32_bf16 v250, v57, s49, v13
    v_dot2_f32_bf16 v251, v57, s63, v13
    v_dot2_f32_bf16 v252, v58, s49, v13
    v_dot2_f32_bf16 v253, v58, s63, v13
    v_dot2_f32_bf16 v254, v59, s49, v13
    v_dot2_f32_bf16 v255, v59, s63, v13
    v_cvt_pk_bf16_f32 v56, v248, v249
    v_cvt_pk_bf16_f32 v57, v250, v251
    v_cvt_pk_bf16_f32 v58, v252, v253
    v_cvt_pk_bf16_f32 v59, v254, v255
    v_dot2_f32_bf16 v248, v60, s49, v13
    v_dot2_f32_bf16 v249, v60, s63, v13
    v_dot2_f32_bf16 v250, v61, s49, v13
    v_dot2_f32_bf16 v251, v61, s63, v13
    v_dot2_f32_bf16 v252, v62, s49, v13
    v_dot2_f32_bf16 v253, v62, s63, v13
    v_dot2_f32_bf16 v254, v63, s49, v13
    v_dot2_f32_bf16 v255, v63, s63, v13
    v_cvt_pk_bf16_f32 v60, v248, v249
    v_cvt_pk_bf16_f32 v61, v250, v251
    v_cvt_pk_bf16_f32 v62, v252, v253
    v_cvt_pk_bf16_f32 v63, v254, v255
    v_dot2_f32_bf16 v248, v64, s49, v13
    v_dot2_f32_bf16 v249, v64, s63, v13
    v_dot2_f32_bf16 v250, v65, s49, v13
    v_dot2_f32_bf16 v251, v65, s63, v13
    v_dot2_f32_bf16 v252, v66, s49, v13
    v_dot2_f32_bf16 v253, v66, s63, v13
    v_dot2_f32_bf16 v254, v67, s49, v13
    v_dot2_f32_bf16 v255, v67, s63, v13
    v_cvt_pk_bf16_f32 v64, v248, v249
    v_cvt_pk_bf16_f32 v65, v250, v251
    v_cvt_pk_bf16_f32 v66, v252, v253
    v_cvt_pk_bf16_f32 v67, v254, v255
    v_dot2_f32_bf16 v248, v68, s49, v13
    v_dot2_f32_bf16 v249, v68, s63, v13
    v_dot2_f32_bf16 v250, v69, s49, v13
    v_dot2_f32_bf16 v251, v69, s63, v13
    v_dot2_f32_bf16 v252, v70, s49, v13
    v_dot2_f32_bf16 v253, v70, s63, v13
    v_dot2_f32_bf16 v254, v71, s49, v13
    v_dot2_f32_bf16 v255, v71, s63, v13
    v_cvt_pk_bf16_f32 v68, v248, v249
    v_cvt_pk_bf16_f32 v69, v250, v251
    v_cvt_pk_bf16_f32 v70, v252, v253
    v_cvt_pk_bf16_f32 v71, v254, v255
    v_dot2_f32_bf16 v248, v72, s49, v13
    v_dot2_f32_bf16 v249, v72, s63, v13
    v_dot2_f32_bf16 v250, v73, s49, v13
    v_dot2_f32_bf16 v251, v73, s63, v13
    v_dot2_f32_bf16 v252, v74, s49, v13
    v_dot2_f32_bf16 v253, v74, s63, v13
    v_dot2_f32_bf16 v254, v75, s49, v13
    v_dot2_f32_bf16 v255, v75, s63, v13
    v_cvt_pk_bf16_f32 v72, v248, v249
    v_cvt_pk_bf16_f32 v73, v250, v251
    v_cvt_pk_bf16_f32 v74, v252, v253
    v_cvt_pk_bf16_f32 v75, v254, v255
    s_waitcnt lgkmcnt(0)
    v_readfirstlane_b32 s58, v12
    s_nop 0
    s_cmp_ge_u32 s58, 4
    s_cbranch_scc0 L_ck3
L_ck2:
    v_add_u32 v5, 114688, v3
    v_add_u32 v6, 114688, v4
    ds_read_b64_tr_b16 v[192:193], v5 offset:0
    ds_read_b64_tr_b16 v[194:195], v5 offset:512
    ds_read_b64_tr_b16 v[196:197], v6 offset:0
    ds_read_b64_tr_b16 v[198:199], v6 offset:512
    ds_read_b64_tr_b16 v[200:201], v5 offset:2048
    ds_read_b64_tr_b16 v[202:203], v5 offset:2560
    ds_read_b64_tr_b16 v[204:205], v6 offset:2048
    ds_read_b64_tr_b16 v[206:207], v6 offset:2560
    ds_read_b64_tr_b16 v[208:209], v5 offset:4096
    ds_read_b64_tr_b16 v[210:211], v5 offset:4608
    ds_read_b64_tr_b16 v[212:213], v6 offset:4096
    ds_read_b64_tr_b16 v[214:215], v6 offset:4608
    s_waitcnt lgkmcnt(10)
    v_mfma_f32_32x32x16_bf16 v[128:143], v[192:195], v[16:19], 0
    ds_read_b64_tr_b16 v[216:217], v5 offset:6144
    ds_read_b64_tr_b16 v[218:219], v5 offset:6656
    ds_read_b64_tr_b16 v[220:221], v6 offset:6144
    ds_read_b64_tr_b16 v[222:223], v6 offset:6656
    v_lshlrev_b32 v248, 16, v76
    v_and_b32 v249, 0xffff0000, v76
    v_add_f32 v248, v248, v13
    s_waitcnt lgkmcnt(12)
    v_mfma_f32_32x32x16_bf16 v[144:159], v[196:199], v[16:19], 0
    s_waitcnt lgkmcnt(8)
    v_add_f32 v249, v249, v13
    v_cvt_pk_bf16_f32 v76, v248, v249
    v_lshlrev_b32 v250, 16, v77
    v_and_b32 v251, 0xffff0000, v77
    v_add_f32 v250, v250, v13
    v_add_f32 v251, v251, v13
    v_cvt_pk_bf16_f32 v77, v250, v251
    v_mfma_f32_32x32x16_bf16 v[128:143], v[200:203], v[20:23], v[128:143]
    ds_read_b64_tr_b16 v[192:193], v5 offset:8192
    ds_read_b64_tr_b16 v[194:195], v5 offset:8704
    ds_read_b64_tr_b16 v[196:197], v6 offset:8192
    ds_read_b64_tr_b16 v[198:199], v6 offset:8704
    v_lshlrev_b32 v252, 16, v78
    v_and_b32 v253, 0xffff0000, v78
    v_add_f32 v252, v252, v13
    v_mfma_f32_32x32x16_bf16 v[144:159], v[204:207], v[20:23], v[144:159]
    s_waitcnt lgkmcnt(8)
    v_add_f32 v253, v253, v13
    v_cvt_pk_bf16_f32 v78, v252, v253
    v_lshlrev_b32 v254, 16, v79
    v_and_b32 v255, 0xffff0000, v79
    v_add_f32 v254, v254, v13
    v_add_f32 v255, v255, v13
    v_cvt_pk_bf16_f32 v79, v254, v255
    v_mfma_f32_32x32x16_bf16 v[128:143], v[208:211], v[24:27], v[128:143]
    ds_read_b64_tr_b16 v[200:201], v5 offset:10240
    ds_read_b64_tr_b16 v[202:203], v5 offset:10752
    ds_read_b64_tr_b16 v[204:205], v6 offset:10240
    ds_read_b64_tr_b16 v[206:207], v6 offset:10752
    v_lshlrev_b32 v248, 16, v80
    v_and_b32 v249, 0xffff0000, v80
    v_add_f32 v248, v248, v13
    v_mfma_f32_32x32x16_bf16 v[144:159], v[212:215], v[24:27], v[144:159]
    s_waitcnt lgkmcnt(8)
    v_add_f32 v249, v249, v13
    v_cvt_pk_bf16_f32 v80, v248, v249
    v_lshlrev_b32 v250, 16, v81
    v_and_b32 v251, 0xffff0000, v81
    v_add_f32 v250, v250, v13
    v_add_f32 v251, v251, v13
    v_cvt_pk_bf16_f32 v81, v250, v251
    v_mfma_f32_32x32x16_bf16 v[128:143], v[216:219], v[28:31], v[128:143]
    ds_read_b64_tr_b16 v[208:209], v5 offset:12288
    ds_read_b64_tr_b16 v[210:211], v5 offset:12800
    ds_read_b64_tr_b16 v[212:213], v6 offset:12288
    ds_read_b64_tr_b16 v[214:215], v6 offset:12800
    v_lshlrev_b32 v252, 16, v82
    v_and_b32 v253, 0xffff0000, v82
    v_add_f32 v252, v252, v13
    v_mfma_f32_32x32x16_bf16 v[144:159], v[220:223], v[28:31], v[144:159]
    s_waitcnt lgkmcnt(8)
    v_add_f32 v253, v253, v13
    v_cvt_pk_bf16_f32 v82, v252, v253
    v_lshlrev_b32 v254, 16, v83
    v_and_b32 v255, 0xffff0000, v83
    v_add_f32 v254, v254, v13
    v_add_f32 v255, v255, v13
    v_cvt_pk_bf16_f32 v83, v254, v255
    v_mfma_f32_32x32x16_bf16 v[128:143], v[192:195], v[32:35], v[128:143]
    ds_read_b64_tr_b16 v[216:217], v5 offset:14336
    ds_read_b64_tr_b16 v[218:219], v5 offset:14848
    ds_read_b64_tr_b16 v[220:221], v6 offset:14336
    ds_read_b64_tr_b16 v[222:223], v6 offset:14848
    v_lshlrev_b32 v248, 16, v84
    v_and_b32 v249, 0xffff0000, v84
    v_add_f32 v248, v248, v13
    v_mfma_f32_32x32x16_bf16 v[144:159], v[196:199], v[32:35], v[144:159]
    s_waitcnt lgkmcnt(8)
    v_add_f32 v249, v249, v13
    v_cvt_pk_bf16_f32 v84, v248, v249
    v_lshlrev_b32 v250, 16, v85
    v_and_b32 v251, 0xffff0000, v85
    v_add_f32 v250, v250, v13
    v_add_f32 v251, v251, v13
    v_cvt_pk_bf16_f32 v85, v250, v251
    v_mfma_f32_32x32x16_bf16 v[128:143], v[200:203], v[36:39], v[128:143]
    ds_read_b64_tr_b16 v[192:193], v5 offset:16384
    ds_read_b64_tr_b16 v[194:195], v5 offset:16896
    ds_read_b64_tr_b16 v[196:197], v6 offset:16384
    ds_read_b64_tr_b16 v[198:199], v6 offset:16896
    v_lshlrev_b32 v252, 16, v86
    v_and_b32 v253, 0xffff0000, v86
    v_add_f32 v252, v252, v13
    v_mfma_f32_32x32x16_bf16 v[144:159], v[204:207], v[36:39], v[144:159]
    s_waitcnt lgkmcnt(8)
    v_add_f32 v253, v253, v13
    v_cvt_pk_bf16_f32 v86, v252, v253
    v_lshlrev_b32 v254, 16, v87
    v_and_b32 v255, 0xffff0000, v87
    v_add_f32 v254, v254, v13
    v_add_f32 v255, v255, v13
    v_cvt_pk_bf16_f32 v87, v254, v255
    v_mfma_f32_32x32x16_bf16 v[128:143], v[208:211], v[40:43], v[128:143]
    ds_read_b64_tr_b16 v[200:201], v5 offset:18432
    ds_read_b64_tr_b16 v[202:203], v5 offset:18944
    ds_read_b64_tr_b16 v[204:205], v6 offset:18432
    ds_read_b64_tr_b16 v[206:207], v6 offset:18944
    v_lshlrev_b32 v248, 16, v88
    v_and_b32 v249, 0xffff0000, v88
    v_add_f32 v248, v248, v13
    v_mfma_f32_32x32x16_bf16 v[144:159], v[212:215], v[40:43], v[144:159]
    s_waitcnt lgkmcnt(8)
    v_add_f32 v249, v249, v13
    v_cvt_pk_bf16_f32 v88, v248, v249
    v_lshlrev_b32 v250, 16, v89
    v_and_b32 v251, 0xffff0000, v89
    v_add_f32 v250, v250, v13
    v_add_f32 v251, v251, v13
    v_cvt_pk_bf16_f32 v89, v250, v251
    v_mfma_f32_32x32x16_bf16 v[128:143], v[216:219], v[44:47], v[128:143]
    ds_read_b64_tr_b16 v[208:209], v5 offset:20480
    ds_read_b64_tr_b16 v[210:211], v5 offset:20992
    ds_read_b64_tr_b16 v[212:213], v6 offset:20480
    ds_read_b64_tr_b16 v[214:215], v6 offset:20992
    v_lshlrev_b32 v252, 16, v90
    v_and_b32 v253, 0xffff0000, v90
    v_add_f32 v252, v252, v13
    v_mfma_f32_32x32x16_bf16 v[144:159], v[220:223], v[44:47], v[144:159]
    s_waitcnt lgkmcnt(8)
    v_add_f32 v253, v253, v13
    v_cvt_pk_bf16_f32 v90, v252, v253
    v_lshlrev_b32 v254, 16, v91
    v_and_b32 v255, 0xffff0000, v91
    v_add_f32 v254, v254, v13
    v_add_f32 v255, v255, v13
    v_cvt_pk_bf16_f32 v91, v254, v255
    v_mfma_f32_32x32x16_bf16 v[128:143], v[192:195], v[48:51], v[128:143]
    ds_read_b64_tr_b16 v[216:217], v5 offset:22528
    ds_read_b64_tr_b16 v[218:219], v5 offset:23040
    ds_read_b64_tr_b16 v[220:221], v6 offset:22528
    ds_read_b64_tr_b16 v[222:223], v6 offset:23040
    ds_read_b32 v12, v0 offset:144
    v_lshlrev_b32 v248, 16, v92
    v_and_b32 v249, 0xffff0000, v92
    v_add_f32 v248, v248, v13
    v_mfma_f32_32x32x16_bf16 v[144:159], v[196:199], v[48:51], v[144:159]
    s_waitcnt lgkmcnt(9)
    v_add_f32 v249, v249, v13
    v_cvt_pk_bf16_f32 v92, v248, v249
    v_lshlrev_b32 v250, 16, v93
    v_and_b32 v251, 0xffff0000, v93
    v_add_f32 v250, v250, v13
    v_add_f32 v251, v251, v13
    v_cvt_pk_bf16_f32 v93, v250, v251
    v_mfma_f32_32x32x16_bf16 v[128:143], v[200:203], v[52:55], v[128:143]
    ds_read_b64_tr_b16 v[192:193], v5 offset:24576
    ds_read_b64_tr_b16 v[194:195], v5 offset:25088
    ds_read_b64_tr_b16 v[196:197], v6 offset:24576
    ds_read_b64_tr_b16 v[198:199], v6 offset:25088
    v_lshlrev_b32 v252, 16, v94
    v_and_b32 v253, 0xffff0000, v94
    v_add_f32 v252, v252, v13
    v_mfma_f32_32x32x16_bf16 v[144:159], v[204:207], v[52:55], v[144:159]
    s_waitcnt lgkmcnt(9)
    v_add_f32 v253, v253, v13
    v_cvt_pk_bf16_f32 v94, v252, v253
    v_lshlrev_b32 v254, 16, v95
    v_and_b32 v255, 0xffff0000, v95
    v_add_f32 v254, v254, v13
    v_add_f32 v255, v255, v13
    v_cvt_pk_bf16_f32 v95, v254, v255
    v_mfma_f32_32x32x16_bf16 v[128:143], v[208:211], v[56:59], v[128:143]
    ds_read_b64_tr_b16 v[200:201], v5 offset:26624
    ds_read_b64_tr_b16 v[202:203], v5 offset:27136
    ds_read_b64_tr_b16 v[204:205], v6 offset:26624
    ds_read_b64_tr_b16 v[206:207], v6 offset:27136
    ds_write_b32 v0, v0 offset:16
    v_lshlrev_b32 v248, 16, v96
    v_and_b32 v249, 0xffff0000, v96
    v_add_f32 v248, v248, v13
    v_add_f32 v249, v249, v13
    v_cvt_pk_bf16_f32 v96, v248, v249
    v_mfma_f32_32x32x16_bf16 v[144:159], v[212:215], v[56:59], v[144:159]
    s_waitcnt lgkmcnt(10)
    v_lshlrev_b32 v250, 16, v97
    v_and_b32 v251, 0xffff0000, v97
    v_add_f32 v250, v250, v13
    v_add_f32 v251, v251, v13
    v_cvt_pk_bf16_f32 v97, v250, v251
    s_waitcnt lgkmcnt(9)
    v_readfirstlane_b32 s58, v12
    s_nop 0
    s_cmp_ge_u32 s58, 4
    s_cbranch_scc0 L_ck6
L_ck5:
    v_add_u32 v5, 143360, v3
    v_add_u32 v6, 143360, v4
    v_mfma_f32_32x32x16_bf16 v[128:143], v[216:219], v[60:63], v[128:143]
    ds_read_b64_tr_b16 v[208:209], v5 offset:0
    ds_read_b64_tr_b16 v[210:211], v5 offset:512
    ds_read_b64_tr_b16 v[212:213], v6 offset:0
    ds_read_b64_tr_b16 v[214:215], v6 offset:512
    v_lshlrev_b32 v252, 16, v98
    v_and_b32 v253, 0xffff0000, v98
    v_add_f32 v252, v252, v13
    v_mfma_f32_32x32x16_bf16 v[144:159], v[220:223], v[60:63], v[144:159]
    s_waitcnt lgkmcnt(9)
    v_add_f32 v253, v253, v13
    v_cvt_pk_bf16_f32 v98, v252, v253
    v_lshlrev_b32 v254, 16, v99
    v_and_b32 v255, 0xffff0000, v99
    v_add_f32 v254, v254, v13
    v_add_f32 v255, v255, v13
    v_cvt_pk_bf16_f32 v99, v254, v255
    v_mfma_f32_32x32x16_bf16 v[128:143], v[192:195], v[64:67], v[128:143]
    ds_read_b64_tr_b16 v[216:217], v5 offset:2048
    ds_read_b64_tr_b16 v[218:219], v5 offset:2560
    ds_read_b64_tr_b16 v[220:221], v6 offset:2048
    ds_read_b64_tr_b16 v[222:223], v6 offset:2560
    v_lshlrev_b32 v248, 16, v100
    v_and_b32 v249, 0xffff0000, v100
    v_add_f32 v248, v248, v13
    v_mfma_f32_32x32x16_bf16 v[144:159], v[196:199], v[64:67], v[144:159]
    s_waitcnt lgkmcnt(9)
    v_add_f32 v249, v249, v13
    v_cvt_pk_bf16_f32 v100, v248, v249
    v_lshlrev_b32 v250, 16, v101
    v_and_b32 v251, 0xffff0000, v101
    v_add_f32 v250, v250, v13
    v_add_f32 v251, v251, v13
    v_cvt_pk_bf16_f32 v101, v250, v251
    v_mfma_f32_32x32x16_bf16 v[128:143], v[200:203], v[68:71], v[128:143]
    ds_read_b64_tr_b16 v[192:193], v5 offset:4096
    ds_read_b64_tr_b16 v[194:195], v5 offset:4608
    ds_read_b64_tr_b16 v[196:197], v6 offset:4096
    ds_read_b64_tr_b16 v[198:199], v6 offset:4608
    v_lshlrev_b32 v252, 16, v102
    v_and_b32 v253, 0xffff0000, v102
    v_add_f32 v252, v252, v13
    v_mfma_f32_32x32x16_bf16 v[144:159], v[204:207], v[68:71], v[144:159]
    s_waitcnt lgkmcnt(8)
    v_add_f32 v253, v253, v13
    v_cvt_pk_bf16_f32 v102, v252, v253
    v_lshlrev_b32 v254, 16, v103
    v_and_b32 v255, 0xffff0000, v103
    v_add_f32 v254, v254, v13
    v_add_f32 v255, v255, v13
    v_cvt_pk_bf16_f32 v103, v254, v255
    v_mfma_f32_32x32x16_bf16 v[128:143], v[208:211], v[72:75], v[128:143]
    ds_read_b64_tr_b16 v[200:201], v5 offset:6144
    ds_read_b64_tr_b16 v[202:203], v5 offset:6656
    ds_read_b64_tr_b16 v[204:205], v6 offset:6144
    ds_read_b64_tr_b16 v[206:207], v6 offset:6656
    v_lshlrev_b32 v248, 16, v104
    v_and_b32 v249, 0xffff0000, v104
    v_add_f32 v248, v248, v13
    v_mfma_f32_32x32x16_bf16 v[144:159], v[212:215], v[72:75], v[144:159]
    s_waitcnt lgkmcnt(8)
    v_add_f32 v249, v249, v13
    v_cvt_pk_bf16_f32 v104, v248, v249
    v_lshlrev_b32 v250, 16, v105
    v_and_b32 v251, 0xffff0000, v105
    v_add_f32 v250, v250, v13
    v_add_f32 v251, v251, v13
    v_cvt_pk_bf16_f32 v105, v250, v251
    v_mfma_f32_32x32x16_bf16 v[128:143], v[216:219], v[76:79], v[128:143]
    ds_read_b64_tr_b16 v[208:209], v5 offset:8192
    ds_read_b64_tr_b16 v[210:211], v5 offset:8704
    ds_read_b64_tr_b16 v[212:213], v6 offset:8192
    ds_read_b64_tr_b16 v[214:215], v6 offset:8704
    v_lshlrev_b32 v252, 16, v106
    v_and_b32 v253, 0xffff0000, v106
    v_add_f32 v252, v252, v13
    v_mfma_f32_32x32x16_bf16 v[144:159], v[220:223], v[76:79], v[144:159]
    s_waitcnt lgkmcnt(8)
    v_add_f32 v253, v253, v13
    v_cvt_pk_bf16_f32 v106, v252, v253
    v_lshlrev_b32 v254, 16, v107
    v_and_b32 v255, 0xffff0000, v107
    v_add_f32 v254, v254, v13
    v_add_f32 v255, v255, v13
    v_cvt_pk_bf16_f32 v107, v254, v255
    v_mfma_f32_32x32x16_bf16 v[128:143], v[192:195], v[80:83], v[128:143]
    ds_read_b64_tr_b16 v[216:217], v5 offset:10240
    ds_read_b64_tr_b16 v[218:219], v5 offset:10752
    ds_read_b64_tr_b16 v[220:221], v6 offset:10240
    ds_read_b64_tr_b16 v[222:223], v6 offset:10752
    ds_read_b32 v12, v0 offset:352
    v_lshlrev_b32 v248, 16, v108
    v_and_b32 v249, 0xffff0000, v108
    v_add_f32 v248, v248, v13
    v_mfma_f32_32x32x16_bf16 v[144:159], v[196:199], v[80:83], v[144:159]
    s_waitcnt lgkmcnt(9)
    v_add_f32 v249, v249, v13
    v_cvt_pk_bf16_f32 v108, v248, v249
    v_lshlrev_b32 v250, 16, v109
    v_and_b32 v251, 0xffff0000, v109
    v_add_f32 v250, v250, v13
    v_add_f32 v251, v251, v13
    v_cvt_pk_bf16_f32 v109, v250, v251
    v_mfma_f32_32x32x16_bf16 v[128:143], v[200:203], v[84:87], v[128:143]
    ds_read_b64_tr_b16 v[192:193], v5 offset:12288
    ds_read_b64_tr_b16 v[194:195], v5 offset:12800
    ds_read_b64_tr_b16 v[196:197], v6 offset:12288
    ds_read_b64_tr_b16 v[198:199], v6 offset:12800
    v_lshlrev_b32 v252, 16, v110
    v_and_b32 v253, 0xffff0000, v110
    v_add_f32 v252, v252, v13
    v_mfma_f32_32x32x16_bf16 v[144:159], v[204:207], v[84:87], v[144:159]
    s_waitcnt lgkmcnt(9)
    v_add_f32 v253, v253, v13
    v_cvt_pk_bf16_f32 v110, v252, v253
    v_lshlrev_b32 v254, 16, v111
    v_and_b32 v255, 0xffff0000, v111
    v_add_f32 v254, v254, v13
    v_add_f32 v255, v255, v13
    v_cvt_pk_bf16_f32 v111, v254, v255
    v_mfma_f32_32x32x16_bf16 v[128:143], v[208:211], v[88:91], v[128:143]
    ds_read_b64_tr_b16 v[200:201], v5 offset:14336
    ds_read_b64_tr_b16 v[202:203], v5 offset:14848
    ds_read_b64_tr_b16 v[204:205], v6 offset:14336
    ds_read_b64_tr_b16 v[206:207], v6 offset:14848
    v_lshlrev_b32 v248, 16, v112
    v_and_b32 v249, 0xffff0000, v112
    v_add_f32 v248, v248, v13
    v_add_f32 v249, v249, v13
    v_cvt_pk_bf16_f32 v112, v248, v249
    v_mfma_f32_32x32x16_bf16 v[144:159], v[212:215], v[88:91], v[144:159]
    s_waitcnt lgkmcnt(9)
    v_lshlrev_b32 v250, 16, v113
    v_and_b32 v251, 0xffff0000, v113
    v_add_f32 v250, v250, v13
    v_add_f32 v251, v251, v13
    v_cvt_pk_bf16_f32 v113, v250, v251
    s_waitcnt lgkmcnt(8)
    v_readfirstlane_b32 s58, v12
    s_nop 0
    s_cmp_ge_u32 s58, 4
    s_cbranch_scc0 L_ck12
L_ck11:
    v_add_u32 v5, 0, v3
    v_add_u32 v6, 0, v4
    v_mfma_f32_32x32x16_bf16 v[128:143], v[216:219], v[92:95], v[128:143]
    ds_read_b64_tr_b16 v[208:209], v5 offset:0
    ds_read_b64_tr_b16 v[210:211], v5 offset:512
    ds_read_b64_tr_b16 v[212:213], v6 offset:0
    ds_read_b64_tr_b16 v[214:215], v6 offset:512
    v_lshlrev_b32 v252, 16, v114
    v_and_b32 v253, 0xffff0000, v114
    v_add_f32 v252, v252, v13
    v_mfma_f32_32x32x16_bf16 v[144:159], v[220:223], v[92:95], v[144:159]
    s_waitcnt lgkmcnt(8)
    v_add_f32 v253, v253, v13
    v_cvt_pk_bf16_f32 v114, v252, v253
    v_lshlrev_b32 v254, 16, v115
    v_and_b32 v255, 0xffff0000, v115
    v_add_f32 v254, v254, v13
    v_add_f32 v255, v255, v13
    v_cvt_pk_bf16_f32 v115, v254, v255
    v_mfma_f32_32x32x16_bf16 v[128:143], v[192:195], v[96:99], v[128:143]
    ds_read_b64_tr_b16 v[216:217], v5 offset:2048
    ds_read_b64_tr_b16 v[218:219], v5 offset:2560
    ds_read_b64_tr_b16 v[220:221], v6 offset:2048
    ds_read_b64_tr_b16 v[222:223], v6 offset:2560
    v_lshlrev_b32 v248, 16, v116
    v_and_b32 v249, 0xffff0000, v116
    v_add_f32 v248, v248, v13
    v_mfma_f32_32x32x16_bf16 v[144:159], v[196:199], v[96:99], v[144:159]
    s_waitcnt lgkmcnt(8)
    v_add_f32 v249, v249, v13
    v_cvt_pk_bf16_f32 v116, v248, v249
    v_lshlrev_b32 v250, 16, v117
    v_and_b32 v251, 0xffff0000, v117
    v_add_f32 v250, v250, v13
    v_add_f32 v251, v251, v13
    v_cvt_pk_bf16_f32 v117, v250, v251
    v_mfma_f32_32x32x16_bf16 v[128:143], v[200:203], v[100:103], v[128:143]
    ds_read_b64_tr_b16 v[192:193], v5 offset:4096
    ds_read_b64_tr_b16 v[194:195], v5 offset:4608
    ds_read_b64_tr_b16 v[196:197], v6 offset:4096
    ds_read_b64_tr_b16 v[198:199], v6 offset:4608
    v_lshlrev_b32 v252, 16, v118
    v_and_b32 v253, 0xffff0000, v118
    v_add_f32 v252, v252, v13
    v_mfma_f32_32x32x16_bf16 v[144:159], v[204:207], v[100:103], v[144:159]
    s_waitcnt lgkmcnt(8)
    v_add_f32 v253, v253, v13
    v_cvt_pk_bf16_f32 v118, v252, v253
    v_lshlrev_b32 v254, 16, v119
    v_and_b32 v255, 0xffff0000, v119
    v_add_f32 v254, v254, v13
    v_add_f32 v255, v255, v13
    v_cvt_pk_bf16_f32 v119, v254, v255
    v_mfma_f32_32x32x16_bf16 v[128:143], v[208:211], v[104:107], v[128:143]
    ds_read_b64_tr_b16 v[200:201], v5 offset:6144
    ds_read_b64_tr_b16 v[202:203], v5 offset:6656
    ds_read_b64_tr_b16 v[204:205], v6 offset:6144
    ds_read_b64_tr_b16 v[206:207], v6 offset:6656
    ds_read_b32 v12, v0 offset:160
    v_lshlrev_b32 v248, 16, v120
    v_and_b32 v249, 0xffff0000, v120
    v_add_f32 v248, v248, v13
    v_mfma_f32_32x32x16_bf16 v[144:159], v[212:215], v[104:107], v[144:159]
    s_waitcnt lgkmcnt(9)
    v_add_f32 v249, v249, v13
    v_cvt_pk_bf16_f32 v120, v248, v249
    v_lshlrev_b32 v250, 16, v121
    v_and_b32 v251, 0xffff0000, v121
    v_add_f32 v250, v250, v13
    v_add_f32 v251, v251, v13
    v_cvt_pk_bf16_f32 v121, v250, v251
    v_mfma_f32_32x32x16_bf16 v[128:143], v[216:219], v[108:111], v[128:143]
    ds_read_b64_tr_b16 v[208:209], v5 offset:8192
    ds_read_b64_tr_b16 v[210:211], v5 offset:8704
    ds_read_b64_tr_b16 v[212:213], v6 offset:8192
    ds_read_b64_tr_b16 v[214:215], v6 offset:8704
    v_lshlrev_b32 v252, 16, v122
    v_and_b32 v253, 0xffff0000, v122
    v_add_f32 v252, v252, v13
    v_mfma_f32_32x32x16_bf16 v[144:159], v[220:223], v[108:111], v[144:159]
    s_waitcnt lgkmcnt(9)
    v_add_f32 v253, v253, v13
    v_cvt_pk_bf16_f32 v122, v252, v253
    v_lshlrev_b32 v254, 16, v123
    v_and_b32 v255, 0xffff0000, v123
    v_add_f32 v254, v254, v13
    v_add_f32 v255, v255, v13
    v_cvt_pk_bf16_f32 v123, v254, v255
    v_mfma_f32_32x32x16_bf16 v[128:143], v[192:195], v[112:115], v[128:143]
    ds_read_b64_tr_b16 v[216:217], v5 offset:10240
    ds_read_b64_tr_b16 v[218:219], v5 offset:10752
    ds_read_b64_tr_b16 v[220:221], v6 offset:10240
    ds_read_b64_tr_b16 v[222:223], v6 offset:10752
    ds_write_b32 v0, v0 offset:32
    v_lshlrev_b32 v248, 16, v124
    v_and_b32 v249, 0xffff0000, v124
    v_add_f32 v248, v248, v13
    v_add_f32 v249, v249, v13
    v_cvt_pk_bf16_f32 v124, v248, v249
    v_mfma_f32_32x32x16_bf16 v[144:159], v[196:199], v[112:115], v[144:159]
    s_waitcnt lgkmcnt(10)
    v_lshlrev_b32 v250, 16, v125
    v_and_b32 v251, 0xffff0000, v125
    v_add_f32 v250, v250, v13
    v_add_f32 v251, v251, v13
    v_cvt_pk_bf16_f32 v125, v250, v251
    s_waitcnt lgkmcnt(9)
    v_readfirstlane_b32 s58, v12
    s_nop 0
    s_cmp_ge_u32 s58, 4
    s_cbranch_scc0 L_ck18
L_ck17:
    v_add_u32 v5, 28672, v3
    v_add_u32 v6, 28672, v4
    v_mfma_f32_32x32x16_bf16 v[128:143], v[200:203], v[116:119], v[128:143]
    ds_read_b64_tr_b16 v[192:193], v5 offset:0
    ds_read_b64_tr_b16 v[194:195], v5 offset:512
    ds_read_b64_tr_b16 v[196:197], v6 offset:0
    ds_read_b64_tr_b16 v[198:199], v6 offset:512
    v_lshlrev_b32 v252, 16, v126
    v_and_b32 v253, 0xffff0000, v126
    v_add_f32 v252, v252, v13
    v_mfma_f32_32x32x16_bf16 v[144:159], v[204:207], v[116:119], v[144:159]
    s_waitcnt lgkmcnt(9)
    v_add_f32 v253, v253, v13
    v_cvt_pk_bf16_f32 v126, v252, v253
    v_lshlrev_b32 v254, 16, v127
    v_and_b32 v255, 0xffff0000, v127
    v_add_f32 v254, v254, v13
    v_add_f32 v255, v255, v13
    v_cvt_pk_bf16_f32 v127, v254, v255
    v_mfma_f32_32x32x16_bf16 v[128:143], v[208:211], v[120:123], v[128:143]
    ds_read_b64_tr_b16 v[200:201], v5 offset:2048
    ds_read_b64_tr_b16 v[202:203], v5 offset:2560
    ds_read_b64_tr_b16 v[204:205], v6 offset:2048
    ds_read_b64_tr_b16 v[206:207], v6 offset:2560
    v_and_b32 v226, 0xffff0000, v229
    v_add_f32 v226, 0x3727c5ac, v226
    v_cvt_pk_bf16_f32 v229, v226, v226
    v_and_b32 v226, 0xffff0000, v229
    v_mfma_f32_32x32x16_bf16 v[144:159], v[212:215], v[120:123], v[144:159]
    s_waitcnt lgkmcnt(9)
    v_sqrt_f32 v226, v226
    v_nop
    v_cvt_pk_bf16_f32 v229, v226, v226
    v_and_b32 v11, 0xffff0000, v229
    v_rcp_f32 v8, v11
    v_nop
    v_mul_f32 v10, 0xbfb8aa3b, v8
    v_cndmask_b32 v9, v8, 0, s[54:55]
    v_mfma_f32_32x32x16_bf16 v[128:143], v[216:219], v[124:127], v[128:143]
    ds_read_b64_tr_b16 v[208:209], v5 offset:4096
    ds_read_b64_tr_b16 v[210:211], v5 offset:4608
    ds_read_b64_tr_b16 v[212:213], v6 offset:4096
    ds_read_b64_tr_b16 v[214:215], v6 offset:4608
    v_mfma_f32_32x32x16_bf16 v[144:159], v[220:223], v[124:127], v[144:159]
    s_waitcnt lgkmcnt(8)
    s_cmp_ge_u32 s7, 8
    s_cbranch_scc1 L_cattn
    v_mfma_f32_32x32x16_bf16 v[160:175], v[192:195], v[16:19], 0
    ds_read_b64_tr_b16 v[216:217], v5 offset:6144
    ds_read_b64_tr_b16 v[218:219], v5 offset:6656
    ds_read_b64_tr_b16 v[220:221], v6 offset:6144
    ds_read_b64_tr_b16 v[222:223], v6 offset:6656
    v_mfma_f32_32x32x16_bf16 v[176:191], v[196:199], v[16:19], 0
    s_waitcnt lgkmcnt(8)
    v_mfma_f32_32x32x16_bf16 v[160:175], v[200:203], v[20:23], v[160:175]
    ds_read_b64_tr_b16 v[192:193], v5 offset:8192
    ds_read_b64_tr_b16 v[194:195], v5 offset:8704
    ds_read_b64_tr_b16 v[196:197], v6 offset:8192
    ds_read_b64_tr_b16 v[198:199], v6 offset:8704
    v_lshrrev_b32 v240, 5, v1
    v_lshlrev_b32 v240, 3, v240
    v_bfe_u32 v7, v1, 2, 2
    v_mfma_f32_32x32x16_bf16 v[176:191], v[204:207], v[20:23], v[176:191]
    s_waitcnt lgkmcnt(8)
    v_add_u32 v240, v240, v7
    v_mul_u32_u24 v7, 64, v240
    v_bfe_u32 v240, v1, 4, 1
    v_lshl_add_u32 v7, v240, 5, v7
    v_and_b32 v240, 3, v1
    v_lshl_add_u32 v7, v240, 3, v7
    s_lshl_b32 s50, s6, 2
    v_mfma_f32_32x32x16_bf16 v[160:175], v[208:211], v[24:27], v[160:175]
    ds_read_b64_tr_b16 v[200:201], v5 offset:10240
    ds_read_b64_tr_b16 v[202:203], v5 offset:10752
    ds_read_b64_tr_b16 v[204:205], v6 offset:10240
    ds_read_b64_tr_b16 v[206:207], v6 offset:10752
    s_add_u32 s50, s50, s3
    s_mul_i32 s50, s50, 114688
    s_add_u32 s50, s50, 0
    v_mfma_f32_32x32x16_bf16 v[176:191], v[212:215], v[24:27], v[176:191]
    s_waitcnt lgkmcnt(8)
    s_mul_i32 s51, s42, 7
    s_and_b32 s52, s42, 1
    s_add_u32 s53, s51, s52
    s_lshl_b32 s53, s53, 11
    s_add_u32 s60, s50, s53
    s_mul_i32 s52, s52, 6
    s_sub_u32 s51, s51, s52
    s_add_u32 s51, s51, 6
    v_mfma_f32_32x32x16_bf16 v[160:175], v[216:219], v[28:31], v[160:175]
    ds_read_b64_tr_b16 v[208:209], v5 offset:12288
    ds_read_b64_tr_b16 v[210:211], v5 offset:12800
    ds_read_b64_tr_b16 v[212:213], v6 offset:12288
    ds_read_b64_tr_b16 v[214:215], v6 offset:12800
    s_lshl_b32 s51, s51, 11
    s_add_u32 s61, s50, s51
    v_mfma_f32_32x32x16_bf16 v[176:191], v[220:223], v[28:31], v[176:191]
    s_waitcnt lgkmcnt(8)
    s_add_u32 s50, s60, 0
    v_mul_f32 v248, v128, v10
    v_mul_f32 v249, v129, v10
    v_mul_f32 v250, v130, v10
    v_mul_f32 v251, v131, v10
    v_exp_f32 v248, v248
    v_mfma_f32_32x32x16_bf16 v[160:175], v[192:195], v[32:35], v[160:175]
    ds_read_b64_tr_b16 v[216:217], v5 offset:14336
    ds_read_b64_tr_b16 v[218:219], v5 offset:14848
    ds_read_b64_tr_b16 v[220:221], v6 offset:14336
    ds_read_b64_tr_b16 v[222:223], v6 offset:14848
    v_exp_f32 v249, v249
    v_exp_f32 v250, v250
    v_mfma_f32_32x32x16_bf16 v[176:191], v[196:199], v[32:35], v[176:191]
    s_waitcnt lgkmcnt(8)
    v_exp_f32 v251, v251
    v_fma_f32 v248, v248, v11, v11
    v_fma_f32 v249, v249, v11, v11
    v_fma_f32 v250, v250, v11, v11
    v_fma_f32 v251, v251, v11, v11
    v_rcp_f32 v248, v248
    v_mfma_f32_32x32x16_bf16 v[160:175], v[200:203], v[36:39], v[160:175]
    ds_read_b64_tr_b16 v[192:193], v5 offset:16384
    ds_read_b64_tr_b16 v[194:195], v5 offset:16896
    ds_read_b64_tr_b16 v[196:197], v6 offset:16384
    ds_read_b64_tr_b16 v[198:199], v6 offset:16896
    v_rcp_f32 v249, v249
    v_mfma_f32_32x32x16_bf16 v[176:191], v[204:207], v[36:39], v[176:191]
    s_waitcnt lgkmcnt(8)
    v_rcp_f32 v250, v250
    v_rcp_f32 v251, v251
    v_mul_f32 v252, v128, v248
    v_mul_f32 v253, v129, v249
    v_mul_f32 v254, v130, v250
    v_mfma_f32_32x32x16_bf16 v[160:175], v[208:211], v[40:43], v[160:175]
    ds_read_b64_tr_b16 v[200:201], v5 offset:18432
    ds_read_b64_tr_b16 v[202:203], v5 offset:18944
    ds_read_b64_tr_b16 v[204:205], v6 offset:18432
    ds_read_b64_tr_b16 v[206:207], v6 offset:18944
    v_mul_f32 v255, v131, v251
    v_cvt_pk_bf16_f32 v240, v252, v253
    v_cvt_pk_bf16_f32 v241, v254, v255
    v_mfma_f32_32x32x16_bf16 v[176:191], v[212:215], v[40:43], v[176:191]
    s_waitcnt lgkmcnt(8)
    v_mul_f32 v248, v132, v10
    v_mul_f32 v249, v133, v10
    v_mul_f32 v250, v134, v10
    v_mul_f32 v251, v135, v10
    v_exp_f32 v248, v248
    v_exp_f32 v249, v249
    v_mfma_f32_32x32x16_bf16 v[160:175], v[216:219], v[44:47], v[160:175]
    ds_read_b64_tr_b16 v[208:209], v5 offset:20480
    ds_read_b64_tr_b16 v[210:211], v5 offset:20992
    ds_read_b64_tr_b16 v[212:213], v6 offset:20480
    ds_read_b64_tr_b16 v[214:215], v6 offset:20992
    v_exp_f32 v250, v250
    v_mfma_f32_32x32x16_bf16 v[176:191], v[220:223], v[44:47], v[176:191]
    s_waitcnt lgkmcnt(8)
    v_exp_f32 v251, v251
    v_fma_f32 v248, v248, v11, v11
    v_fma_f32 v249, v249, v11, v11
    v_fma_f32 v250, v250, v11, v11
    v_fma_f32 v251, v251, v11, v11
    v_rcp_f32 v248, v248
    v_mfma_f32_32x32x16_bf16 v[160:175], v[192:195], v[48:51], v[160:175]
    ds_read_b64_tr_b16 v[216:217], v5 offset:22528
    ds_read_b64_tr_b16 v[218:219], v5 offset:23040
    ds_read_b64_tr_b16 v[220:221], v6 offset:22528
    ds_read_b64_tr_b16 v[222:223], v6 offset:23040
    ds_read_b32 v12, v0 offset:176
    v_rcp_f32 v249, v249
    v_mfma_f32_32x32x16_bf16 v[176:191], v[196:199], v[48:51], v[176:191]
    s_waitcnt lgkmcnt(9)
    v_rcp_f32 v250, v250
    v_rcp_f32 v251, v251
    v_mul_f32 v252, v132, v248
    v_mul_f32 v253, v133, v249
    v_mul_f32 v254, v134, v250
    v_mul_f32 v255, v135, v251
    v_mfma_f32_32x32x16_bf16 v[160:175], v[200:203], v[52:55], v[160:175]
    ds_read_b64_tr_b16 v[192:193], v5 offset:24576
    ds_read_b64_tr_b16 v[194:195], v5 offset:25088
    ds_read_b64_tr_b16 v[196:197], v6 offset:24576
    ds_read_b64_tr_b16 v[198:199], v6 offset:25088
    v_cvt_pk_bf16_f32 v242, v252, v253
    v_cvt_pk_bf16_f32 v243, v254, v255
    buffer_store_dwordx4 v[240:243], v2, s[16:19], s50 offen offset:0 sc1
    v_mfma_f32_32x32x16_bf16 v[176:191], v[204:207], v[52:55], v[176:191]
    s_waitcnt lgkmcnt(9)
    v_mul_f32 v248, v136, v10
    v_mul_f32 v249, v137, v10
    v_mul_f32 v250, v138, v10
    v_mul_f32 v251, v139, v10
    v_exp_f32 v248, v248
    v_exp_f32 v249, v249
    v_mfma_f32_32x32x16_bf16 v[160:175], v[208:211], v[56:59], v[160:175]
    ds_read_b64_tr_b16 v[200:201], v5 offset:26624
    ds_read_b64_tr_b16 v[202:203], v5 offset:27136
    ds_read_b64_tr_b16 v[204:205], v6 offset:26624
    ds_read_b64_tr_b16 v[206:207], v6 offset:27136
    ds_write_b32 v0, v0 offset:48
    v_exp_f32 v250, v250
    v_mfma_f32_32x32x16_bf16 v[176:191], v[212:215], v[56:59], v[176:191]
    s_waitcnt lgkmcnt(10)
    v_exp_f32 v251, v251
    v_fma_f32 v248, v248, v11, v11
    s_waitcnt lgkmcnt(9)
    v_readfirstlane_b32 s58, v12
    s_nop 0
    s_cmp_ge_u32 s58, 4
    s_cbranch_scc0 L_ck24
L_ck23:
    v_add_u32 v5, 57344, v3
    v_add_u32 v6, 57344, v4
    v_mfma_f32_32x32x16_bf16 v[160:175], v[216:219], v[60:63], v[160:175]
    ds_read_b64_tr_b16 v[208:209], v5 offset:0
    ds_read_b64_tr_b16 v[210:211], v5 offset:512
    ds_read_b64_tr_b16 v[212:213], v6 offset:0
    ds_read_b64_tr_b16 v[214:215], v6 offset:512
    v_fma_f32 v249, v249, v11, v11
    v_fma_f32 v250, v250, v11, v11
    v_fma_f32 v251, v251, v11, v11
    v_mfma_f32_32x32x16_bf16 v[176:191], v[220:223], v[60:63], v[176:191]
    s_waitcnt lgkmcnt(9)
    v_rcp_f32 v248, v248
    v_rcp_f32 v249, v249
    v_rcp_f32 v250, v250
    v_rcp_f32 v251, v251
    v_mfma_f32_32x32x16_bf16 v[160:175], v[192:195], v[64:67], v[160:175]
    ds_read_b64_tr_b16 v[216:217], v5 offset:2048
    ds_read_b64_tr_b16 v[218:219], v5 offset:2560
    ds_read_b64_tr_b16 v[220:221], v6 offset:2048
    ds_read_b64_tr_b16 v[222:223], v6 offset:2560
    v_mul_f32 v252, v136, v248
    v_mul_f32 v253, v137, v249
    v_mfma_f32_32x32x16_bf16 v[176:191], v[196:199], v[64:67], v[176:191]
    s_waitcnt lgkmcnt(9)
    v_mul_f32 v254, v138, v250
    v_mul_f32 v255, v139, v251
    v_cvt_pk_bf16_f32 v244, v252, v253
    v_cvt_pk_bf16_f32 v245, v254, v255
    v_mul_f32 v248, v140, v10
    v_mul_f32 v249, v141, v10
    v_mul_f32 v250, v142, v10
    v_mul_f32 v251, v143, v10
    v_mfma_f32_32x32x16_bf16 v[160:175], v[200:203], v[68:71], v[160:175]
    ds_read_b64_tr_b16 v[192:193], v5 offset:4096
    ds_read_b64_tr_b16 v[194:195], v5 offset:4608
    ds_read_b64_tr_b16 v[196:197], v6 offset:4096
    ds_read_b64_tr_b16 v[198:199], v6 offset:4608
    v_exp_f32 v248, v248
    v_mfma_f32_32x32x16_bf16 v[176:191], v[204:207], v[68:71], v[176:191]
    s_waitcnt lgkmcnt(8)
    v_exp_f32 v249, v249
    v_exp_f32 v250, v250
    v_exp_f32 v251, v251
    v_fma_f32 v248, v248, v11, v11
    v_fma_f32 v249, v249, v11, v11
    v_mfma_f32_32x32x16_bf16 v[160:175], v[208:211], v[72:75], v[160:175]
    ds_read_b64_tr_b16 v[200:201], v5 offset:6144
    ds_read_b64_tr_b16 v[202:203], v5 offset:6656
    ds_read_b64_tr_b16 v[204:205], v6 offset:6144
    ds_read_b64_tr_b16 v[206:207], v6 offset:6656
    v_fma_f32 v250, v250, v11, v11
    v_fma_f32 v251, v251, v11, v11
    v_mfma_f32_32x32x16_bf16 v[176:191], v[212:215], v[72:75], v[176:191]
    s_waitcnt lgkmcnt(8)
    v_rcp_f32 v248, v248
    v_rcp_f32 v249, v249
    v_rcp_f32 v250, v250
    v_rcp_f32 v251, v251
    v_mfma_f32_32x32x16_bf16 v[160:175], v[216:219], v[76:79], v[160:175]
    ds_read_b64_tr_b16 v[208:209], v5 offset:8192
    ds_read_b64_tr_b16 v[210:211], v5 offset:8704
    ds_read_b64_tr_b16 v[212:213], v6 offset:8192
    ds_read_b64_tr_b16 v[214:215], v6 offset:8704
    v_mul_f32 v252, v140, v248
    v_mul_f32 v253, v141, v249
    v_mul_f32 v254, v142, v250
    v_mfma_f32_32x32x16_bf16 v[176:191], v[220:223], v[76:79], v[176:191]
    s_waitcnt lgkmcnt(8)
    v_mul_f32 v255, v143, v251
    v_cvt_pk_bf16_f32 v246, v252, v253
    v_cvt_pk_bf16_f32 v247, v254, v255
    buffer_store_dwordx4 v[244:247], v2, s[16:19], s50 offen offset:1024 sc1
    v_mul_f32 v248, v144, v10
    v_mul_f32 v249, v145, v10
    v_mul_f32 v250, v146, v10
    v_mfma_f32_32x32x16_bf16 v[160:175], v[192:195], v[80:83], v[160:175]
    ds_read_b64_tr_b16 v[216:217], v5 offset:10240
    ds_read_b64_tr_b16 v[218:219], v5 offset:10752
    ds_read_b64_tr_b16 v[220:221], v6 offset:10240
    ds_read_b64_tr_b16 v[222:223], v6 offset:10752
    v_mul_f32 v251, v147, v10
    v_exp_f32 v248, v248
    v_mfma_f32_32x32x16_bf16 v[176:191], v[196:199], v[80:83], v[176:191]
    s_waitcnt lgkmcnt(8)
    v_exp_f32 v249, v249
    v_exp_f32 v250, v250
    v_exp_f32 v251, v251
    v_fma_f32 v248, v248, v11, v11
    v_fma_f32 v249, v249, v11, v11
    v_mfma_f32_32x32x16_bf16 v[160:175], v[200:203], v[84:87], v[160:175]
    ds_read_b64_tr_b16 v[192:193], v5 offset:12288
    ds_read_b64_tr_b16 v[194:195], v5 offset:12800
    ds_read_b64_tr_b16 v[196:197], v6 offset:12288
    ds_read_b64_tr_b16 v[198:199], v6 offset:12800
    v_fma_f32 v250, v250, v11, v11
    v_fma_f32 v251, v251, v11, v11
    v_mfma_f32_32x32x16_bf16 v[176:191], v[204:207], v[84:87], v[176:191]
    s_waitcnt lgkmcnt(8)
    v_rcp_f32 v248, v248
    v_rcp_f32 v249, v249
    v_rcp_f32 v250, v250
    v_rcp_f32 v251, v251
    v_mfma_f32_32x32x16_bf16 v[160:175], v[208:211], v[88:91], v[160:175]
    ds_read_b64_tr_b16 v[200:201], v5 offset:14336
    ds_read_b64_tr_b16 v[202:203], v5 offset:14848
    ds_read_b64_tr_b16 v[204:205], v6 offset:14336
    ds_read_b64_tr_b16 v[206:207], v6 offset:14848
    v_mul_f32 v252, v144, v248
    v_mul_f32 v253, v145, v249
    v_mul_f32 v254, v146, v250
    v_mfma_f32_32x32x16_bf16 v[176:191], v[212:215], v[88:91], v[176:191]
    s_waitcnt lgkmcnt(8)
    v_mul_f32 v255, v147, v251
    v_cvt_pk_bf16_f32 v224, v252, v253
    v_cvt_pk_bf16_f32 v225, v254, v255
    v_mul_f32 v248, v148, v10
    v_mul_f32 v249, v149, v10
    v_mul_f32 v250, v150, v10
    v_mul_f32 v251, v151, v10
    v_mfma_f32_32x32x16_bf16 v[160:175], v[216:219], v[92:95], v[160:175]
    ds_read_b64_tr_b16 v[208:209], v5 offset:16384
    ds_read_b64_tr_b16 v[210:211], v5 offset:16896
    ds_read_b64_tr_b16 v[212:213], v6 offset:16384
    ds_read_b64_tr_b16 v[214:215], v6 offset:16896
    v_exp_f32 v248, v248
    v_exp_f32 v249, v249
    v_mfma_f32_32x32x16_bf16 v[176:191], v[220:223], v[92:95], v[176:191]
    s_waitcnt lgkmcnt(8)
    v_exp_f32 v250, v250
    v_exp_f32 v251, v251
    v_fma_f32 v248, v248, v11, v11
    v_fma_f32 v249, v249, v11, v11
    v_mfma_f32_32x32x16_bf16 v[160:175], v[192:195], v[96:99], v[160:175]
    ds_read_b64_tr_b16 v[216:217], v5 offset:18432
    ds_read_b64_tr_b16 v[218:219], v5 offset:18944
    ds_read_b64_tr_b16 v[220:221], v6 offset:18432
    ds_read_b64_tr_b16 v[222:223], v6 offset:18944
    v_fma_f32 v250, v250, v11, v11
    v_fma_f32 v251, v251, v11, v11
    v_rcp_f32 v248, v248
    v_mfma_f32_32x32x16_bf16 v[176:191], v[196:199], v[96:99], v[176:191]
    s_waitcnt lgkmcnt(8)
    v_rcp_f32 v249, v249
    v_rcp_f32 v250, v250
    v_rcp_f32 v251, v251
    v_mul_f32 v252, v148, v248
    v_mfma_f32_32x32x16_bf16 v[160:175], v[200:203], v[100:103], v[160:175]
    ds_read_b64_tr_b16 v[192:193], v5 offset:20480
    ds_read_b64_tr_b16 v[194:195], v5 offset:20992
    ds_read_b64_tr_b16 v[196:197], v6 offset:20480
    ds_read_b64_tr_b16 v[198:199], v6 offset:20992
    v_mul_f32 v253, v149, v249
    v_mul_f32 v254, v150, v250
    v_mul_f32 v255, v151, v251
    v_mfma_f32_32x32x16_bf16 v[176:191], v[204:207], v[100:103], v[176:191]
    s_waitcnt lgkmcnt(8)
    v_cvt_pk_bf16_f32 v226, v252, v253
    v_cvt_pk_bf16_f32 v227, v254, v255
    buffer_store_dwordx4 v[224:227], v2, s[16:19], s50 offen offset:2048 sc1
    v_mul_f32 v248, v152, v10
    v_mul_f32 v249, v153, v10
    v_mul_f32 v250, v154, v10
    v_mul_f32 v251, v155, v10
    v_mfma_f32_32x32x16_bf16 v[160:175], v[208:211], v[104:107], v[160:175]
    ds_read_b64_tr_b16 v[200:201], v5 offset:22528
    ds_read_b64_tr_b16 v[202:203], v5 offset:23040
    ds_read_b64_tr_b16 v[204:205], v6 offset:22528
    ds_read_b64_tr_b16 v[206:207], v6 offset:23040
    ds_read_b32 v12, v0 offset:192
    v_exp_f32 v248, v248
    v_mfma_f32_32x32x16_bf16 v[176:191], v[212:215], v[104:107], v[176:191]
    s_waitcnt lgkmcnt(9)
    v_exp_f32 v249, v249
    v_exp_f32 v250, v250
    v_exp_f32 v251, v251
    v_fma_f32 v248, v248, v11, v11
    v_fma_f32 v249, v249, v11, v11
    v_mfma_f32_32x32x16_bf16 v[160:175], v[216:219], v[108:111], v[160:175]
    ds_read_b64_tr_b16 v[208:209], v5 offset:24576
    ds_read_b64_tr_b16 v[210:211], v5 offset:25088
    ds_read_b64_tr_b16 v[212:213], v6 offset:24576
    ds_read_b64_tr_b16 v[214:215], v6 offset:25088
    v_fma_f32 v250, v250, v11, v11
    v_fma_f32 v251, v251, v11, v11
    v_rcp_f32 v248, v248
    v_mfma_f32_32x32x16_bf16 v[176:191], v[220:223], v[108:111], v[176:191]
    s_waitcnt lgkmcnt(9)
    v_rcp_f32 v249, v249
    v_rcp_f32 v250, v250
    v_rcp_f32 v251, v251
    v_mfma_f32_32x32x16_bf16 v[160:175], v[192:195], v[112:115], v[160:175]
    ds_read_b64_tr_b16 v[216:217], v5 offset:26624
    ds_read_b64_tr_b16 v[218:219], v5 offset:27136
    ds_read_b64_tr_b16 v[220:221], v6 offset:26624
    ds_read_b64_tr_b16 v[222:223], v6 offset:27136
    ds_write_b32 v0, v0 offset:64
    v_mul_f32 v252, v152, v248
    v_mul_f32 v253, v153, v249
    v_mul_f32 v254, v154, v250
    v_mfma_f32_32x32x16_bf16 v[176:191], v[196:199], v[112:115], v[176:191]
    s_waitcnt lgkmcnt(10)
    v_mul_f32 v255, v155, v251
    v_cvt_pk_bf16_f32 v228, v252, v253
    v_cvt_pk_bf16_f32 v229, v254, v255
    s_waitcnt lgkmcnt(9)
    v_readfirstlane_b32 s58, v12
    s_nop 0
    s_cmp_ge_u32 s58, 4
    s_cbranch_scc0 L_ck30
L_ck29:
    v_add_u32 v5, 86016, v3
    v_add_u32 v6, 86016, v4
    v_mfma_f32_32x32x16_bf16 v[160:175], v[200:203], v[116:119], v[160:175]
    ds_read_b64_tr_b16 v[192:193], v5 offset:0
    ds_read_b64_tr_b16 v[194:195], v5 offset:512
    ds_read_b64_tr_b16 v[196:197], v6 offset:0
    ds_read_b64_tr_b16 v[198:199], v6 offset:512
    v_mul_f32 v248, v156, v10
    v_mul_f32 v249, v157, v10
    v_mul_f32 v250, v158, v10
    v_mfma_f32_32x32x16_bf16 v[176:191], v[204:207], v[116:119], v[176:191]
    s_waitcnt lgkmcnt(9)
    v_mul_f32 v251, v159, v10
    v_exp_f32 v248, v248
    v_exp_f32 v249, v249
    v_exp_f32 v250, v250
    v_mfma_f32_32x32x16_bf16 v[160:175], v[208:211], v[120:123], v[160:175]
    ds_read_b64_tr_b16 v[200:201], v5 offset:2048
    ds_read_b64_tr_b16 v[202:203], v5 offset:2560
    ds_read_b64_tr_b16 v[204:205], v6 offset:2048
    ds_read_b64_tr_b16 v[206:207], v6 offset:2560
    v_exp_f32 v251, v251
    v_fma_f32 v248, v248, v11, v11
    v_mfma_f32_32x32x16_bf16 v[176:191], v[212:215], v[120:123], v[176:191]
    s_waitcnt lgkmcnt(9)
    v_fma_f32 v249, v249, v11, v11
    v_fma_f32 v250, v250, v11, v11
    v_fma_f32 v251, v251, v11, v11
    v_rcp_f32 v248, v248
    v_rcp_f32 v249, v249
    v_mfma_f32_32x32x16_bf16 v[160:175], v[216:219], v[124:127], v[160:175]
    ds_read_b64_tr_b16 v[208:209], v5 offset:4096
    ds_read_b64_tr_b16 v[210:211], v5 offset:4608
    ds_read_b64_tr_b16 v[212:213], v6 offset:4096
    ds_read_b64_tr_b16 v[214:215], v6 offset:4608
    v_rcp_f32 v250, v250
    v_rcp_f32 v251, v251
    v_mfma_f32_32x32x16_bf16 v[176:191], v[220:223], v[124:127], v[176:191]
    s_waitcnt lgkmcnt(8)
    v_mul_f32 v252, v156, v248
    v_mul_f32 v253, v157, v249
    v_mul_f32 v254, v158, v250
    v_mul_f32 v255, v159, v251
    v_cvt_pk_bf16_f32 v230, v252, v253
    v_cvt_pk_bf16_f32 v231, v254, v255
    buffer_store_dwordx4 v[228:231], v2, s[16:19], s50 offen offset:3072 sc1
    v_mfma_f32_32x32x16_bf16 v[128:143], v[192:195], v[16:19], 0
    ds_read_b64_tr_b16 v[216:217], v5 offset:6144
    ds_read_b64_tr_b16 v[218:219], v5 offset:6656
    ds_read_b64_tr_b16 v[220:221], v6 offset:6144
    ds_read_b64_tr_b16 v[222:223], v6 offset:6656
    v_mfma_f32_32x32x16_bf16 v[144:159], v[196:199], v[16:19], 0
    s_waitcnt lgkmcnt(8)
    v_mfma_f32_32x32x16_bf16 v[128:143], v[200:203], v[20:23], v[128:143]
    ds_read_b64_tr_b16 v[192:193], v5 offset:8192
    ds_read_b64_tr_b16 v[194:195], v5 offset:8704
    ds_read_b64_tr_b16 v[196:197], v6 offset:8192
    ds_read_b64_tr_b16 v[198:199], v6 offset:8704
    s_add_u32 s50, s60, 4096
    v_mul_f32 v248, v160, v10
    v_mul_f32 v249, v161, v10
    v_mfma_f32_32x32x16_bf16 v[144:159], v[204:207], v[20:23], v[144:159]
    s_waitcnt lgkmcnt(8)
    v_mul_f32 v250, v162, v10
    v_mul_f32 v251, v163, v10
    v_exp_f32 v248, v248
    v_exp_f32 v249, v249
    v_mfma_f32_32x32x16_bf16 v[128:143], v[208:211], v[24:27], v[128:143]
    ds_read_b64_tr_b16 v[200:201], v5 offset:10240
    ds_read_b64_tr_b16 v[202:203], v5 offset:10752
    ds_read_b64_tr_b16 v[204:205], v6 offset:10240
    ds_read_b64_tr_b16 v[206:207], v6 offset:10752
    v_exp_f32 v250, v250
    v_exp_f32 v251, v251
    v_mfma_f32_32x32x16_bf16 v[144:159], v[212:215], v[24:27], v[144:159]
    s_waitcnt lgkmcnt(8)
    v_fma_f32 v248, v248, v11, v11
    v_fma_f32 v249, v249, v11, v11
    v_fma_f32 v250, v250, v11, v11
    v_fma_f32 v251, v251, v11, v11
    v_rcp_f32 v248, v248
    v_mfma_f32_32x32x16_bf16 v[128:143], v[216:219], v[28:31], v[128:143]
    ds_read_b64_tr_b16 v[208:209], v5 offset:12288
    ds_read_b64_tr_b16 v[210:211], v5 offset:12800
    ds_read_b64_tr_b16 v[212:213], v6 offset:12288
    ds_read_b64_tr_b16 v[214:215], v6 offset:12800
    v_rcp_f32 v249, v249
    v_mfma_f32_32x32x16_bf16 v[144:159], v[220:223], v[28:31], v[144:159]
    s_waitcnt lgkmcnt(8)
    v_rcp_f32 v250, v250
    v_rcp_f32 v251, v251
    v_mul_f32 v252, v160, v248
    v_mul_f32 v253, v161, v249
    v_mul_f32 v254, v162, v250
    v_mfma_f32_32x32x16_bf16 v[128:143], v[192:195], v[32:35], v[128:143]
    ds_read_b64_tr_b16 v[216:217], v5 offset:14336
    ds_read_b64_tr_b16 v[218:219], v5 offset:14848
    ds_read_b64_tr_b16 v[220:221], v6 offset:14336
    ds_read_b64_tr_b16 v[222:223], v6 offset:14848
    v_mul_f32 v255, v163, v251
    v_cvt_pk_bf16_f32 v240, v252, v253
    v_cvt_pk_bf16_f32 v241, v254, v255
    v_mfma_f32_32x32x16_bf16 v[144:159], v[196:199], v[32:35], v[144:159]
    s_waitcnt lgkmcnt(8)
    v_mul_f32 v248, v164, v10
    v_mul_f32 v249, v165, v10
    v_mul_f32 v250, v166, v10
    v_mul_f32 v251, v167, v10
    v_exp_f32 v248, v248
    v_mfma_f32_32x32x16_bf16 v[128:143], v[200:203], v[36:39], v[128:143]
    ds_read_b64_tr_b16 v[192:193], v5 offset:16384
    ds_read_b64_tr_b16 v[194:195], v5 offset:16896
    ds_read_b64_tr_b16 v[196:197], v6 offset:16384
    ds_read_b64_tr_b16 v[198:199], v6 offset:16896
    v_exp_f32 v249, v249
    v_exp_f32 v250, v250
    v_mfma_f32_32x32x16_bf16 v[144:159], v[204:207], v[36:39], v[144:159]
    s_waitcnt lgkmcnt(8)
    v_exp_f32 v251, v251
    v_fma_f32 v248, v248, v11, v11
    v_fma_f32 v249, v249, v11, v11
    v_fma_f32 v250, v250, v11, v11
    v_fma_f32 v251, v251, v11, v11
    v_mfma_f32_32x32x16_bf16 v[128:143], v[208:211], v[40:43], v[128:143]
    ds_read_b64_tr_b16 v[200:201], v5 offset:18432
    ds_read_b64_tr_b16 v[202:203], v5 offset:18944
    ds_read_b64_tr_b16 v[204:205], v6 offset:18432
    ds_read_b64_tr_b16 v[206:207], v6 offset:18944
    v_rcp_f32 v248, v248
    v_mfma_f32_32x32x16_bf16 v[144:159], v[212:215], v[40:43], v[144:159]
    s_waitcnt lgkmcnt(8)
    v_rcp_f32 v249, v249
    v_rcp_f32 v250, v250
    v_rcp_f32 v251, v251
    v_mul_f32 v252, v164, v248
    v_mfma_f32_32x32x16_bf16 v[128:143], v[216:219], v[44:47], v[128:143]
    ds_read_b64_tr_b16 v[208:209], v5 offset:20480
    ds_read_b64_tr_b16 v[210:211], v5 offset:20992
    ds_read_b64_tr_b16 v[212:213], v6 offset:20480
    ds_read_b64_tr_b16 v[214:215], v6 offset:20992
    v_mul_f32 v253, v165, v249
    v_mul_f32 v254, v166, v250
    v_mul_f32 v255, v167, v251
    v_mfma_f32_32x32x16_bf16 v[144:159], v[220:223], v[44:47], v[144:159]
    s_waitcnt lgkmcnt(8)
    v_cvt_pk_bf16_f32 v242, v252, v253
    v_cvt_pk_bf16_f32 v243, v254, v255
    buffer_store_dwordx4 v[240:243], v2, s[16:19], s50 offen offset:0 sc1
    v_mul_f32 v248, v168, v10
    v_mul_f32 v249, v169, v10
    v_mul_f32 v250, v170, v10
    v_mul_f32 v251, v171, v10
    v_mfma_f32_32x32x16_bf16 v[128:143], v[192:195], v[48:51], v[128:143]
    ds_read_b64_tr_b16 v[216:217], v5 offset:22528
    ds_read_b64_tr_b16 v[218:219], v5 offset:23040
    ds_read_b64_tr_b16 v[220:221], v6 offset:22528
    ds_read_b64_tr_b16 v[222:223], v6 offset:23040
    ds_read_b32 v12, v0 offset:208
    v_exp_f32 v248, v248
    v_mfma_f32_32x32x16_bf16 v[144:159], v[196:199], v[48:51], v[144:159]
    s_waitcnt lgkmcnt(9)
    v_exp_f32 v249, v249
    v_exp_f32 v250, v250
    v_exp_f32 v251, v251
    v_fma_f32 v248, v248, v11, v11
    v_mfma_f32_32x32x16_bf16 v[128:143], v[200:203], v[52:55], v[128:143]
    ds_read_b64_tr_b16 v[192:193], v5 offset:24576
    ds_read_b64_tr_b16 v[194:195], v5 offset:25088
    ds_read_b64_tr_b16 v[196:197], v6 offset:24576
    ds_read_b64_tr_b16 v[198:199], v6 offset:25088
    v_fma_f32 v249, v249, v11, v11
    v_fma_f32 v250, v250, v11, v11
    v_fma_f32 v251, v251, v11, v11
    v_mfma_f32_32x32x16_bf16 v[144:159], v[204:207], v[52:55], v[144:159]
    s_waitcnt lgkmcnt(9)
    v_rcp_f32 v248, v248
    v_rcp_f32 v249, v249
    v_rcp_f32 v250, v250
    v_mfma_f32_32x32x16_bf16 v[128:143], v[208:211], v[56:59], v[128:143]
    ds_read_b64_tr_b16 v[200:201], v5 offset:26624
    ds_read_b64_tr_b16 v[202:203], v5 offset:27136
    ds_read_b64_tr_b16 v[204:205], v6 offset:26624
    ds_read_b64_tr_b16 v[206:207], v6 offset:27136
    v_rcp_f32 v251, v251
    v_mul_f32 v252, v168, v248
    v_mfma_f32_32x32x16_bf16 v[144:159], v[212:215], v[56:59], v[144:159]
    s_waitcnt lgkmcnt(9)
    v_mul_f32 v253, v169, v249
    v_mul_f32 v254, v170, v250
    v_mul_f32 v255, v171, v251
    s_waitcnt lgkmcnt(8)
    v_readfirstlane_b32 s58, v12
    s_nop 0
    s_cmp_ge_u32 s58, 4
    s_cbranch_scc0 L_ck36
L_ck35:
    v_add_u32 v5, 114688, v3
    v_add_u32 v6, 114688, v4
    v_mfma_f32_32x32x16_bf16 v[128:143], v[216:219], v[60:63], v[128:143]
    ds_read_b64_tr_b16 v[208:209], v5 offset:0
    ds_read_b64_tr_b16 v[210:211], v5 offset:512
    ds_read_b64_tr_b16 v[212:213], v6 offset:0
    ds_read_b64_tr_b16 v[214:215], v6 offset:512
    v_cvt_pk_bf16_f32 v244, v252, v253
    v_cvt_pk_bf16_f32 v245, v254, v255
    v_mfma_f32_32x32x16_bf16 v[144:159], v[220:223], v[60:63], v[144:159]
    s_waitcnt lgkmcnt(8)
    v_mul_f32 v248, v172, v10
    v_mul_f32 v249, v173, v10
    v_mul_f32 v250, v174, v10
    v_mul_f32 v251, v175, v10
    v_exp_f32 v248, v248
    v_exp_f32 v249, v249
    v_mfma_f32_32x32x16_bf16 v[128:143], v[192:195], v[64:67], v[128:143]
    ds_read_b64_tr_b16 v[216:217], v5 offset:2048
    ds_read_b64_tr_b16 v[218:219], v5 offset:2560
    ds_read_b64_tr_b16 v[220:221], v6 offset:2048
    ds_read_b64_tr_b16 v[222:223], v6 offset:2560
    v_exp_f32 v250, v250
    v_mfma_f32_32x32x16_bf16 v[144:159], v[196:199], v[64:67], v[144:159]
    s_waitcnt lgkmcnt(8)
    v_exp_f32 v251, v251
    v_fma_f32 v248, v248, v11, v11
    v_fma_f32 v249, v249, v11, v11
    v_fma_f32 v250, v250, v11, v11
    v_fma_f32 v251, v251, v11, v11
    v_mfma_f32_32x32x16_bf16 v[128:143], v[200:203], v[68:71], v[128:143]
    ds_read_b64_tr_b16 v[192:193], v5 offset:4096
    ds_read_b64_tr_b16 v[194:195], v5 offset:4608
    ds_read_b64_tr_b16 v[196:197], v6 offset:4096
    ds_read_b64_tr_b16 v[198:199], v6 offset:4608
    v_rcp_f32 v248, v248
    v_rcp_f32 v249, v249
    v_mfma_f32_32x32x16_bf16 v[144:159], v[204:207], v[68:71], v[144:159]
    s_waitcnt lgkmcnt(8)
    v_rcp_f32 v250, v250
    v_rcp_f32 v251, v251
    v_mul_f32 v252, v172, v248
    v_mul_f32 v253, v173, v249
    v_mfma_f32_32x32x16_bf16 v[128:143], v[208:211], v[72:75], v[128:143]
    ds_read_b64_tr_b16 v[200:201], v5 offset:6144
    ds_read_b64_tr_b16 v[202:203], v5 offset:6656
    ds_read_b64_tr_b16 v[204:205], v6 offset:6144
    ds_read_b64_tr_b16 v[206:207], v6 offset:6656
    v_mul_f32 v254, v174, v250
    v_mul_f32 v255, v175, v251
    v_mfma_f32_32x32x16_bf16 v[144:159], v[212:215], v[72:75], v[144:159]
    s_waitcnt lgkmcnt(8)
    v_cvt_pk_bf16_f32 v246, v252, v253
    v_cvt_pk_bf16_f32 v247, v254, v255
    buffer_store_dwordx4 v[244:247], v2, s[16:19], s50 offen offset:1024 sc1
    v_mul_f32 v248, v176, v10
    v_mul_f32 v249, v177, v10
    v_mul_f32 v250, v178, v10
    v_mul_f32 v251, v179, v10
    v_mfma_f32_32x32x16_bf16 v[128:143], v[216:219], v[76:79], v[128:143]
    ds_read_b64_tr_b16 v[208:209], v5 offset:8192
    ds_read_b64_tr_b16 v[210:211], v5 offset:8704
    ds_read_b64_tr_b16 v[212:213], v6 offset:8192
    ds_read_b64_tr_b16 v[214:215], v6 offset:8704
    v_exp_f32 v248, v248
    v_mfma_f32_32x32x16_bf16 v[144:159], v[220:223], v[76:79], v[144:159]
    s_waitcnt lgkmcnt(8)
    v_exp_f32 v249, v249
    v_exp_f32 v250, v250
    v_exp_f32 v251, v251
    v_fma_f32 v248, v248, v11, v11
    v_fma_f32 v249, v249, v11, v11
    v_mfma_f32_32x32x16_bf16 v[128:143], v[192:195], v[80:83], v[128:143]
    ds_read_b64_tr_b16 v[216:217], v5 offset:10240
    ds_read_b64_tr_b16 v[218:219], v5 offset:10752
    ds_read_b64_tr_b16 v[220:221], v6 offset:10240
    ds_read_b64_tr_b16 v[222:223], v6 offset:10752
    v_fma_f32 v250, v250, v11, v11
    v_fma_f32 v251, v251, v11, v11
    v_mfma_f32_32x32x16_bf16 v[144:159], v[196:199], v[80:83], v[144:159]
    s_waitcnt lgkmcnt(8)
    v_rcp_f32 v248, v248
    v_rcp_f32 v249, v249
    v_rcp_f32 v250, v250
    v_mfma_f32_32x32x16_bf16 v[128:143], v[200:203], v[84:87], v[128:143]
    ds_read_b64_tr_b16 v[192:193], v5 offset:12288
    ds_read_b64_tr_b16 v[194:195], v5 offset:12800
    ds_read_b64_tr_b16 v[196:197], v6 offset:12288
    ds_read_b64_tr_b16 v[198:199], v6 offset:12800
    v_rcp_f32 v251, v251
    v_mul_f32 v252, v176, v248
    v_mul_f32 v253, v177, v249
    v_mfma_f32_32x32x16_bf16 v[144:159], v[204:207], v[84:87], v[144:159]
    s_waitcnt lgkmcnt(8)
    v_mul_f32 v254, v178, v250
    v_mul_f32 v255, v179, v251
    v_cvt_pk_bf16_f32 v224, v252, v253
    v_cvt_pk_bf16_f32 v225, v254, v255
    v_mul_f32 v248, v180, v10
    v_mul_f32 v249, v181, v10
    v_mfma_f32_32x32x16_bf16 v[128:143], v[208:211], v[88:91], v[128:143]
    ds_read_b64_tr_b16 v[200:201], v5 offset:14336
    ds_read_b64_tr_b16 v[202:203], v5 offset:14848
    ds_read_b64_tr_b16 v[204:205], v6 offset:14336
    ds_read_b64_tr_b16 v[206:207], v6 offset:14848
    v_mul_f32 v250, v182, v10
    v_mul_f32 v251, v183, v10
    v_mfma_f32_32x32x16_bf16 v[144:159], v[212:215], v[88:91], v[144:159]
    s_waitcnt lgkmcnt(8)
    v_exp_f32 v248, v248
    v_exp_f32 v249, v249
    v_exp_f32 v250, v250
    v_exp_f32 v251, v251
    v_mfma_f32_32x32x16_bf16 v[128:143], v[216:219], v[92:95], v[128:143]
    ds_read_b64_tr_b16 v[208:209], v5 offset:16384
    ds_read_b64_tr_b16 v[210:211], v5 offset:16896
    ds_read_b64_tr_b16 v[212:213], v6 offset:16384
    ds_read_b64_tr_b16 v[214:215], v6 offset:16896
    v_fma_f32 v248, v248, v11, v11
    v_fma_f32 v249, v249, v11, v11
    v_mfma_f32_32x32x16_bf16 v[144:159], v[220:223], v[92:95], v[144:159]
    s_waitcnt lgkmcnt(8)
    v_fma_f32 v250, v250, v11, v11
    v_fma_f32 v251, v251, v11, v11
    v_rcp_f32 v248, v248
    v_rcp_f32 v249, v249
    v_rcp_f32 v250, v250
    v_mfma_f32_32x32x16_bf16 v[128:143], v[192:195], v[96:99], v[128:143]
    ds_read_b64_tr_b16 v[216:217], v5 offset:18432
    ds_read_b64_tr_b16 v[218:219], v5 offset:18944
    ds_read_b64_tr_b16 v[220:221], v6 offset:18432
    ds_read_b64_tr_b16 v[222:223], v6 offset:18944
    v_rcp_f32 v251, v251
    v_mfma_f32_32x32x16_bf16 v[144:159], v[196:199], v[96:99], v[144:159]
    s_waitcnt lgkmcnt(8)
    v_mul_f32 v252, v180, v248
    v_mul_f32 v253, v181, v249
    v_mul_f32 v254, v182, v250
    v_mul_f32 v255, v183, v251
    v_cvt_pk_bf16_f32 v226, v252, v253
    v_cvt_pk_bf16_f32 v227, v254, v255
    v_mfma_f32_32x32x16_bf16 v[128:143], v[200:203], v[100:103], v[128:143]
    ds_read_b64_tr_b16 v[192:193], v5 offset:20480
    ds_read_b64_tr_b16 v[194:195], v5 offset:20992
    ds_read_b64_tr_b16 v[196:197], v6 offset:20480
    ds_read_b64_tr_b16 v[198:199], v6 offset:20992
    buffer_store_dwordx4 v[224:227], v2, s[16:19], s50 offen offset:2048 sc1
    v_mul_f32 v248, v184, v10
    v_mul_f32 v249, v185, v10
    v_mfma_f32_32x32x16_bf16 v[144:159], v[204:207], v[100:103], v[144:159]
    s_waitcnt lgkmcnt(8)
    v_mul_f32 v250, v186, v10
    v_mul_f32 v251, v187, v10
    v_exp_f32 v248, v248
    v_exp_f32 v249, v249
    v_mfma_f32_32x32x16_bf16 v[128:143], v[208:211], v[104:107], v[128:143]
    ds_read_b64_tr_b16 v[200:201], v5 offset:22528
    ds_read_b64_tr_b16 v[202:203], v5 offset:23040
    ds_read_b64_tr_b16 v[204:205], v6 offset:22528
    ds_read_b64_tr_b16 v[206:207], v6 offset:23040
    ds_read_b32 v12, v0 offset:224
    v_exp_f32 v250, v250
    v_exp_f32 v251, v251
    v_mfma_f32_32x32x16_bf16 v[144:159], v[212:215], v[104:107], v[144:159]
    s_waitcnt lgkmcnt(9)
    v_fma_f32 v248, v248, v11, v11
    v_fma_f32 v249, v249, v11, v11
    v_fma_f32 v250, v250, v11, v11
    v_fma_f32 v251, v251, v11, v11
    v_rcp_f32 v248, v248
    v_mfma_f32_32x32x16_bf16 v[128:143], v[216:219], v[108:111], v[128:143]
    ds_read_b64_tr_b16 v[208:209], v5 offset:24576
    ds_read_b64_tr_b16 v[210:211], v5 offset:25088
    ds_read_b64_tr_b16 v[212:213], v6 offset:24576
    ds_read_b64_tr_b16 v[214:215], v6 offset:25088
    v_rcp_f32 v249, v249
    v_mfma_f32_32x32x16_bf16 v[144:159], v[220:223], v[108:111], v[144:159]
    s_waitcnt lgkmcnt(9)
    v_rcp_f32 v250, v250
    v_rcp_f32 v251, v251
    v_mul_f32 v252, v184, v248
    v_mul_f32 v253, v185, v249
    v_mul_f32 v254, v186, v250
    v_mul_f32 v255, v187, v251
    v_mfma_f32_32x32x16_bf16 v[128:143], v[192:195], v[112:115], v[128:143]
    ds_read_b64_tr_b16 v[216:217], v5 offset:26624
    ds_read_b64_tr_b16 v[218:219], v5 offset:27136
    ds_read_b64_tr_b16 v[220:221], v6 offset:26624
    ds_read_b64_tr_b16 v[222:223], v6 offset:27136
    v_cvt_pk_bf16_f32 v228, v252, v253
    v_cvt_pk_bf16_f32 v229, v254, v255
    v_mfma_f32_32x32x16_bf16 v[144:159], v[196:199], v[112:115], v[144:159]
    s_waitcnt lgkmcnt(9)
    v_mul_f32 v248, v188, v10
    v_mul_f32 v249, v189, v10
    v_mul_f32 v250, v190, v10
    s_waitcnt lgkmcnt(8)
    v_readfirstlane_b32 s58, v12
    s_nop 0
    s_cmp_ge_u32 s58, 4
    s_cbranch_scc0 L_ck42
L_ck41:
    v_mfma_f32_32x32x16_bf16 v[128:143], v[200:203], v[116:119], v[128:143]
    ds_read_b64_tr_b16 v[192:193], v7 offset:0
    ds_read_b64_tr_b16 v[194:195], v7 offset:256
    v_mul_f32 v251, v191, v10
    v_exp_f32 v248, v248
    v_mfma_f32_32x32x16_bf16 v[144:159], v[204:207], v[116:119], v[144:159]
    s_waitcnt lgkmcnt(6)
    v_exp_f32 v249, v249
    v_exp_f32 v250, v250
    v_exp_f32 v251, v251
    v_mfma_f32_32x32x16_bf16 v[128:143], v[208:211], v[120:123], v[128:143]
    ds_read_b64_tr_b16 v[200:201], v7 offset:1024
    ds_read_b64_tr_b16 v[202:203], v7 offset:1280
    v_fma_f32 v248, v248, v11, v11
    v_fma_f32 v249, v249, v11, v11
    v_fma_f32 v250, v250, v11, v11
    v_mfma_f32_32x32x16_bf16 v[144:159], v[212:215], v[120:123], v[144:159]
    s_waitcnt lgkmcnt(4)
    v_fma_f32 v251, v251, v11, v11
    v_rcp_f32 v248, v248
    v_rcp_f32 v249, v249
    v_rcp_f32 v250, v250
    v_mfma_f32_32x32x16_bf16 v[128:143], v[216:219], v[124:127], v[128:143]
    ds_read_b64_tr_b16 v[208:209], v7 offset:2048
    ds_read_b64_tr_b16 v[210:211], v7 offset:2304
    v_rcp_f32 v251, v251
    v_mfma_f32_32x32x16_bf16 v[144:159], v[220:223], v[124:127], v[144:159]
    s_waitcnt lgkmcnt(4)
    v_mul_f32 v252, v188, v248
    v_mul_f32 v253, v189, v249
    v_mul_f32 v254, v190, v250
    v_mul_f32 v255, v191, v251
    v_cvt_pk_bf16_f32 v230, v252, v253
    v_cvt_pk_bf16_f32 v231, v254, v255
    buffer_store_dwordx4 v[228:231], v2, s[16:19], s50 offen offset:3072 sc1
    v_mfma_f32_32x32x16_bf16 v[160:175], v[192:195], v[16:19], 0
    ds_read_b64_tr_b16 v[216:217], v7 offset:3072
    ds_read_b64_tr_b16 v[218:219], v7 offset:3328
    s_waitcnt lgkmcnt(4)
    v_mfma_f32_32x32x16_bf16 v[160:175], v[200:203], v[20:23], v[160:175]
    ds_read_b64_tr_b16 v[192:193], v7 offset:4096
    ds_read_b64_tr_b16 v[194:195], v7 offset:4352
    s_add_u32 s50, s60, 8192
    v_mul_f32 v248, v128, v10
    v_mul_f32 v249, v129, v10
    v_mul_f32 v250, v130, v10
    v_mul_f32 v251, v131, v10
    v_exp_f32 v248, v248
    v_exp_f32 v249, v249
    s_waitcnt lgkmcnt(4)
    v_mfma_f32_32x32x16_bf16 v[160:175], v[208:211], v[24:27], v[160:175]
    ds_read_b64_tr_b16 v[200:201], v7 offset:5120
    ds_read_b64_tr_b16 v[202:203], v7 offset:5376
    v_exp_f32 v250, v250
    v_exp_f32 v251, v251
    v_fma_f32 v248, v248, v11, v11
    v_fma_f32 v249, v249, v11, v11
    v_fma_f32 v250, v250, v11, v11
    v_fma_f32 v251, v251, v11, v11
    v_rcp_f32 v248, v248
    s_waitcnt lgkmcnt(4)
    v_mfma_f32_32x32x16_bf16 v[160:175], v[216:219], v[28:31], v[160:175]
    ds_read_b64_tr_b16 v[208:209], v7 offset:6144
    ds_read_b64_tr_b16 v[210:211], v7 offset:6400
    v_rcp_f32 v249, v249
    v_rcp_f32 v250, v250
    v_rcp_f32 v251, v251
    v_mul_f32 v252, v128, v248
    v_mul_f32 v253, v129, v249
    s_waitcnt lgkmcnt(4)
    v_mfma_f32_32x32x16_bf16 v[160:175], v[192:195], v[32:35], v[160:175]
    ds_read_b64_tr_b16 v[216:217], v7 offset:7168
    ds_read_b64_tr_b16 v[218:219], v7 offset:7424
    v_mul_f32 v254, v130, v250
    v_mul_f32 v255, v131, v251
    v_cvt_pk_bf16_f32 v240, v252, v253
    v_cvt_pk_bf16_f32 v241, v254, v255
    v_mul_f32 v248, v132, v10
    v_mul_f32 v249, v133, v10
    v_mul_f32 v250, v134, v10
    v_mul_f32 v251, v135, v10
    v_exp_f32 v248, v248
    s_waitcnt lgkmcnt(4)
    v_mfma_f32_32x32x16_bf16 v[160:175], v[200:203], v[36:39], v[160:175]
    ds_read_b64_tr_b16 v[192:193], v7 offset:8192
    ds_read_b64_tr_b16 v[194:195], v7 offset:8448
    v_exp_f32 v249, v249
    v_exp_f32 v250, v250
    v_exp_f32 v251, v251
    v_fma_f32 v248, v248, v11, v11
    v_fma_f32 v249, v249, v11, v11
    v_fma_f32 v250, v250, v11, v11
    s_waitcnt lgkmcnt(4)
    v_mfma_f32_32x32x16_bf16 v[160:175], v[208:211], v[40:43], v[160:175]
    ds_read_b64_tr_b16 v[200:201], v7 offset:9216
    ds_read_b64_tr_b16 v[202:203], v7 offset:9472
    v_fma_f32 v251, v251, v11, v11
    v_rcp_f32 v248, v248
    v_rcp_f32 v249, v249
    v_rcp_f32 v250, v250
    v_rcp_f32 v251, v251
    s_waitcnt lgkmcnt(4)
    v_mfma_f32_32x32x16_bf16 v[160:175], v[216:219], v[44:47], v[160:175]
    ds_read_b64_tr_b16 v[208:209], v7 offset:10240
    ds_read_b64_tr_b16 v[210:211], v7 offset:10496
    v_mul_f32 v252, v132, v248
    v_mul_f32 v253, v133, v249
    v_mul_f32 v254, v134, v250
    v_mul_f32 v255, v135, v251
    v_cvt_pk_bf16_f32 v242, v252, v253
    v_cvt_pk_bf16_f32 v243, v254, v255
    buffer_store_dwordx4 v[240:243], v2, s[16:19], s50 offen offset:0 sc1
    v_mul_f32 v248, v136, v10
    v_mul_f32 v249, v137, v10
    s_waitcnt lgkmcnt(4)
    v_mfma_f32_32x32x16_bf16 v[160:175], v[192:195], v[48:51], v[160:175]
    ds_read_b64_tr_b16 v[216:217], v7 offset:11264
    ds_read_b64_tr_b16 v[218:219], v7 offset:11520
    v_mul_f32 v250, v138, v10
    v_mul_f32 v251, v139, v10
    v_exp_f32 v248, v248
    v_exp_f32 v249, v249
    v_exp_f32 v250, v250
    s_waitcnt lgkmcnt(4)
    v_mfma_f32_32x32x16_bf16 v[160:175], v[200:203], v[52:55], v[160:175]
    ds_read_b64_tr_b16 v[192:193], v7 offset:12288
    ds_read_b64_tr_b16 v[194:195], v7 offset:12544
    v_exp_f32 v251, v251
    v_fma_f32 v248, v248, v11, v11
    v_fma_f32 v249, v249, v11, v11
    v_fma_f32 v250, v250, v11, v11
    v_fma_f32 v251, v251, v11, v11
    v_rcp_f32 v248, v248
    v_rcp_f32 v249, v249
    s_waitcnt lgkmcnt(4)
    v_mfma_f32_32x32x16_bf16 v[160:175], v[208:211], v[56:59], v[160:175]
    ds_read_b64_tr_b16 v[200:201], v7 offset:13312
    ds_read_b64_tr_b16 v[202:203], v7 offset:13568
    v_rcp_f32 v250, v250
    v_rcp_f32 v251, v251
    v_mul_f32 v252, v136, v248
    v_mul_f32 v253, v137, v249
    v_mul_f32 v254, v138, v250
    v_mul_f32 v255, v139, v251
    v_cvt_pk_bf16_f32 v244, v252, v253
    s_waitcnt lgkmcnt(4)
    v_mfma_f32_32x32x16_bf16 v[160:175], v[216:219], v[60:63], v[160:175]
    ds_read_b64_tr_b16 v[208:209], v7 offset:14336
    ds_read_b64_tr_b16 v[210:211], v7 offset:14592
    v_cvt_pk_bf16_f32 v245, v254, v255
    v_mul_f32 v248, v140, v10
    v_mul_f32 v249, v141, v10
    v_mul_f32 v250, v142, v10
    v_mul_f32 v251, v143, v10
    v_exp_f32 v248, v248
    v_exp_f32 v249, v249
    s_waitcnt lgkmcnt(4)
    v_mfma_f32_32x32x16_bf16 v[160:175], v[192:195], v[64:67], v[160:175]
    ds_read_b64_tr_b16 v[216:217], v7 offset:15360
    ds_read_b64_tr_b16 v[218:219], v7 offset:15616
    v_exp_f32 v250, v250
    v_exp_f32 v251, v251
    v_fma_f32 v248, v248, v11, v11
    v_fma_f32 v249, v249, v11, v11
    v_fma_f32 v250, v250, v11, v11
    v_fma_f32 v251, v251, v11, v11
    v_rcp_f32 v248, v248
    s_waitcnt lgkmcnt(4)
    v_mfma_f32_32x32x16_bf16 v[160:175], v[200:203], v[68:71], v[160:175]
    ds_read_b64_tr_b16 v[192:193], v7 offset:16384
    ds_read_b64_tr_b16 v[194:195], v7 offset:16640
    v_rcp_f32 v249, v249
    v_rcp_f32 v250, v250
    v_rcp_f32 v251, v251
    v_mul_f32 v252, v140, v248
    v_mul_f32 v253, v141, v249
    s_waitcnt lgkmcnt(4)
    v_mfma_f32_32x32x16_bf16 v[160:175], v[208:211], v[72:75], v[160:175]
    ds_read_b64_tr_b16 v[200:201], v7 offset:17408
    ds_read_b64_tr_b16 v[202:203], v7 offset:17664
    v_mul_f32 v254, v142, v250
    v_mul_f32 v255, v143, v251
    v_cvt_pk_bf16_f32 v246, v252, v253
    v_cvt_pk_bf16_f32 v247, v254, v255
    buffer_store_dwordx4 v[244:247], v2, s[16:19], s50 offen offset:1024 sc1
    v_mul_f32 v248, v144, v10
    v_mul_f32 v249, v145, v10
    v_mul_f32 v250, v146, v10
    v_mul_f32 v251, v147, v10
    s_waitcnt lgkmcnt(4)
    v_mfma_f32_32x32x16_bf16 v[160:175], v[216:219], v[76:79], v[160:175]
    ds_read_b64_tr_b16 v[208:209], v7 offset:18432
    ds_read_b64_tr_b16 v[210:211], v7 offset:18688
    v_exp_f32 v248, v248
    v_exp_f32 v249, v249
    v_exp_f32 v250, v250
    v_exp_f32 v251, v251
    v_fma_f32 v248, v248, v11, v11
    v_fma_f32 v249, v249, v11, v11
    s_waitcnt lgkmcnt(4)
    v_mfma_f32_32x32x16_bf16 v[160:175], v[192:195], v[80:83], v[160:175]
    ds_read_b64_tr_b16 v[216:217], v7 offset:19456
    ds_read_b64_tr_b16 v[218:219], v7 offset:19712
    v_fma_f32 v250, v250, v11, v11
    v_fma_f32 v251, v251, v11, v11
    v_rcp_f32 v248, v248
    v_rcp_f32 v249, v249
    v_rcp_f32 v250, v250
    s_waitcnt lgkmcnt(4)
    v_mfma_f32_32x32x16_bf16 v[160:175], v[200:203], v[84:87], v[160:175]
    ds_read_b64_tr_b16 v[192:193], v7 offset:20480
    ds_read_b64_tr_b16 v[194:195], v7 offset:20736
    v_rcp_f32 v251, v251
    v_mul_f32 v252, v144, v248
    v_mul_f32 v253, v145, v249
    v_mul_f32 v254, v146, v250
    v_mul_f32 v255, v147, v251
    v_cvt_pk_bf16_f32 v224, v252, v253
    v_cvt_pk_bf16_f32 v225, v254, v255
    v_mul_f32 v248, v148, v10
    v_mul_f32 v249, v149, v10
    s_waitcnt lgkmcnt(4)
    v_mfma_f32_32x32x16_bf16 v[160:175], v[208:211], v[88:91], v[160:175]
    ds_read_b64_tr_b16 v[200:201], v7 offset:21504
    ds_read_b64_tr_b16 v[202:203], v7 offset:21760
    v_mul_f32 v250, v150, v10
    v_mul_f32 v251, v151, v10
    v_exp_f32 v248, v248
    v_exp_f32 v249, v249
    v_exp_f32 v250, v250
    v_exp_f32 v251, v251
    s_waitcnt lgkmcnt(4)
    v_mfma_f32_32x32x16_bf16 v[160:175], v[216:219], v[92:95], v[160:175]
    ds_read_b64_tr_b16 v[208:209], v7 offset:22528
    ds_read_b64_tr_b16 v[210:211], v7 offset:22784
    v_fma_f32 v248, v248, v11, v11
    v_fma_f32 v249, v249, v11, v11
    v_fma_f32 v250, v250, v11, v11
    v_fma_f32 v251, v251, v11, v11
    v_rcp_f32 v248, v248
    v_rcp_f32 v249, v249
    s_waitcnt lgkmcnt(4)
    v_mfma_f32_32x32x16_bf16 v[160:175], v[192:195], v[96:99], v[160:175]
    ds_read_b64_tr_b16 v[216:217], v7 offset:23552
    ds_read_b64_tr_b16 v[218:219], v7 offset:23808
    v_rcp_f32 v250, v250
    v_rcp_f32 v251, v251
    v_mul_f32 v252, v148, v248
    v_mul_f32 v253, v149, v249
    v_mul_f32 v254, v150, v250
    v_mul_f32 v255, v151, v251
    v_cvt_pk_bf16_f32 v226, v252, v253
    s_waitcnt lgkmcnt(4)
    v_mfma_f32_32x32x16_bf16 v[160:175], v[200:203], v[100:103], v[160:175]
    ds_read_b64_tr_b16 v[192:193], v7 offset:24576
    ds_read_b64_tr_b16 v[194:195], v7 offset:24832
    v_cvt_pk_bf16_f32 v227, v254, v255
    buffer_store_dwordx4 v[224:227], v2, s[16:19], s50 offen offset:2048 sc1
    v_mul_f32 v248, v152, v10
    v_mul_f32 v249, v153, v10
    v_mul_f32 v250, v154, v10
    v_mul_f32 v251, v155, v10
    v_exp_f32 v248, v248
    v_exp_f32 v249, v249
    s_waitcnt lgkmcnt(4)
    v_mfma_f32_32x32x16_bf16 v[160:175], v[208:211], v[104:107], v[160:175]
    ds_read_b64_tr_b16 v[200:201], v7 offset:25600
    ds_read_b64_tr_b16 v[202:203], v7 offset:25856
    v_exp_f32 v250, v250
    v_exp_f32 v251, v251
    v_fma_f32 v248, v248, v11, v11
    v_fma_f32 v249, v249, v11, v11
    v_fma_f32 v250, v250, v11, v11
    v_fma_f32 v251, v251, v11, v11
    s_waitcnt lgkmcnt(4)
    v_mfma_f32_32x32x16_bf16 v[160:175], v[216:219], v[108:111], v[160:175]
    ds_read_b64_tr_b16 v[208:209], v7 offset:26624
    ds_read_b64_tr_b16 v[210:211], v7 offset:26880
    v_rcp_f32 v248, v248
    v_rcp_f32 v249, v249
    v_rcp_f32 v250, v250
    v_rcp_f32 v251, v251
    v_mul_f32 v252, v152, v248
    v_mul_f32 v253, v153, v249
    s_waitcnt lgkmcnt(4)
    v_mfma_f32_32x32x16_bf16 v[160:175], v[192:195], v[112:115], v[160:175]
    ds_read_b64_tr_b16 v[216:217], v7 offset:27648
    ds_read_b64_tr_b16 v[218:219], v7 offset:27904
    v_mul_f32 v254, v154, v250
    v_mul_f32 v255, v155, v251
    v_cvt_pk_bf16_f32 v228, v252, v253
    v_cvt_pk_bf16_f32 v229, v254, v255
    v_mul_f32 v248, v156, v10
    v_mul_f32 v249, v157, v10
    v_mul_f32 v250, v158, v10
    v_mul_f32 v251, v159, v10
    s_waitcnt lgkmcnt(4)
    v_mfma_f32_32x32x16_bf16 v[160:175], v[200:203], v[116:119], v[160:175]
    v_exp_f32 v248, v248
    v_exp_f32 v249, v249
    v_exp_f32 v250, v250
    v_exp_f32 v251, v251
    v_fma_f32 v248, v248, v11, v11
    v_fma_f32 v249, v249, v11, v11
    s_waitcnt lgkmcnt(2)
    v_mfma_f32_32x32x16_bf16 v[160:175], v[208:211], v[120:123], v[160:175]
    v_fma_f32 v250, v250, v11, v11
    v_fma_f32 v251, v251, v11, v11
    v_rcp_f32 v248, v248
    v_rcp_f32 v249, v249
    v_rcp_f32 v250, v250
    s_waitcnt lgkmcnt(0)
    v_mfma_f32_32x32x16_bf16 v[160:175], v[216:219], v[124:127], v[160:175]
    v_rcp_f32 v251, v251
    v_mul_f32 v252, v156, v248
    v_mul_f32 v253, v157, v249
    v_mul_f32 v254, v158, v250
    v_mul_f32 v255, v159, v251
    v_cvt_pk_bf16_f32 v230, v252, v253
    v_cvt_pk_bf16_f32 v231, v254, v255
    buffer_store_dwordx4 v[228:231], v2, s[16:19], s50 offen offset:3072 sc1
    ds_read_b32 v14, v0 offset:320
    s_nop 2
    v_mul_f32 v248, v160, v10
    v_mul_f32 v249, v161, v10
    v_mul_f32 v250, v162, v10
    v_mul_f32 v251, v163, v10
    v_exp_f32 v248, v248
    v_exp_f32 v249, v249
    v_exp_f32 v250, v250
    v_exp_f32 v251, v251
    v_fma_f32 v248, v248, v11, v11
    v_fma_f32 v249, v249, v11, v11
    v_fma_f32 v250, v250, v11, v11
    v_fma_f32 v251, v251, v11, v11
    v_rcp_f32 v248, v248
    v_rcp_f32 v249, v249
    v_rcp_f32 v250, v250
    v_rcp_f32 v251, v251
    v_mul_f32 v252, v160, v248
    v_mul_f32 v253, v161, v249
    v_mul_f32 v254, v162, v250
    v_mul_f32 v255, v163, v251
    v_cvt_pk_bf16_f32 v240, v252, v253
    v_cvt_pk_bf16_f32 v241, v254, v255
    v_mul_f32 v248, v164, v10
    v_mul_f32 v249, v165, v10
    v_mul_f32 v250, v166, v10
    v_mul_f32 v251, v167, v10
    v_exp_f32 v248, v248
    v_exp_f32 v249, v249
    v_exp_f32 v250, v250
    v_exp_f32 v251, v251
    v_fma_f32 v248, v248, v11, v11
    v_fma_f32 v249, v249, v11, v11
    v_fma_f32 v250, v250, v11, v11
    v_fma_f32 v251, v251, v11, v11
    v_rcp_f32 v248, v248
    v_rcp_f32 v249, v249
    v_rcp_f32 v250, v250
    v_rcp_f32 v251, v251
    v_mul_f32 v252, v164, v248
    v_mul_f32 v253, v165, v249
    v_mul_f32 v254, v166, v250
    v_mul_f32 v255, v167, v251
    v_cvt_pk_bf16_f32 v242, v252, v253
    v_cvt_pk_bf16_f32 v243, v254, v255
    buffer_store_dwordx4 v[240:243], v2, s[16:19], s61 offen offset:0 sc1
    v_mul_f32 v248, v168, v10
    v_mul_f32 v249, v169, v10
    v_mul_f32 v250, v170, v10
    v_mul_f32 v251, v171, v10
    v_exp_f32 v248, v248
    v_exp_f32 v249, v249
    v_exp_f32 v250, v250
    v_exp_f32 v251, v251
    v_fma_f32 v248, v248, v11, v11
    v_fma_f32 v249, v249, v11, v11
    v_fma_f32 v250, v250, v11, v11
    v_fma_f32 v251, v251, v11, v11
    v_rcp_f32 v248, v248
    v_rcp_f32 v249, v249
    v_rcp_f32 v250, v250
    v_rcp_f32 v251, v251
    v_mul_f32 v252, v168, v248
    v_mul_f32 v253, v169, v249
    v_mul_f32 v254, v170, v250
    v_mul_f32 v255, v171, v251
    v_cvt_pk_bf16_f32 v244, v252, v253
    v_cvt_pk_bf16_f32 v245, v254, v255
    v_mul_f32 v248, v172, v10
    v_mul_f32 v249, v173, v10
    v_mul_f32 v250, v174, v10
    v_mul_f32 v251, v175, v10
    v_exp_f32 v248, v248
    v_exp_f32 v249, v249
    v_exp_f32 v250, v250
    v_exp_f32 v251, v251
    v_fma_f32 v248, v248, v11, v11
    v_fma_f32 v249, v249, v11, v11
    v_fma_f32 v250, v250, v11, v11
    v_fma_f32 v251, v251, v11, v11
    v_rcp_f32 v248, v248
    v_rcp_f32 v249, v249
    v_rcp_f32 v250, v250
    v_rcp_f32 v251, v251
    v_mul_f32 v252, v172, v248
    v_mul_f32 v253, v173, v249
    v_mul_f32 v254, v174, v250
    v_mul_f32 v255, v175, v251
    v_cvt_pk_bf16_f32 v246, v252, v253
    v_cvt_pk_bf16_f32 v247, v254, v255
    buffer_store_dwordx4 v[244:247], v2, s[16:19], s61 offen offset:1024 sc1
    ds_write_b32 v0, v0 offset:96
    s_lshl_b32 s61, s6, 1
    s_lshr_b32 s51, s59, 1
    s_add_u32 s61, s61, s51
    s_lshl_b32 s61, s61, 15
    s_lshl_b32 s51, s7, 8
    s_add_u32 s61, s61, s51
    s_and_b32 s51, s59, 1
    s_lshl_b32 s51, s51, 7
    s_add_u32 s61, s61, s51
    s_add_u32 s61, s61, 13697024
    v_bfe_u32 v8, v1, 2, 2
    v_lshrrev_b32 v9, 5, v1
    v_lshlrev_b32 v9, 9, v9
    v_lshl_add_u32 v9, v8, 7, v9
    v_bfe_u32 v8, v1, 3, 1
    v_lshlrev_b32 v8, 6, v8
    v_bfe_u32 v10, v1, 4, 1
    v_lshlrev_b32 v10, 5, v10
    v_and_b32 v6, 3, v1
    v_lshl_add_u32 v10, v6, 3, v10
    v_xor_b32 v6, v10, v8
    v_add_u32 v6, v6, v9
    v_add_u32 v10, 64, v10
    v_xor_b32 v7, v10, v8
    v_add_u32 v7, v7, v9
    s_lshr_b32 s50, s59, 1
    s_lshl_b32 s53, s50, 15
    s_add_u32 s53, s53, 98304
    s_xor_b32 s51, s50, 1
    s_lshl_b32 s51, s51, 6
    v_add_u32 v6, s53, v6
    v_xor_b32 v6, s51, v6
    v_xor_b32 v7, 64, v6
    s_waitcnt lgkmcnt(1)
    v_readfirstlane_b32 s43, v14
    s_nop 0
    s_cmp_lg_u32 s43, 0
    s_cbranch_scc1 L_tg47
L_tg46:
    ds_read_b32 v14, v0 offset:320
    s_sleep 1
    s_waitcnt lgkmcnt(0)
    v_readfirstlane_b32 s43, v14
    s_nop 0
    s_cmp_eq_u32 s43, 0
    s_cbranch_scc1 L_tg46
L_tg47:
    s_waitcnt vmcnt(0)
    v_mov_b32 v248, s43
    v_mov_b32 v249, s43
    v_mov_b32 v250, s43
    v_mov_b32 v251, s43
    v_lshrrev_b32 v252, 3, v1
    v_lshlrev_b32 v252, 12, v252
    v_and_or_b32 v252, v2, s56, v252
    s_mov_b32 exec_lo, 0xffffffff
    s_mov_b32 exec_hi, 0xffffff
    buffer_store_dwordx4 v[248:251], v252, s[16:19], s61 offen sc1
    s_mov_b64 exec, -1
    v_and_b32 v8, 31, v1
    v_mul_u32_u24 v3, 896, v8
    v_lshrrev_b32 v8, 5, v1
    v_lshl_add_u32 v3, v8, 4, v3
    s_and_b32 s50, s59, 1
    s_lshl_b32 s51, s40, 1
    s_add_u32 s50, s50, s51
    s_mul_i32 s60, s50, 28672
    s_lshr_b32 s50, s59, 1
    s_lshl_b32 s50, s50, 6
    s_add_u32 s60, s60, s50
    s_lshl_b32 s50, s41, 7
    s_add_u32 s60, s60, s50
    buffer_load_dwordx4 v[236:239], v3, s[8:11], s60 offen offset:32
    s_branch L_aphase
L_cspare:
    s_waitcnt vmcnt(0)
    s_lshl_b32 s61, s6, 1
    s_lshr_b32 s51, s59, 1
    s_add_u32 s61, s61, s51
    s_lshl_b32 s61, s61, 15
    s_lshl_b32 s51, s7, 8
    s_add_u32 s61, s61, s51
    s_and_b32 s51, s59, 1
    s_lshl_b32 s51, s51, 7
    s_add_u32 s61, s61, s51
    s_add_u32 s61, s61, 13697024
    v_mov_b32 v248, s43
    v_mov_b32 v249, s43
    v_mov_b32 v250, s43
    v_mov_b32 v251, s43
    v_lshrrev_b32 v252, 3, v1
    v_lshlrev_b32 v252, 12, v252
    v_and_or_b32 v252, v2, s56, v252
    s_mov_b32 exec_lo, 0xffffffff
    s_mov_b32 exec_hi, 0xffffff
    buffer_store_dwordx4 v[248:251], v252, s[16:19], s61 offen sc1
    s_mov_b64 exec, -1
    s_setprio 0
    s_branch L_fin
L_cattn:
    v_mfma_f32_32x32x16_bf16 v[160:175], v[192:195], v[16:19], 0
    ds_read_b64_tr_b16 v[216:217], v5 offset:6144
    ds_read_b64_tr_b16 v[218:219], v5 offset:6656
    ds_read_b64_tr_b16 v[220:221], v6 offset:6144
    ds_read_b64_tr_b16 v[222:223], v6 offset:6656
    v_mfma_f32_32x32x16_bf16 v[176:191], v[196:199], v[16:19], 0
    s_waitcnt lgkmcnt(8)
    v_mfma_f32_32x32x16_bf16 v[160:175], v[200:203], v[20:23], v[160:175]
    ds_read_b64_tr_b16 v[192:193], v5 offset:8192
    ds_read_b64_tr_b16 v[194:195], v5 offset:8704
    ds_read_b64_tr_b16 v[196:197], v6 offset:8192
    ds_read_b64_tr_b16 v[198:199], v6 offset:8704
    v_mov_b32 v252, 163328
    ds_read_b128 v[248:251], v252 offset:32
    v_mfma_f32_32x32x16_bf16 v[176:191], v[204:207], v[20:23], v[176:191]
    s_waitcnt lgkmcnt(9)
    s_lshl_b32 s50, s3, 12
    s_add_u32 s50, s50, 143360
    v_add_u32 v7, s50, v2
    v_mul_f32 v128, v128, v8
    v_mul_f32 v129, v129, v8
    v_mul_f32 v130, v130, v8
    v_mfma_f32_32x32x16_bf16 v[160:175], v[208:211], v[24:27], v[160:175]
    ds_read_b64_tr_b16 v[200:201], v5 offset:10240
    ds_read_b64_tr_b16 v[202:203], v5 offset:10752
    ds_read_b64_tr_b16 v[204:205], v6 offset:10240
    ds_read_b64_tr_b16 v[206:207], v6 offset:10752
    v_mul_f32 v131, v131, v8
    v_mul_f32 v132, v132, v8
    v_mfma_f32_32x32x16_bf16 v[176:191], v[212:215], v[24:27], v[176:191]
    s_waitcnt lgkmcnt(9)
    v_mul_f32 v133, v133, v8
    v_mul_f32 v134, v134, v8
    v_mul_f32 v135, v135, v8
    v_mul_f32 v136, v136, v8
    v_mul_f32 v137, v137, v8
    v_mul_f32 v138, v138, v8
    s_waitcnt lgkmcnt(4)
    v_min3_u32 v248, v248, v249, v250
    v_min_u32 v248, v248, v251
    s_nop 0
    v_readfirstlane_b32 s58, v248
    s_nop 0
    s_cmp_lg_u32 s58, 0
    s_cbranch_scc0 L_cf53
L_cf52:
    v_mfma_f32_32x32x16_bf16 v[160:175], v[216:219], v[28:31], v[160:175]
    ds_read_b64_tr_b16 v[208:209], v5 offset:12288
    ds_read_b64_tr_b16 v[210:211], v5 offset:12800
    ds_read_b64_tr_b16 v[212:213], v6 offset:12288
    ds_read_b64_tr_b16 v[214:215], v6 offset:12800
    v_mul_f32 v139, v139, v8
    v_mul_f32 v140, v140, v9
    v_mfma_f32_32x32x16_bf16 v[176:191], v[220:223], v[28:31], v[176:191]
    v_mul_f32 v141, v141, v9
    v_mul_f32 v142, v142, v9
    v_mul_f32 v143, v143, v9
    v_cvt_pk_bf16_f32 v240, v128, v129
    v_cvt_pk_bf16_f32 v241, v130, v131
    v_cvt_pk_bf16_f32 v242, v132, v133
    v_mfma_f32_32x32x16_bf16 v[160:175], v[192:195], v[32:35], v[160:175]
    ds_read_b64_tr_b16 v[216:217], v5 offset:14336
    ds_read_b64_tr_b16 v[218:219], v5 offset:14848
    ds_read_b64_tr_b16 v[220:221], v6 offset:14336
    ds_read_b64_tr_b16 v[222:223], v6 offset:14848
    v_cvt_pk_bf16_f32 v243, v134, v135
    v_cvt_pk_bf16_f32 v244, v136, v137
    v_mfma_f32_32x32x16_bf16 v[176:191], v[196:199], v[32:35], v[176:191]
    s_waitcnt lgkmcnt(8)
    v_cvt_pk_bf16_f32 v245, v138, v139
    v_cvt_pk_bf16_f32 v246, v140, v141
    v_cvt_pk_bf16_f32 v247, v142, v143
    ds_write_b128 v7, v[240:243]
    ds_write_b128 v7, v[244:247] offset:1024
    ds_write_b32 v0, v0 offset:80
    v_mfma_f32_32x32x16_bf16 v[160:175], v[200:203], v[36:39], v[160:175]
    ds_read_b64_tr_b16 v[192:193], v5 offset:16384
    ds_read_b64_tr_b16 v[194:195], v5 offset:16896
    ds_read_b64_tr_b16 v[196:197], v6 offset:16384
    ds_read_b64_tr_b16 v[198:199], v6 offset:16896
    v_lshrrev_b32 v248, 5, v1
    v_lshlrev_b32 v248, 2, v248
    v_bfe_u32 v11, v1, 2, 2
    v_mfma_f32_32x32x16_bf16 v[176:191], v[204:207], v[36:39], v[176:191]
    s_waitcnt lgkmcnt(11)
    v_add_u32 v248, v248, v11
    v_mul_u32_u24 v11, 56, v248
    v_bfe_u32 v248, v1, 4, 1
    v_lshl_add_u32 v11, v248, 5, v11
    v_and_b32 v248, 3, v1
    v_lshl_add_u32 v11, v248, 3, v11
    v_add_u32 v11, 159744, v11
    v_mfma_f32_32x32x16_bf16 v[160:175], v[208:211], v[40:43], v[160:175]
    ds_read_b64_tr_b16 v[200:201], v5 offset:18432
    ds_read_b64_tr_b16 v[202:203], v5 offset:18944
    ds_read_b64_tr_b16 v[204:205], v6 offset:18432
    ds_read_b64_tr_b16 v[206:207], v6 offset:18944
    ds_read_b64_tr_b16 v[224:225], v11 offset:0
    ds_read_b64_tr_b16 v[226:227], v11 offset:448
    ds_read_b64_tr_b16 v[228:229], v11 offset:896
    v_mfma_f32_32x32x16_bf16 v[176:191], v[212:215], v[40:43], v[176:191]
    s_waitcnt lgkmcnt(14)
    ds_read_b64_tr_b16 v[230:231], v11 offset:1344
    ds_read_b64_tr_b16 v[232:233], v11 offset:1568
    ds_read_b64_tr_b16 v[234:235], v11 offset:2016
    ds_read_b64_tr_b16 v[236:237], v11 offset:2464
    ds_read_b64_tr_b16 v[238:239], v11 offset:2912
    v_mul_f32 v144, v144, v8
    v_mul_f32 v145, v145, v8
    v_mfma_f32_32x32x16_bf16 v[160:175], v[216:219], v[44:47], v[160:175]
    ds_read_b64_tr_b16 v[208:209], v5 offset:20480
    ds_read_b64_tr_b16 v[210:211], v5 offset:20992
    ds_read_b64_tr_b16 v[212:213], v6 offset:20480
    ds_read_b64_tr_b16 v[214:215], v6 offset:20992
    v_mul_f32 v146, v146, v8
    v_mul_f32 v147, v147, v8
    v_mul_f32 v148, v148, v8
    v_mfma_f32_32x32x16_bf16 v[176:191], v[220:223], v[44:47], v[176:191]
    s_waitcnt lgkmcnt(15)
    v_mul_f32 v149, v149, v8
    v_mul_f32 v150, v150, v8
    v_mul_f32 v151, v151, v8
    v_mul_f32 v152, v152, v8
    v_mul_f32 v153, v153, v8
    v_mul_f32 v154, v154, v8
    v_mul_f32 v155, v155, v8
    v_mul_f32 v156, v156, v9
    v_mfma_f32_32x32x16_bf16 v[160:175], v[192:195], v[48:51], v[160:175]
    ds_read_b64_tr_b16 v[216:217], v5 offset:22528
    ds_read_b64_tr_b16 v[218:219], v5 offset:23040
    ds_read_b64_tr_b16 v[220:221], v6 offset:22528
    ds_read_b64_tr_b16 v[222:223], v6 offset:23040
    ds_read_b32 v12, v0 offset:176
    v_mul_f32 v157, v157, v9
    v_mul_f32 v158, v158, v9
    v_mul_f32 v159, v159, v9
    v_mfma_f32_32x32x16_bf16 v[176:191], v[196:199], v[48:51], v[176:191]
    s_waitcnt lgkmcnt(15)
    v_cvt_pk_bf16_f32 v240, v144, v145
    v_cvt_pk_bf16_f32 v241, v146, v147
    v_cvt_pk_bf16_f32 v242, v148, v149
    v_cvt_pk_bf16_f32 v243, v150, v151
    v_cvt_pk_bf16_f32 v244, v152, v153
    v_cvt_pk_bf16_f32 v245, v154, v155
    v_cvt_pk_bf16_f32 v246, v156, v157
    v_mfma_f32_32x32x16_bf16 v[160:175], v[200:203], v[52:55], v[160:175]
    ds_read_b64_tr_b16 v[192:193], v5 offset:24576
    ds_read_b64_tr_b16 v[194:195], v5 offset:25088
    ds_read_b64_tr_b16 v[196:197], v6 offset:24576
    ds_read_b64_tr_b16 v[198:199], v6 offset:25088
    v_cvt_pk_bf16_f32 v247, v158, v159
    v_and_b32 v251, 31, v1
    s_lshl_b32 s50, s3, 5
    v_mfma_f32_32x32x16_bf16 v[176:191], v[204:207], v[52:55], v[176:191]
    s_waitcnt lgkmcnt(9)
    v_add_u32 v251, s50, v251
    v_lshrrev_b32 v252, 5, v1
    v_lshlrev_b32 v252, 3, v252
    v_mul_u32_u24 v10, 72, v251
    v_add_u32 v10, v10, v252
    v_add_u32 v10, 28672, v10
    v_mul_u32_u24 v13, 112, v251
    v_add_u32 v13, v13, v252
    v_mfma_f32_32x32x16_bf16 v[144:159], v[232:235], v[240:243], 0
    v_mfma_f32_32x32x16_bf16 v[144:159], v[236:239], v[244:247], v[144:159]
    v_mfma_f32_32x32x16_bf16 v[160:175], v[208:211], v[56:59], v[160:175]
    ds_read_b64_tr_b16 v[200:201], v5 offset:26624
    ds_read_b64_tr_b16 v[202:203], v5 offset:27136
    ds_read_b64_tr_b16 v[204:205], v6 offset:26624
    ds_read_b64_tr_b16 v[206:207], v6 offset:27136
    ds_write_b32 v0, v0 offset:48
    v_mfma_f32_32x32x16_bf16 v[176:191], v[212:215], v[56:59], v[176:191]
    s_waitcnt lgkmcnt(10)
    s_waitcnt lgkmcnt(9)
    v_readfirstlane_b32 s58, v12
    s_nop 0
    s_cmp_ge_u32 s58, 4
    s_cbranch_scc0 L_ck56
L_ck55:
    v_add_u32 v5, 57344, v3
    v_add_u32 v6, 57344, v4
    v_mfma_f32_32x32x16_bf16 v[160:175], v[216:219], v[60:63], v[160:175]
    ds_read_b64_tr_b16 v[208:209], v5 offset:0
    ds_read_b64_tr_b16 v[210:211], v5 offset:512
    ds_read_b64_tr_b16 v[212:213], v6 offset:0
    ds_read_b64_tr_b16 v[214:215], v6 offset:512
    v_cndmask_b32 v156, v156, v152, s[54:55]
    v_cndmask_b32 v157, v157, v153, s[54:55]
    v_mfma_f32_32x32x16_bf16 v[176:191], v[220:223], v[60:63], v[176:191]
    s_waitcnt lgkmcnt(9)
    v_cndmask_b32 v158, v158, v154, s[54:55]
    v_cndmask_b32 v159, v159, v155, s[54:55]
    v_max3_f32 v248, v144, v145, v146
    v_max3_f32 v248, v248, v147, v148
    v_mfma_f32_32x32x16_bf16 v[160:175], v[192:195], v[64:67], v[160:175]
    ds_read_b64_tr_b16 v[216:217], v5 offset:2048
    ds_read_b64_tr_b16 v[218:219], v5 offset:2560
    ds_read_b64_tr_b16 v[220:221], v6 offset:2048
    ds_read_b64_tr_b16 v[222:223], v6 offset:2560
    v_max3_f32 v248, v248, v149, v150
    v_max3_f32 v248, v248, v151, v152
    v_mfma_f32_32x32x16_bf16 v[176:191], v[196:199], v[64:67], v[176:191]
    s_waitcnt lgkmcnt(9)
    v_max3_f32 v248, v248, v153, v154
    v_max3_f32 v248, v248, v155, v156
    v_max3_f32 v248, v248, v157, v158
    v_min3_f32 v250, v144, v145, v146
    v_mfma_f32_32x32x16_bf16 v[160:175], v[200:203], v[68:71], v[160:175]
    ds_read_b64_tr_b16 v[192:193], v5 offset:4096
    ds_read_b64_tr_b16 v[194:195], v5 offset:4608
    ds_read_b64_tr_b16 v[196:197], v6 offset:4096
    ds_read_b64_tr_b16 v[198:199], v6 offset:4608
    v_min3_f32 v250, v250, v147, v148
    v_min3_f32 v250, v250, v149, v150
    v_mfma_f32_32x32x16_bf16 v[176:191], v[204:207], v[68:71], v[176:191]
    s_waitcnt lgkmcnt(8)
    v_min3_f32 v250, v250, v151, v152
    v_min3_f32 v250, v250, v153, v154
    v_min3_f32 v250, v250, v155, v156
    v_min3_f32 v250, v250, v157, v158
    v_max_f32 v248, v248, v159
    v_mfma_f32_32x32x16_bf16 v[160:175], v[208:211], v[72:75], v[160:175]
    ds_read_b64_tr_b16 v[200:201], v5 offset:6144
    ds_read_b64_tr_b16 v[202:203], v5 offset:6656
    ds_read_b64_tr_b16 v[204:205], v6 offset:6144
    ds_read_b64_tr_b16 v[206:207], v6 offset:6656
    v_min_f32 v250, v250, v159
    v_mov_b32 v249, v248
    v_mfma_f32_32x32x16_bf16 v[176:191], v[212:215], v[72:75], v[176:191]
    s_waitcnt lgkmcnt(8)
    v_mov_b32 v251, v250
    v_permlane32_swap_b32 v248, v249
    s_nop 0
    v_permlane32_swap_b32 v250, v251
    v_max_f32 v248, v248, v249
    v_mfma_f32_32x32x16_bf16 v[160:175], v[216:219], v[76:79], v[160:175]
    ds_read_b64_tr_b16 v[208:209], v5 offset:8192
    ds_read_b64_tr_b16 v[210:211], v5 offset:8704
    ds_read_b64_tr_b16 v[212:213], v6 offset:8192
    ds_read_b64_tr_b16 v[214:215], v6 offset:8704
    v_min_f32 v250, v250, v251
    v_mul_f32 v248, 0xbfb8aa3b, v248
    v_mfma_f32_32x32x16_bf16 v[176:191], v[220:223], v[76:79], v[176:191]
    s_waitcnt lgkmcnt(8)
    v_mul_f32 v250, 0x3fb8aa3b, v250
    v_fma_f32 v128, v144, s62, v248
    v_fma_f32 v129, v145, s62, v248
    v_fma_f32 v130, v146, s62, v248
    v_fma_f32 v131, v147, s62, v248
    v_mfma_f32_32x32x16_bf16 v[160:175], v[192:195], v[80:83], v[160:175]
    ds_read_b64_tr_b16 v[216:217], v5 offset:10240
    ds_read_b64_tr_b16 v[218:219], v5 offset:10752
    ds_read_b64_tr_b16 v[220:221], v6 offset:10240
    ds_read_b64_tr_b16 v[222:223], v6 offset:10752
    v_fma_f32 v132, v148, s62, v248
    v_fma_f32 v133, v149, s62, v248
    v_mfma_f32_32x32x16_bf16 v[176:191], v[196:199], v[80:83], v[176:191]
    s_waitcnt lgkmcnt(8)
    v_fma_f32 v134, v150, s62, v248
    v_fma_f32 v135, v151, s62, v248
    v_fma_f32 v136, v152, s62, v248
    v_fma_f32 v137, v153, s62, v248
    v_mfma_f32_32x32x16_bf16 v[160:175], v[200:203], v[84:87], v[160:175]
    ds_read_b64_tr_b16 v[192:193], v5 offset:12288
    ds_read_b64_tr_b16 v[194:195], v5 offset:12800
    ds_read_b64_tr_b16 v[196:197], v6 offset:12288
    ds_read_b64_tr_b16 v[198:199], v6 offset:12800
    v_fma_f32 v138, v154, s62, v248
    v_fma_f32 v139, v155, s62, v248
    v_mfma_f32_32x32x16_bf16 v[176:191], v[204:207], v[84:87], v[176:191]
    s_waitcnt lgkmcnt(8)
    v_fma_f32 v140, v156, s62, v248
    v_fma_f32 v141, v157, s62, v248
    v_fma_f32 v142, v158, s62, v248
    v_fma_f32 v143, v159, s62, v248
    v_exp_f32 v128, v128
    v_mfma_f32_32x32x16_bf16 v[160:175], v[208:211], v[88:91], v[160:175]
    ds_read_b64_tr_b16 v[200:201], v5 offset:14336
    ds_read_b64_tr_b16 v[202:203], v5 offset:14848
    ds_read_b64_tr_b16 v[204:205], v6 offset:14336
    ds_read_b64_tr_b16 v[206:207], v6 offset:14848
    v_exp_f32 v129, v129
    v_exp_f32 v130, v130
    v_mfma_f32_32x32x16_bf16 v[176:191], v[212:215], v[88:91], v[176:191]
    s_waitcnt lgkmcnt(8)
    v_exp_f32 v131, v131
    v_exp_f32 v132, v132
    v_exp_f32 v133, v133
    v_exp_f32 v134, v134
    v_mfma_f32_32x32x16_bf16 v[160:175], v[216:219], v[92:95], v[160:175]
    ds_read_b64_tr_b16 v[208:209], v5 offset:16384
    ds_read_b64_tr_b16 v[210:211], v5 offset:16896
    ds_read_b64_tr_b16 v[212:213], v6 offset:16384
    ds_read_b64_tr_b16 v[214:215], v6 offset:16896
    v_exp_f32 v135, v135
    v_exp_f32 v136, v136
    v_mfma_f32_32x32x16_bf16 v[176:191], v[220:223], v[92:95], v[176:191]
    s_waitcnt lgkmcnt(8)
    v_exp_f32 v137, v137
    v_exp_f32 v138, v138
    v_exp_f32 v139, v139
    v_exp_f32 v140, v140
    v_exp_f32 v141, v141
    v_mfma_f32_32x32x16_bf16 v[160:175], v[192:195], v[96:99], v[160:175]
    ds_read_b64_tr_b16 v[216:217], v5 offset:18432
    ds_read_b64_tr_b16 v[218:219], v5 offset:18944
    ds_read_b64_tr_b16 v[220:221], v6 offset:18432
    ds_read_b64_tr_b16 v[222:223], v6 offset:18944
    v_exp_f32 v142, v142
    v_mfma_f32_32x32x16_bf16 v[176:191], v[196:199], v[96:99], v[176:191]
    s_waitcnt lgkmcnt(8)
    v_exp_f32 v143, v143
    v_add_f32 v253, v140, v141
    v_add_f32 v252, v128, v129
    v_add_f32 v253, v253, v142
    v_add_f32 v252, v252, v130
    v_mfma_f32_32x32x16_bf16 v[160:175], v[200:203], v[100:103], v[160:175]
    ds_read_b64_tr_b16 v[192:193], v5 offset:20480
    ds_read_b64_tr_b16 v[194:195], v5 offset:20992
    ds_read_b64_tr_b16 v[196:197], v6 offset:20480
    ds_read_b64_tr_b16 v[198:199], v6 offset:20992
    v_add_f32 v253, v253, v143
    v_add_f32 v252, v252, v131
    v_mfma_f32_32x32x16_bf16 v[176:191], v[204:207], v[100:103], v[176:191]
    s_waitcnt lgkmcnt(8)
    v_cndmask_b32 v253, v253, 0, s[54:55]
    v_add_f32 v252, v252, v132
    v_add_f32 v253, v253, v133
    v_add_f32 v252, v252, v134
    v_add_f32 v253, v253, v135
    v_mfma_f32_32x32x16_bf16 v[160:175], v[208:211], v[104:107], v[160:175]
    ds_read_b64_tr_b16 v[200:201], v5 offset:22528
    ds_read_b64_tr_b16 v[202:203], v5 offset:23040
    ds_read_b64_tr_b16 v[204:205], v6 offset:22528
    ds_read_b64_tr_b16 v[206:207], v6 offset:23040
    ds_read_b32 v12, v0 offset:192
    v_add_f32 v252, v252, v136
    v_add_f32 v253, v253, v137
    v_mfma_f32_32x32x16_bf16 v[176:191], v[212:215], v[104:107], v[176:191]
    s_waitcnt lgkmcnt(9)
    v_add_f32 v252, v252, v138
    v_add_f32 v253, v253, v139
    v_add_f32 v252, v252, v253
    v_mov_b32 v253, v252
    v_mfma_f32_32x32x16_bf16 v[160:175], v[216:219], v[108:111], v[160:175]
    ds_read_b64_tr_b16 v[208:209], v5 offset:24576
    ds_read_b64_tr_b16 v[210:211], v5 offset:25088
    ds_read_b64_tr_b16 v[212:213], v6 offset:24576
    ds_read_b64_tr_b16 v[214:215], v6 offset:25088
    v_permlane32_swap_b32 v252, v253
    v_add_f32 v252, v252, v253
    v_mfma_f32_32x32x16_bf16 v[176:191], v[220:223], v[108:111], v[176:191]
    s_waitcnt lgkmcnt(9)
    v_rcp_f32 v252, v252
    s_nop 0
    v_mul_f32 v128, v128, v252
    v_mul_f32 v129, v129, v252
    v_mul_f32 v130, v130, v252
    v_mul_f32 v131, v131, v252
    v_mfma_f32_32x32x16_bf16 v[160:175], v[192:195], v[112:115], v[160:175]
    ds_read_b64_tr_b16 v[216:217], v5 offset:26624
    ds_read_b64_tr_b16 v[218:219], v5 offset:27136
    ds_read_b64_tr_b16 v[220:221], v6 offset:26624
    ds_read_b64_tr_b16 v[222:223], v6 offset:27136
    ds_write_b32 v0, v0 offset:64
    v_mul_f32 v132, v132, v252
    v_mul_f32 v133, v133, v252
    v_mul_f32 v134, v134, v252
    v_mul_f32 v135, v135, v252
    v_mfma_f32_32x32x16_bf16 v[176:191], v[196:199], v[112:115], v[176:191]
    s_waitcnt lgkmcnt(10)
    v_mul_f32 v136, v136, v252
    v_mul_f32 v137, v137, v252
    v_mov_b32 v244, 163328
    ds_read_b128 v[240:243], v244 offset:48
    s_waitcnt lgkmcnt(10)
    v_readfirstlane_b32 s58, v12
    s_nop 0
    s_cmp_ge_u32 s58, 4
    s_cbranch_scc0 L_ck62
L_ck61:
    v_add_u32 v5, 86016, v3
    v_add_u32 v6, 86016, v4
    v_mfma_f32_32x32x16_bf16 v[160:175], v[200:203], v[116:119], v[160:175]
    ds_read_b64_tr_b16 v[192:193], v5 offset:0
    ds_read_b64_tr_b16 v[194:195], v5 offset:512
    ds_read_b64_tr_b16 v[196:197], v6 offset:0
    ds_read_b64_tr_b16 v[198:199], v6 offset:512
    v_mul_f32 v138, v138, v252
    v_mul_f32 v139, v139, v252
    v_mfma_f32_32x32x16_bf16 v[176:191], v[204:207], v[116:119], v[176:191]
    s_waitcnt lgkmcnt(10)
    v_mul_f32 v140, v140, v252
    v_mul_f32 v141, v141, v252
    v_mul_f32 v142, v142, v252
    v_mul_f32 v143, v143, v252
    v_cvt_pk_bf16_f32 v128, v128, v129
    v_mfma_f32_32x32x16_bf16 v[160:175], v[208:211], v[120:123], v[160:175]
    ds_read_b64_tr_b16 v[200:201], v5 offset:2048
    ds_read_b64_tr_b16 v[202:203], v5 offset:2560
    ds_read_b64_tr_b16 v[204:205], v6 offset:2048
    ds_read_b64_tr_b16 v[206:207], v6 offset:2560
    v_cvt_pk_bf16_f32 v129, v130, v131
    v_cvt_pk_bf16_f32 v130, v132, v133
    v_mfma_f32_32x32x16_bf16 v[176:191], v[212:215], v[120:123], v[176:191]
    s_waitcnt lgkmcnt(10)
    v_cvt_pk_bf16_f32 v131, v134, v135
    v_cvt_pk_bf16_f32 v132, v136, v137
    v_cvt_pk_bf16_f32 v133, v138, v139
    v_cvt_pk_bf16_f32 v134, v140, v141
    s_waitcnt lgkmcnt(8)
    v_min3_u32 v240, v240, v241, v242
    v_min_u32 v240, v240, v243
    s_nop 0
    v_readfirstlane_b32 s58, v240
    s_nop 0
    s_cmp_lg_u32 s58, 0
    s_cbranch_scc0 L_cf50
L_cf49:
    v_mfma_f32_32x32x16_bf16 v[160:175], v[216:219], v[124:127], v[160:175]
    ds_read_b64_tr_b16 v[208:209], v5 offset:4096
    ds_read_b64_tr_b16 v[210:211], v5 offset:4608
    ds_read_b64_tr_b16 v[212:213], v6 offset:4096
    ds_read_b64_tr_b16 v[214:215], v6 offset:4608
    v_cvt_pk_bf16_f32 v135, v142, v143
    ds_write_b64 v13, v[128:129] offset:14336
    ds_write_b64 v13, v[130:131] offset:14352
    v_mfma_f32_32x32x16_bf16 v[176:191], v[220:223], v[124:127], v[176:191]
    s_waitcnt lgkmcnt(10)
    ds_write_b64 v13, v[132:133] offset:14368
    s_mov_b64 exec, 0xffffffff
    ds_write_b64 v13, v[134:135] offset:14384
    s_mov_b64 exec, -1
    v_fma_f32 v144, -v144, s62, v250
    v_fma_f32 v145, -v145, s62, v250
    v_fma_f32 v146, -v146, s62, v250
    v_fma_f32 v147, -v147, s62, v250
    v_fma_f32 v148, -v148, s62, v250
    v_fma_f32 v149, -v149, s62, v250
    v_fma_f32 v150, -v150, s62, v250
    v_fma_f32 v151, -v151, s62, v250
    v_fma_f32 v152, -v152, s62, v250
    v_fma_f32 v153, -v153, s62, v250
    v_fma_f32 v154, -v154, s62, v250
    v_fma_f32 v155, -v155, s62, v250
    v_fma_f32 v156, -v156, s62, v250
    v_fma_f32 v157, -v157, s62, v250
    v_fma_f32 v158, -v158, s62, v250
    v_fma_f32 v159, -v159, s62, v250
    v_mov_b32 v255, 0x3f80
    v_mul_f32 v160, v160, v8
    v_mul_f32 v161, v161, v8
    v_mul_f32 v162, v162, v8
    v_mul_f32 v163, v163, v8
    v_mul_f32 v164, v164, v8
    v_mul_f32 v165, v165, v8
    v_mul_f32 v166, v166, v8
    v_mul_f32 v167, v167, v8
    v_mul_f32 v168, v168, v8
    v_mul_f32 v169, v169, v8
    v_mul_f32 v170, v170, v8
    v_mul_f32 v171, v171, v8
    v_mul_f32 v172, v172, v8
    v_mul_f32 v173, v173, v8
    v_mul_f32 v174, v174, v8
    v_mul_f32 v175, v175, v8
    v_cvt_pk_bf16_f32 v240, v160, v161
    v_cvt_pk_bf16_f32 v241, v162, v163
    v_cvt_pk_bf16_f32 v242, v164, v165
    v_cvt_pk_bf16_f32 v243, v166, v167
    v_cvt_pk_bf16_f32 v244, v168, v169
    v_cvt_pk_bf16_f32 v245, v170, v171
    v_cvt_pk_bf16_f32 v246, v172, v173
    v_cvt_pk_bf16_f32 v247, v174, v175
    v_cndmask_b32 v246, v246, v255, s[54:55]
    v_cndmask_b32 v247, v247, 0, s[54:55]
    ds_write_b64 v10, v[240:241] offset:0
    ds_write_b64 v10, v[242:243] offset:16
    ds_write_b64 v10, v[244:245] offset:32
    ds_write_b64 v10, v[246:247] offset:48
    v_mul_f32 v176, v176, v8
    v_mul_f32 v177, v177, v8
    v_mul_f32 v178, v178, v8
    v_mul_f32 v179, v179, v8
    v_mul_f32 v180, v180, v8
    v_mul_f32 v181, v181, v8
    v_mul_f32 v182, v182, v8
    v_mul_f32 v183, v183, v8
    v_mul_f32 v184, v184, v8
    v_mul_f32 v185, v185, v8
    v_mul_f32 v186, v186, v8
    v_mul_f32 v187, v187, v8
    v_mul_f32 v188, v188, v8
    v_mul_f32 v189, v189, v8
    v_mul_f32 v190, v190, v8
    v_mul_f32 v191, v191, v8
    v_cvt_pk_bf16_f32 v240, v176, v177
    v_cvt_pk_bf16_f32 v241, v178, v179
    v_cvt_pk_bf16_f32 v242, v180, v181
    v_cvt_pk_bf16_f32 v243, v182, v183
    v_cvt_pk_bf16_f32 v244, v184, v185
    v_cvt_pk_bf16_f32 v245, v186, v187
    v_cvt_pk_bf16_f32 v246, v188, v189
    v_cvt_pk_bf16_f32 v247, v190, v191
    v_cndmask_b32 v246, v246, v255, s[54:55]
    v_cndmask_b32 v247, v247, 0, s[54:55]
    ds_write_b64 v10, v[240:241] offset:9216
    ds_write_b64 v10, v[242:243] offset:9232
    ds_write_b64 v10, v[244:245] offset:9248
    ds_write_b64 v10, v[246:247] offset:9264
    v_exp_f32 v144, v144
    v_exp_f32 v145, v145
    v_exp_f32 v146, v146
    v_exp_f32 v147, v147
    v_exp_f32 v148, v148
    v_exp_f32 v149, v149
    v_exp_f32 v150, v150
    v_exp_f32 v151, v151
    v_exp_f32 v152, v152
    v_exp_f32 v153, v153
    v_exp_f32 v154, v154
    v_exp_f32 v155, v155
    v_exp_f32 v156, v156
    v_exp_f32 v157, v157
    v_exp_f32 v158, v158
    v_exp_f32 v159, v159
    v_add_f32 v253, v156, v157
    v_add_f32 v252, v144, v145
    v_add_f32 v253, v253, v158
    v_add_f32 v252, v252, v146
    v_add_f32 v253, v253, v159
    v_add_f32 v252, v252, v147
    v_cndmask_b32 v253, v253, 0, s[54:55]
    v_add_f32 v252, v252, v148
    v_add_f32 v253, v253, v149
    v_add_f32 v252, v252, v150
    v_add_f32 v253, v253, v151
    v_add_f32 v252, v252, v152
    v_add_f32 v253, v253, v153
    v_add_f32 v252, v252, v154
    v_add_f32 v253, v253, v155
    v_add_f32 v252, v252, v253
    v_mov_b32 v253, v252
    s_nop 1
    v_permlane32_swap_b32 v252, v253
    v_add_f32 v252, v252, v253
    v_rcp_f32 v252, v252
    s_nop 0
    v_mul_f32 v144, v144, v252
    v_mul_f32 v145, v145, v252
    v_mul_f32 v146, v146, v252
    v_mul_f32 v147, v147, v252
    v_mul_f32 v148, v148, v252
    v_mul_f32 v149, v149, v252
    v_mul_f32 v150, v150, v252
    v_mul_f32 v151, v151, v252
    v_mul_f32 v152, v152, v252
    v_mul_f32 v153, v153, v252
    v_mul_f32 v154, v154, v252
    v_mul_f32 v155, v155, v252
    v_mul_f32 v156, v156, v252
    v_mul_f32 v157, v157, v252
    v_mul_f32 v158, v158, v252
    v_mul_f32 v159, v159, v252
    v_cvt_pk_bf16_f32 v144, v144, v145
    v_cvt_pk_bf16_f32 v145, v146, v147
    v_cvt_pk_bf16_f32 v146, v148, v149
    v_cvt_pk_bf16_f32 v147, v150, v151
    v_cvt_pk_bf16_f32 v148, v152, v153
    v_cvt_pk_bf16_f32 v149, v154, v155
    v_cvt_pk_bf16_f32 v150, v156, v157
    v_cvt_pk_bf16_f32 v151, v158, v159
    ds_write_b64 v13, v[144:145] offset:14392
    ds_write_b64 v13, v[146:147] offset:14408
    ds_write_b64 v13, v[148:149] offset:14424
    s_mov_b64 exec, 0xffffffff
    ds_write_b64 v13, v[150:151] offset:14440
    s_mov_b64 exec, -1
    ds_write_b32 v0, v0 offset:112
    v_mfma_f32_32x32x16_bf16 v[128:143], v[192:195], v[16:19], 0
    ds_read_b64_tr_b16 v[216:217], v5 offset:6144
    ds_read_b64_tr_b16 v[218:219], v5 offset:6656
    ds_read_b64_tr_b16 v[220:221], v6 offset:6144
    ds_read_b64_tr_b16 v[222:223], v6 offset:6656
    v_mfma_f32_32x32x16_bf16 v[144:159], v[196:199], v[16:19], 0
    s_waitcnt lgkmcnt(15)
    v_mfma_f32_32x32x16_bf16 v[128:143], v[200:203], v[20:23], v[128:143]
    ds_read_b64_tr_b16 v[192:193], v5 offset:8192
    ds_read_b64_tr_b16 v[194:195], v5 offset:8704
    ds_read_b64_tr_b16 v[196:197], v6 offset:8192
    ds_read_b64_tr_b16 v[198:199], v6 offset:8704
    v_mfma_f32_32x32x16_bf16 v[144:159], v[204:207], v[20:23], v[144:159]
    v_mfma_f32_32x32x16_bf16 v[128:143], v[208:211], v[24:27], v[128:143]
    ds_read_b64_tr_b16 v[200:201], v5 offset:10240
    ds_read_b64_tr_b16 v[202:203], v5 offset:10752
    ds_read_b64_tr_b16 v[204:205], v6 offset:10240
    ds_read_b64_tr_b16 v[206:207], v6 offset:10752
    v_mfma_f32_32x32x16_bf16 v[144:159], v[212:215], v[24:27], v[144:159]
    s_waitcnt lgkmcnt(8)
    v_mfma_f32_32x32x16_bf16 v[128:143], v[216:219], v[28:31], v[128:143]
    ds_read_b64_tr_b16 v[208:209], v5 offset:12288
    ds_read_b64_tr_b16 v[210:211], v5 offset:12800
    ds_read_b64_tr_b16 v[212:213], v6 offset:12288
    ds_read_b64_tr_b16 v[214:215], v6 offset:12800
    v_mfma_f32_32x32x16_bf16 v[144:159], v[220:223], v[28:31], v[144:159]
    s_waitcnt lgkmcnt(8)
    v_mfma_f32_32x32x16_bf16 v[128:143], v[192:195], v[32:35], v[128:143]
    ds_read_b64_tr_b16 v[216:217], v5 offset:14336
    ds_read_b64_tr_b16 v[218:219], v5 offset:14848
    ds_read_b64_tr_b16 v[220:221], v6 offset:14336
    ds_read_b64_tr_b16 v[222:223], v6 offset:14848
    v_mfma_f32_32x32x16_bf16 v[144:159], v[196:199], v[32:35], v[144:159]
    s_waitcnt lgkmcnt(8)
    v_mfma_f32_32x32x16_bf16 v[128:143], v[200:203], v[36:39], v[128:143]
    ds_read_b64_tr_b16 v[192:193], v5 offset:16384
    ds_read_b64_tr_b16 v[194:195], v5 offset:16896
    ds_read_b64_tr_b16 v[196:197], v6 offset:16384
    ds_read_b64_tr_b16 v[198:199], v6 offset:16896
    v_mfma_f32_32x32x16_bf16 v[144:159], v[204:207], v[36:39], v[144:159]
    s_waitcnt lgkmcnt(8)
    v_mfma_f32_32x32x16_bf16 v[128:143], v[208:211], v[40:43], v[128:143]
    ds_read_b64_tr_b16 v[200:201], v5 offset:18432
    ds_read_b64_tr_b16 v[202:203], v5 offset:18944
    ds_read_b64_tr_b16 v[204:205], v6 offset:18432
    ds_read_b64_tr_b16 v[206:207], v6 offset:18944
    v_mfma_f32_32x32x16_bf16 v[144:159], v[212:215], v[40:43], v[144:159]
    s_waitcnt lgkmcnt(8)
    v_mfma_f32_32x32x16_bf16 v[128:143], v[216:219], v[44:47], v[128:143]
    ds_read_b64_tr_b16 v[208:209], v5 offset:20480
    ds_read_b64_tr_b16 v[210:211], v5 offset:20992
    ds_read_b64_tr_b16 v[212:213], v6 offset:20480
    ds_read_b64_tr_b16 v[214:215], v6 offset:20992
    v_mfma_f32_32x32x16_bf16 v[144:159], v[220:223], v[44:47], v[144:159]
    s_waitcnt lgkmcnt(8)
    v_mfma_f32_32x32x16_bf16 v[128:143], v[192:195], v[48:51], v[128:143]
    ds_read_b64_tr_b16 v[216:217], v5 offset:22528
    ds_read_b64_tr_b16 v[218:219], v5 offset:23040
    ds_read_b64_tr_b16 v[220:221], v6 offset:22528
    ds_read_b64_tr_b16 v[222:223], v6 offset:23040
    ds_read_b32 v12, v0 offset:208
    v_mfma_f32_32x32x16_bf16 v[144:159], v[196:199], v[48:51], v[144:159]
    s_waitcnt lgkmcnt(9)
    v_mfma_f32_32x32x16_bf16 v[128:143], v[200:203], v[52:55], v[128:143]
    ds_read_b64_tr_b16 v[192:193], v5 offset:24576
    ds_read_b64_tr_b16 v[194:195], v5 offset:25088
    ds_read_b64_tr_b16 v[196:197], v6 offset:24576
    ds_read_b64_tr_b16 v[198:199], v6 offset:25088
    v_mfma_f32_32x32x16_bf16 v[144:159], v[204:207], v[52:55], v[144:159]
    s_waitcnt lgkmcnt(9)
    v_mfma_f32_32x32x16_bf16 v[128:143], v[208:211], v[56:59], v[128:143]
    ds_read_b64_tr_b16 v[200:201], v5 offset:26624
    ds_read_b64_tr_b16 v[202:203], v5 offset:27136
    ds_read_b64_tr_b16 v[204:205], v6 offset:26624
    ds_read_b64_tr_b16 v[206:207], v6 offset:27136
    v_mfma_f32_32x32x16_bf16 v[144:159], v[212:215], v[56:59], v[144:159]
    s_waitcnt lgkmcnt(9)
    s_waitcnt lgkmcnt(8)
    v_readfirstlane_b32 s58, v12
    s_nop 0
    s_cmp_ge_u32 s58, 4
    s_cbranch_scc0 L_ck68
L_ck67:
    v_add_u32 v5, 114688, v3
    v_add_u32 v6, 114688, v4
    v_mfma_f32_32x32x16_bf16 v[128:143], v[216:219], v[60:63], v[128:143]
    ds_read_b64_tr_b16 v[208:209], v5 offset:0
    ds_read_b64_tr_b16 v[210:211], v5 offset:512
    ds_read_b64_tr_b16 v[212:213], v6 offset:0
    ds_read_b64_tr_b16 v[214:215], v6 offset:512
    v_mfma_f32_32x32x16_bf16 v[144:159], v[220:223], v[60:63], v[144:159]
    s_waitcnt lgkmcnt(8)
    v_mfma_f32_32x32x16_bf16 v[128:143], v[192:195], v[64:67], v[128:143]
    ds_read_b64_tr_b16 v[216:217], v5 offset:2048
    ds_read_b64_tr_b16 v[218:219], v5 offset:2560
    ds_read_b64_tr_b16 v[220:221], v6 offset:2048
    ds_read_b64_tr_b16 v[222:223], v6 offset:2560
    v_mfma_f32_32x32x16_bf16 v[144:159], v[196:199], v[64:67], v[144:159]
    s_waitcnt lgkmcnt(8)
    v_mfma_f32_32x32x16_bf16 v[128:143], v[200:203], v[68:71], v[128:143]
    ds_read_b64_tr_b16 v[192:193], v5 offset:4096
    ds_read_b64_tr_b16 v[194:195], v5 offset:4608
    ds_read_b64_tr_b16 v[196:197], v6 offset:4096
    ds_read_b64_tr_b16 v[198:199], v6 offset:4608
    v_mfma_f32_32x32x16_bf16 v[144:159], v[204:207], v[68:71], v[144:159]
    s_waitcnt lgkmcnt(8)
    v_mfma_f32_32x32x16_bf16 v[128:143], v[208:211], v[72:75], v[128:143]
    ds_read_b64_tr_b16 v[200:201], v5 offset:6144
    ds_read_b64_tr_b16 v[202:203], v5 offset:6656
    ds_read_b64_tr_b16 v[204:205], v6 offset:6144
    ds_read_b64_tr_b16 v[206:207], v6 offset:6656
    v_mfma_f32_32x32x16_bf16 v[144:159], v[212:215], v[72:75], v[144:159]
    s_waitcnt lgkmcnt(8)
    v_mfma_f32_32x32x16_bf16 v[128:143], v[216:219], v[76:79], v[128:143]
    ds_read_b64_tr_b16 v[208:209], v5 offset:8192
    ds_read_b64_tr_b16 v[210:211], v5 offset:8704
    ds_read_b64_tr_b16 v[212:213], v6 offset:8192
    ds_read_b64_tr_b16 v[214:215], v6 offset:8704
    v_mfma_f32_32x32x16_bf16 v[144:159], v[220:223], v[76:79], v[144:159]
    s_waitcnt lgkmcnt(8)
    v_mfma_f32_32x32x16_bf16 v[128:143], v[192:195], v[80:83], v[128:143]
    ds_read_b64_tr_b16 v[216:217], v5 offset:10240
    ds_read_b64_tr_b16 v[218:219], v5 offset:10752
    ds_read_b64_tr_b16 v[220:221], v6 offset:10240
    ds_read_b64_tr_b16 v[222:223], v6 offset:10752
    v_mfma_f32_32x32x16_bf16 v[144:159], v[196:199], v[80:83], v[144:159]
    s_waitcnt lgkmcnt(8)
    v_mfma_f32_32x32x16_bf16 v[128:143], v[200:203], v[84:87], v[128:143]
    ds_read_b64_tr_b16 v[192:193], v5 offset:12288
    ds_read_b64_tr_b16 v[194:195], v5 offset:12800
    ds_read_b64_tr_b16 v[196:197], v6 offset:12288
    ds_read_b64_tr_b16 v[198:199], v6 offset:12800
    v_mfma_f32_32x32x16_bf16 v[144:159], v[204:207], v[84:87], v[144:159]
    s_waitcnt lgkmcnt(8)
    v_mfma_f32_32x32x16_bf16 v[128:143], v[208:211], v[88:91], v[128:143]
    ds_read_b64_tr_b16 v[200:201], v5 offset:14336
    ds_read_b64_tr_b16 v[202:203], v5 offset:14848
    ds_read_b64_tr_b16 v[204:205], v6 offset:14336
    ds_read_b64_tr_b16 v[206:207], v6 offset:14848
    v_mfma_f32_32x32x16_bf16 v[144:159], v[212:215], v[88:91], v[144:159]
    s_waitcnt lgkmcnt(8)
    v_mfma_f32_32x32x16_bf16 v[128:143], v[216:219], v[92:95], v[128:143]
    ds_read_b64_tr_b16 v[208:209], v5 offset:16384
    ds_read_b64_tr_b16 v[210:211], v5 offset:16896
    ds_read_b64_tr_b16 v[212:213], v6 offset:16384
    ds_read_b64_tr_b16 v[214:215], v6 offset:16896
    v_mfma_f32_32x32x16_bf16 v[144:159], v[220:223], v[92:95], v[144:159]
    s_waitcnt lgkmcnt(8)
    v_mfma_f32_32x32x16_bf16 v[128:143], v[192:195], v[96:99], v[128:143]
    ds_read_b64_tr_b16 v[216:217], v5 offset:18432
    ds_read_b64_tr_b16 v[218:219], v5 offset:18944
    ds_read_b64_tr_b16 v[220:221], v6 offset:18432
    ds_read_b64_tr_b16 v[222:223], v6 offset:18944
    v_mfma_f32_32x32x16_bf16 v[144:159], v[196:199], v[96:99], v[144:159]
    s_waitcnt lgkmcnt(8)
    ds_read_b32 v14, v0 offset:320
    v_mfma_f32_32x32x16_bf16 v[128:143], v[200:203], v[100:103], v[128:143]
    ds_read_b64_tr_b16 v[192:193], v5 offset:20480
    ds_read_b64_tr_b16 v[194:195], v5 offset:20992
    ds_read_b64_tr_b16 v[196:197], v6 offset:20480
    ds_read_b64_tr_b16 v[198:199], v6 offset:20992
    v_mfma_f32_32x32x16_bf16 v[144:159], v[204:207], v[100:103], v[144:159]
    s_waitcnt lgkmcnt(9)
    v_mfma_f32_32x32x16_bf16 v[128:143], v[208:211], v[104:107], v[128:143]
    ds_read_b64_tr_b16 v[200:201], v5 offset:22528
    ds_read_b64_tr_b16 v[202:203], v5 offset:23040
    ds_read_b64_tr_b16 v[204:205], v6 offset:22528
    ds_read_b64_tr_b16 v[206:207], v6 offset:23040
    v_mfma_f32_32x32x16_bf16 v[144:159], v[212:215], v[104:107], v[144:159]
    s_waitcnt lgkmcnt(9)
    v_mfma_f32_32x32x16_bf16 v[128:143], v[216:219], v[108:111], v[128:143]
    ds_read_b64_tr_b16 v[208:209], v5 offset:24576
    ds_read_b64_tr_b16 v[210:211], v5 offset:25088
    ds_read_b64_tr_b16 v[212:213], v6 offset:24576
    ds_read_b64_tr_b16 v[214:215], v6 offset:25088
    v_mfma_f32_32x32x16_bf16 v[144:159], v[220:223], v[108:111], v[144:159]
    s_waitcnt lgkmcnt(8)
    v_mfma_f32_32x32x16_bf16 v[128:143], v[192:195], v[112:115], v[128:143]
    ds_read_b64_tr_b16 v[216:217], v5 offset:26624
    ds_read_b64_tr_b16 v[218:219], v5 offset:27136
    ds_read_b64_tr_b16 v[220:221], v6 offset:26624
    ds_read_b64_tr_b16 v[222:223], v6 offset:27136
    v_mfma_f32_32x32x16_bf16 v[144:159], v[196:199], v[112:115], v[144:159]
    s_waitcnt lgkmcnt(8)
    v_mfma_f32_32x32x16_bf16 v[128:143], v[200:203], v[116:119], v[128:143]
    v_mfma_f32_32x32x16_bf16 v[144:159], v[204:207], v[116:119], v[144:159]
    s_waitcnt lgkmcnt(4)
    v_mfma_f32_32x32x16_bf16 v[128:143], v[208:211], v[120:123], v[128:143]
    v_mfma_f32_32x32x16_bf16 v[144:159], v[212:215], v[120:123], v[144:159]
    s_waitcnt lgkmcnt(0)
    v_mfma_f32_32x32x16_bf16 v[128:143], v[216:219], v[124:127], v[128:143]
    v_mfma_f32_32x32x16_bf16 v[144:159], v[220:223], v[124:127], v[144:159]
    ds_write_b32 v0, v0 offset:96
    v_mov_b32 v248, s62
    s_nop 8
    v_mul_f32 v128, v128, v8
    v_mul_f32 v129, v129, v8
    v_mul_f32 v130, v130, v8
    v_mul_f32 v131, v131, v8
    v_mul_f32 v132, v132, v8
    v_mul_f32 v133, v133, v8
    v_mul_f32 v134, v134, v8
    v_mul_f32 v135, v135, v8
    v_mul_f32 v136, v136, v8
    v_mul_f32 v137, v137, v8
    v_mul_f32 v138, v138, v8
    v_mul_f32 v139, v139, v8
    v_mul_f32 v140, v140, v9
    v_mul_f32 v141, v141, v9
    v_mul_f32 v142, v142, v9
    v_mul_f32 v143, v143, v9
    v_cvt_pk_bf16_f32 v240, v128, v129
    v_cvt_pk_bf16_f32 v241, v130, v131
    v_cvt_pk_bf16_f32 v242, v132, v133
    v_cvt_pk_bf16_f32 v243, v134, v135
    v_cvt_pk_bf16_f32 v244, v136, v137
    v_cvt_pk_bf16_f32 v245, v138, v139
    v_cvt_pk_bf16_f32 v246, v140, v141
    v_cvt_pk_bf16_f32 v247, v142, v143
    v_mfma_f32_32x32x16_bf16 v[128:143], v[224:227], v[240:243], 0
    s_nop 0
    v_mfma_f32_32x32x16_bf16 v[128:143], v[228:231], v[244:247], v[128:143]
    v_mul_f32 v144, v144, v8
    v_mul_f32 v145, v145, v8
    v_mul_f32 v146, v146, v8
    v_mul_f32 v147, v147, v8
    v_mul_f32 v148, v148, v8
    v_mul_f32 v149, v149, v8
    v_mul_f32 v150, v150, v8
    v_mul_f32 v151, v151, v8
    v_mul_f32 v152, v152, v8
    v_mul_f32 v153, v153, v8
    v_mul_f32 v154, v154, v8
    v_mul_f32 v155, v155, v8
    v_mul_f32 v156, v156, v9
    v_mul_f32 v157, v157, v9
    v_mul_f32 v158, v158, v9
    v_mul_f32 v159, v159, v9
    v_cvt_pk_bf16_f32 v208, v144, v145
    v_cvt_pk_bf16_f32 v209, v146, v147
    v_cvt_pk_bf16_f32 v210, v148, v149
    v_cvt_pk_bf16_f32 v211, v150, v151
    v_cvt_pk_bf16_f32 v212, v152, v153
    v_cvt_pk_bf16_f32 v213, v154, v155
    v_cvt_pk_bf16_f32 v214, v156, v157
    v_cvt_pk_bf16_f32 v215, v158, v159
    v_mfma_f32_32x32x16_bf16 v[144:159], v[232:235], v[208:211], 0
    s_nop 0
    v_mfma_f32_32x32x16_bf16 v[144:159], v[236:239], v[212:215], v[144:159]
    v_and_b32 v8, 31, v1
    v_mul_u32_u24 v3, 896, v8
    v_lshrrev_b32 v8, 5, v1
    v_lshl_add_u32 v3, v8, 4, v3
    s_and_b32 s50, s59, 1
    s_lshl_b32 s51, s40, 1
    s_add_u32 s50, s50, s51
    s_mul_i32 s60, s50, 28672
    s_lshr_b32 s50, s59, 1
    s_lshl_b32 s50, s50, 6
    s_add_u32 s60, s60, s50
    s_lshl_b32 s50, s41, 7
    s_add_u32 s60, s60, s50
    buffer_load_dwordx4 v[236:239], v3, s[8:11], s60 offen offset:32
    v_cndmask_b32 v140, v140, v136, s[54:55]
    v_cndmask_b32 v141, v141, v137, s[54:55]
    v_cndmask_b32 v142, v142, v138, s[54:55]
    v_cndmask_b32 v143, v143, v139, s[54:55]
    v_max3_f32 v252, v128, v129, v130
    v_max3_f32 v252, v252, v131, v132
    v_max3_f32 v252, v252, v133, v134
    v_max3_f32 v252, v252, v135, v136
    v_max3_f32 v252, v252, v137, v138
    v_max3_f32 v252, v252, v139, v140
    v_max3_f32 v252, v252, v141, v142
    v_min3_f32 v254, v128, v129, v130
    v_min3_f32 v254, v254, v131, v132
    v_min3_f32 v254, v254, v133, v134
    v_min3_f32 v254, v254, v135, v136
    v_min3_f32 v254, v254, v137, v138
    v_min3_f32 v254, v254, v139, v140
    v_min3_f32 v254, v254, v141, v142
    v_max_f32 v252, v252, v143
    v_min_f32 v254, v254, v143
    v_mov_b32 v253, v252
    v_mov_b32 v255, v254
    s_nop 0
    v_permlane32_swap_b32 v252, v253
    v_permlane32_swap_b32 v254, v255
    v_max_f32 v252, v252, v253
    v_min_f32 v254, v254, v255
    v_mul_f32 v252, 0xbfb8aa3b, v252
    v_mul_f32 v254, 0x3fb8aa3b, v254
    v_pk_fma_f32 v[160:161], v[128:129], v[248:249], v[252:253] op_sel_hi:[1,0,0]
    v_pk_fma_f32 v[162:163], v[130:131], v[248:249], v[252:253] op_sel_hi:[1,0,0]
    v_pk_fma_f32 v[164:165], v[132:133], v[248:249], v[252:253] op_sel_hi:[1,0,0]
    v_pk_fma_f32 v[166:167], v[134:135], v[248:249], v[252:253] op_sel_hi:[1,0,0]
    v_pk_fma_f32 v[168:169], v[136:137], v[248:249], v[252:253] op_sel_hi:[1,0,0]
    v_pk_fma_f32 v[170:171], v[138:139], v[248:249], v[252:253] op_sel_hi:[1,0,0]
    v_pk_fma_f32 v[172:173], v[140:141], v[248:249], v[252:253] op_sel_hi:[1,0,0]
    v_pk_fma_f32 v[174:175], v[142:143], v[248:249], v[252:253] op_sel_hi:[1,0,0]
    v_exp_f32 v160, v160
    v_exp_f32 v161, v161
    v_exp_f32 v162, v162
    v_exp_f32 v163, v163
    v_exp_f32 v164, v164
    v_exp_f32 v165, v165
    v_exp_f32 v166, v166
    v_exp_f32 v167, v167
    v_exp_f32 v168, v168
    v_exp_f32 v169, v169
    v_exp_f32 v170, v170
    v_exp_f32 v171, v171
    v_exp_f32 v172, v172
    v_exp_f32 v173, v173
    v_exp_f32 v174, v174
    v_exp_f32 v175, v175
    v_cvt_pk_bf16_f32 v192, v160, v161
    v_cvt_pk_bf16_f32 v193, v162, v163
    v_cvt_pk_bf16_f32 v194, v164, v165
    v_cvt_pk_bf16_f32 v195, v166, v167
    v_cvt_pk_bf16_f32 v196, v168, v169
    v_cvt_pk_bf16_f32 v197, v170, v171
    v_cvt_pk_bf16_f32 v198, v172, v173
    v_cvt_pk_bf16_f32 v199, v174, v175
    v_pk_fma_f32 v[128:129], v[128:129], v[248:249], v[254:255] op_sel_hi:[1,0,0] neg_lo:[1,0,0] neg_hi:[1,0,0]
    v_pk_fma_f32 v[130:131], v[130:131], v[248:249], v[254:255] op_sel_hi:[1,0,0] neg_lo:[1,0,0] neg_hi:[1,0,0]
    v_pk_fma_f32 v[132:133], v[132:133], v[248:249], v[254:255] op_sel_hi:[1,0,0] neg_lo:[1,0,0] neg_hi:[1,0,0]
    v_pk_fma_f32 v[134:135], v[134:135], v[248:249], v[254:255] op_sel_hi:[1,0,0] neg_lo:[1,0,0] neg_hi:[1,0,0]
    v_pk_fma_f32 v[136:137], v[136:137], v[248:249], v[254:255] op_sel_hi:[1,0,0] neg_lo:[1,0,0] neg_hi:[1,0,0]
    v_pk_fma_f32 v[138:139], v[138:139], v[248:249], v[254:255] op_sel_hi:[1,0,0] neg_lo:[1,0,0] neg_hi:[1,0,0]
    v_pk_fma_f32 v[140:141], v[140:141], v[248:249], v[254:255] op_sel_hi:[1,0,0] neg_lo:[1,0,0] neg_hi:[1,0,0]
    v_pk_fma_f32 v[142:143], v[142:143], v[248:249], v[254:255] op_sel_hi:[1,0,0] neg_lo:[1,0,0] neg_hi:[1,0,0]
    v_exp_f32 v128, v128
    v_exp_f32 v129, v129
    v_exp_f32 v130, v130
    v_exp_f32 v131, v131
    v_exp_f32 v132, v132
    v_exp_f32 v133, v133
    v_exp_f32 v134, v134
    v_exp_f32 v135, v135
    v_exp_f32 v136, v136
    v_exp_f32 v137, v137
    v_exp_f32 v138, v138
    v_exp_f32 v139, v139
    v_exp_f32 v140, v140
    v_exp_f32 v141, v141
    v_exp_f32 v142, v142
    v_exp_f32 v143, v143
    v_cvt_pk_bf16_f32 v200, v128, v129
    v_cvt_pk_bf16_f32 v201, v130, v131
    v_cvt_pk_bf16_f32 v202, v132, v133
    v_cvt_pk_bf16_f32 v203, v134, v135
    v_cvt_pk_bf16_f32 v204, v136, v137
    v_cvt_pk_bf16_f32 v205, v138, v139
    v_cvt_pk_bf16_f32 v206, v140, v141
    v_cvt_pk_bf16_f32 v207, v142, v143
    v_cndmask_b32 v156, v156, v152, s[54:55]
    v_cndmask_b32 v157, v157, v153, s[54:55]
    v_cndmask_b32 v158, v158, v154, s[54:55]
    v_cndmask_b32 v159, v159, v155, s[54:55]
    v_max3_f32 v252, v144, v145, v146
    v_max3_f32 v252, v252, v147, v148
    v_max3_f32 v252, v252, v149, v150
    v_max3_f32 v252, v252, v151, v152
    v_max3_f32 v252, v252, v153, v154
    v_max3_f32 v252, v252, v155, v156
    v_max3_f32 v252, v252, v157, v158
    v_min3_f32 v254, v144, v145, v146
    v_min3_f32 v254, v254, v147, v148
    v_min3_f32 v254, v254, v149, v150
    v_min3_f32 v254, v254, v151, v152
    v_min3_f32 v254, v254, v153, v154
    v_min3_f32 v254, v254, v155, v156
    v_min3_f32 v254, v254, v157, v158
    v_max_f32 v252, v252, v159
    v_min_f32 v254, v254, v159
    v_mov_b32 v253, v252
    v_mov_b32 v255, v254
    s_nop 0
    v_permlane32_swap_b32 v252, v253
    v_permlane32_swap_b32 v254, v255
    v_max_f32 v252, v252, v253
    v_min_f32 v254, v254, v255
    v_mul_f32 v252, 0xbfb8aa3b, v252
    v_mul_f32 v254, 0x3fb8aa3b, v254
    v_pk_fma_f32 v[176:177], v[144:145], v[248:249], v[252:253] op_sel_hi:[1,0,0]
    v_pk_fma_f32 v[178:179], v[146:147], v[248:249], v[252:253] op_sel_hi:[1,0,0]
    v_pk_fma_f32 v[180:181], v[148:149], v[248:249], v[252:253] op_sel_hi:[1,0,0]
    v_pk_fma_f32 v[182:183], v[150:151], v[248:249], v[252:253] op_sel_hi:[1,0,0]
    v_pk_fma_f32 v[184:185], v[152:153], v[248:249], v[252:253] op_sel_hi:[1,0,0]
    v_pk_fma_f32 v[186:187], v[154:155], v[248:249], v[252:253] op_sel_hi:[1,0,0]
    v_pk_fma_f32 v[188:189], v[156:157], v[248:249], v[252:253] op_sel_hi:[1,0,0]
    v_pk_fma_f32 v[190:191], v[158:159], v[248:249], v[252:253] op_sel_hi:[1,0,0]
    v_exp_f32 v176, v176
    v_exp_f32 v177, v177
    v_exp_f32 v178, v178
    v_exp_f32 v179, v179
    v_exp_f32 v180, v180
    v_exp_f32 v181, v181
    v_exp_f32 v182, v182
    v_exp_f32 v183, v183
    v_exp_f32 v184, v184
    v_exp_f32 v185, v185
    v_exp_f32 v186, v186
    v_exp_f32 v187, v187
    v_exp_f32 v188, v188
    v_exp_f32 v189, v189
    v_exp_f32 v190, v190
    v_exp_f32 v191, v191
    v_cvt_pk_bf16_f32 v208, v176, v177
    v_cvt_pk_bf16_f32 v209, v178, v179
    v_cvt_pk_bf16_f32 v210, v180, v181
    v_cvt_pk_bf16_f32 v211, v182, v183
    v_cvt_pk_bf16_f32 v212, v184, v185
    v_cvt_pk_bf16_f32 v213, v186, v187
    v_cvt_pk_bf16_f32 v214, v188, v189
    v_cvt_pk_bf16_f32 v215, v190, v191
    v_pk_fma_f32 v[144:145], v[144:145], v[248:249], v[254:255] op_sel_hi:[1,0,0] neg_lo:[1,0,0] neg_hi:[1,0,0]
    v_pk_fma_f32 v[146:147], v[146:147], v[248:249], v[254:255] op_sel_hi:[1,0,0] neg_lo:[1,0,0] neg_hi:[1,0,0]
    v_pk_fma_f32 v[148:149], v[148:149], v[248:249], v[254:255] op_sel_hi:[1,0,0] neg_lo:[1,0,0] neg_hi:[1,0,0]
    v_pk_fma_f32 v[150:151], v[150:151], v[248:249], v[254:255] op_sel_hi:[1,0,0] neg_lo:[1,0,0] neg_hi:[1,0,0]
    v_pk_fma_f32 v[152:153], v[152:153], v[248:249], v[254:255] op_sel_hi:[1,0,0] neg_lo:[1,0,0] neg_hi:[1,0,0]
    v_pk_fma_f32 v[154:155], v[154:155], v[248:249], v[254:255] op_sel_hi:[1,0,0] neg_lo:[1,0,0] neg_hi:[1,0,0]
    v_pk_fma_f32 v[156:157], v[156:157], v[248:249], v[254:255] op_sel_hi:[1,0,0] neg_lo:[1,0,0] neg_hi:[1,0,0]
    v_pk_fma_f32 v[158:159], v[158:159], v[248:249], v[254:255] op_sel_hi:[1,0,0] neg_lo:[1,0,0] neg_hi:[1,0,0]
    v_exp_f32 v144, v144
    v_exp_f32 v145, v145
    v_exp_f32 v146, v146
    v_exp_f32 v147, v147
    v_exp_f32 v148, v148
    v_exp_f32 v149, v149
    v_exp_f32 v150, v150
    v_exp_f32 v151, v151
    v_exp_f32 v152, v152
    v_exp_f32 v153, v153
    v_exp_f32 v154, v154
    v_exp_f32 v155, v155
    v_exp_f32 v156, v156
    v_exp_f32 v157, v157
    v_exp_f32 v158, v158
    v_exp_f32 v159, v159
    v_cvt_pk_bf16_f32 v216, v144, v145
    v_cvt_pk_bf16_f32 v217, v146, v147
    v_cvt_pk_bf16_f32 v218, v148, v149
    v_cvt_pk_bf16_f32 v219, v150, v151
    v_cvt_pk_bf16_f32 v220, v152, v153
    v_cvt_pk_bf16_f32 v221, v154, v155
    v_cvt_pk_bf16_f32 v222, v156, v157
    v_cvt_pk_bf16_f32 v223, v158, v159
    s_setprio 2
    v_readfirstlane_b32 s43, v14
    s_nop 0
    s_cmp_lg_u32 s43, 0
    s_cbranch_scc1 L_tg73
L_tg72:
    ds_read_b32 v14, v0 offset:320
    s_sleep 1
    s_waitcnt lgkmcnt(0)
    v_readfirstlane_b32 s43, v14
    s_nop 0
    s_cmp_eq_u32 s43, 0
    s_cbranch_scc1 L_tg72
L_tg73:
    s_lshl_b32 s50, s42, 10
    s_add_u32 s50, s50, 14811136
    s_lshl_b32 s51, s42, 13
    s_add_u32 s51, s51, 13631488
    s_add_u32 s52, s51, 4096
    s_lshl_b32 s61, s6, 2
    s_add_u32 s61, s61, s3
    s_lshl_b32 s61, s61, 3
    s_add_u32 s61, s61, s42
    s_lshl_b32 s61, s61, 12
    s_add_u32 s61, s61, 7340032
    v_lshlrev_b32 v8, 7, v1
    v_lshlrev_b32 v13, 2, v1
    v_add_u32 v13, 163328, v13
    v_mov_b32 v9, 4
    ds_read_b32 v12, v0 offset:384
    s_waitcnt lgkmcnt(0)
    v_readfirstlane_b32 s58, v12
    s_nop 0
    s_cmp_ge_u32 s58, 4
    s_cbranch_scc0 L_ck76
L_ck75:
    s_waitcnt vmcnt(0)
    s_mov_b32 s70, 0
    s_cmp_lg_u32 s59, 0
    s_cbranch_scc1 L_kv78
L_kv77:
    s_mov_b64 exec, 0xff
    buffer_load_dword v10, v8, s[16:19], s50 offen sc1
    s_waitcnt vmcnt(0)
    v_cmp_ne_u32 vcc, s43, v10
    s_nop 1
    s_cbranch_vccz L_kv79
    s_add_u32 s70, s70, 1
    s_cmp_gt_u32 s70, 0x400000
    s_cbranch_scc1 L_kv79
    s_sleep 3
    s_branch L_kv77
L_kv79:
    s_mov_b64 exec, 15
    ds_write_b32 v13, v9 offset:288
    s_mov_b64 exec, -1
L_kv78:
    ds_read_b32 v12, v0 offset:288
    s_waitcnt lgkmcnt(0)
    v_readfirstlane_b32 s58, v12
    s_nop 0
    s_cmp_ge_u32 s58, 4
    s_cbranch_scc0 L_ck82
L_ck81:
    buffer_load_dwordx4 v[160:163], v2, s[16:19], s51 offen offset:0 sc1
    buffer_load_dwordx4 v[164:167], v2, s[16:19], s51 offen offset:1024 sc1
    buffer_load_dwordx4 v[168:171], v2, s[16:19], s51 offen offset:2048 sc1
    buffer_load_dwordx4 v[172:175], v2, s[16:19], s51 offen offset:3072 sc1
    buffer_load_dwordx4 v[176:179], v2, s[16:19], s52 offen offset:0 sc1
    buffer_load_dwordx4 v[180:183], v2, s[16:19], s52 offen offset:1024 sc1
    buffer_load_dwordx4 v[184:187], v2, s[16:19], s52 offen offset:2048 sc1
    buffer_load_dwordx4 v[188:191], v2, s[16:19], s52 offen offset:3072 sc1
    s_waitcnt vmcnt(7)
    v_mfma_f32_32x32x16_bf16 v[16:31], v[160:163], v[192:195], 0
    s_waitcnt vmcnt(5)
    v_mfma_f32_32x32x16_bf16 v[32:47], v[168:171], v[200:203], 0
    v_mfma_f32_32x32x16_bf16 v[16:31], v[164:167], v[196:199], v[16:31]
    s_waitcnt vmcnt(4)
    v_mfma_f32_32x32x16_bf16 v[32:47], v[172:175], v[204:207], v[32:47]
    s_waitcnt vmcnt(3)
    v_mfma_f32_32x32x16_bf16 v[48:63], v[176:179], v[208:211], 0
    s_waitcnt vmcnt(1)
    v_mfma_f32_32x32x16_bf16 v[64:79], v[184:187], v[216:219], 0
    v_mfma_f32_32x32x16_bf16 v[48:63], v[180:183], v[212:215], v[48:63]
    s_waitcnt vmcnt(0)
    v_mfma_f32_32x32x16_bf16 v[64:79], v[188:191], v[220:223], v[64:79]
    s_nop 2
    v_rcp_f32 v248, v29
    s_nop 0
    v_rcp_f32 v249, v45
    v_mov_b32 v250, 0x358637bd
    v_fmac_f32 v250, v28, v248
    v_fmac_f32 v250, v44, v249
    v_rcp_f32 v250, v250
    s_nop 0
    v_mul_f32 v248, v248, v250
    v_mul_f32 v249, v249, v250
    v_mov_b32 v251, v248
    v_mov_b32 v252, v249
    s_nop 0
    v_permlane32_swap_b32 v248, v251
    v_permlane32_swap_b32 v249, v252
    v_mul_f32 v16, v16, v251
    v_mul_f32 v17, v17, v251
    v_mul_f32 v18, v18, v251
    v_mul_f32 v19, v19, v251
    v_mul_f32 v20, v20, v251
    v_mul_f32 v21, v21, v251
    v_mul_f32 v22, v22, v251
    v_mul_f32 v23, v23, v251
    v_mul_f32 v24, v24, v251
    v_mul_f32 v25, v25, v251
    v_mul_f32 v26, v26, v251
    v_mul_f32 v27, v27, v251
    v_mul_f32 v28, v28, v251
    v_mul_f32 v29, v29, v251
    v_mul_f32 v30, v30, v251
    v_mul_f32 v31, v31, v251
    v_fmac_f32 v16, v32, v252
    v_fmac_f32 v17, v33, v252
    v_fmac_f32 v18, v34, v252
    v_fmac_f32 v19, v35, v252
    v_fmac_f32 v20, v36, v252
    v_fmac_f32 v21, v37, v252
    v_fmac_f32 v22, v38, v252
    v_fmac_f32 v23, v39, v252
    v_fmac_f32 v24, v40, v252
    v_fmac_f32 v25, v41, v252
    v_fmac_f32 v26, v42, v252
    v_fmac_f32 v27, v43, v252
    v_fmac_f32 v28, v44, v252
    v_fmac_f32 v29, v45, v252
    v_fmac_f32 v30, v46, v252
    v_fmac_f32 v31, v47, v252
    v_cvt_pk_bf16_f32 v192, v16, v17
    v_cvt_pk_bf16_f32 v193, v18, v19
    v_cvt_pk_bf16_f32 v194, v20, v21
    v_cvt_pk_bf16_f32 v195, v22, v23
    v_cvt_pk_bf16_f32 v196, v24, v25
    v_cvt_pk_bf16_f32 v197, v26, v27
    v_cvt_pk_bf16_f32 v198, v28, v29
    v_cvt_pk_bf16_f32 v199, v30, v31
    v_cndmask_b32 v198, v198, 0, s[54:55]
    v_cndmask_b32 v199, v199, 0, s[54:55]
    buffer_store_dwordx4 v[192:195], v2, s[16:19], s61 offen offset:0 sc1
    buffer_store_dwordx4 v[196:199], v2, s[16:19], s61 offen offset:1024 sc1
    v_rcp_f32 v248, v61
    v_rcp_f32 v249, v77
    v_mov_b32 v250, 0x358637bd
    v_fmac_f32 v250, v60, v248
    v_fmac_f32 v250, v76, v249
    v_rcp_f32 v250, v250
    s_nop 0
    v_mul_f32 v248, v248, v250
    v_mul_f32 v249, v249, v250
    v_mov_b32 v251, v248
    v_mov_b32 v252, v249
    s_nop 0
    v_permlane32_swap_b32 v248, v251
    v_permlane32_swap_b32 v249, v252
    v_mul_f32 v48, v48, v251
    v_mul_f32 v49, v49, v251
    v_mul_f32 v50, v50, v251
    v_mul_f32 v51, v51, v251
    v_mul_f32 v52, v52, v251
    v_mul_f32 v53, v53, v251
    v_mul_f32 v54, v54, v251
    v_mul_f32 v55, v55, v251
    v_mul_f32 v56, v56, v251
    v_mul_f32 v57, v57, v251
    v_mul_f32 v58, v58, v251
    v_mul_f32 v59, v59, v251
    v_mul_f32 v60, v60, v251
    v_mul_f32 v61, v61, v251
    v_mul_f32 v62, v62, v251
    v_mul_f32 v63, v63, v251
    v_fmac_f32 v48, v64, v252
    v_fmac_f32 v49, v65, v252
    v_fmac_f32 v50, v66, v252
    v_fmac_f32 v51, v67, v252
    v_fmac_f32 v52, v68, v252
    v_fmac_f32 v53, v69, v252
    v_fmac_f32 v54, v70, v252
    v_fmac_f32 v55, v71, v252
    v_fmac_f32 v56, v72, v252
    v_fmac_f32 v57, v73, v252
    v_fmac_f32 v58, v74, v252
    v_fmac_f32 v59, v75, v252
    v_fmac_f32 v60, v76, v252
    v_fmac_f32 v61, v77, v252
    v_fmac_f32 v62, v78, v252
    v_fmac_f32 v63, v79, v252
    v_cvt_pk_bf16_f32 v208, v48, v49
    v_cvt_pk_bf16_f32 v209, v50, v51
    v_cvt_pk_bf16_f32 v210, v52, v53
    v_cvt_pk_bf16_f32 v211, v54, v55
    v_cvt_pk_bf16_f32 v212, v56, v57
    v_cvt_pk_bf16_f32 v213, v58, v59
    v_cvt_pk_bf16_f32 v214, v60, v61
    v_cvt_pk_bf16_f32 v215, v62, v63
    v_cndmask_b32 v214, v214, 0, s[54:55]
    v_cndmask_b32 v215, v215, 0, s[54:55]
    buffer_store_dwordx4 v[208:211], v2, s[16:19], s61 offen offset:2048 sc1
    buffer_store_dwordx4 v[212:215], v2, s[16:19], s61 offen offset:3072 sc1
    s_cmp_ge_u32 s5, 12
    s_cbranch_scc1 L_cspare
    s_lshl_b32 s61, s6, 1
    s_lshr_b32 s51, s59, 1
    s_add_u32 s61, s61, s51
    s_lshl_b32 s61, s61, 15
    s_lshl_b32 s51, s7, 8
    s_add_u32 s61, s61, s51
    s_and_b32 s51, s59, 1
    s_lshl_b32 s51, s51, 7
    s_add_u32 s61, s61, s51
    s_add_u32 s61, s61, 13697024
    v_bfe_u32 v8, v1, 2, 2
    v_lshrrev_b32 v9, 5, v1
    v_lshlrev_b32 v9, 9, v9
    v_lshl_add_u32 v9, v8, 7, v9
    v_bfe_u32 v8, v1, 3, 1
    v_lshlrev_b32 v8, 6, v8
    v_bfe_u32 v10, v1, 4, 1
    v_lshlrev_b32 v10, 5, v10
    v_and_b32 v6, 3, v1
    v_lshl_add_u32 v10, v6, 3, v10
    v_xor_b32 v6, v10, v8
    v_add_u32 v6, v6, v9
    v_add_u32 v10, 64, v10
    v_xor_b32 v7, v10, v8
    v_add_u32 v7, v7, v9
    s_lshr_b32 s50, s59, 1
    s_lshl_b32 s53, s50, 15
    s_add_u32 s53, s53, 98304
    s_xor_b32 s51, s50, 1
    s_lshl_b32 s51, s51, 6
    v_add_u32 v6, s53, v6
    v_xor_b32 v6, s51, v6
    v_xor_b32 v7, 64, v6
    s_waitcnt vmcnt(0)
    v_mov_b32 v248, s43
    v_mov_b32 v249, s43
    v_mov_b32 v250, s43
    v_mov_b32 v251, s43
    v_lshrrev_b32 v252, 3, v1
    v_lshlrev_b32 v252, 12, v252
    v_and_or_b32 v252, v2, s56, v252
    s_mov_b32 exec_lo, 0xffffffff
    s_mov_b32 exec_hi, 0xffffff
    buffer_store_dwordx4 v[248:251], v252, s[16:19], s61 offen sc1
    s_mov_b64 exec, -1
    s_setprio 0
L_aphase:
    s_lshl_b32 s68, s40, 16
    s_and_b32 s52, s59, 1
    s_lshl_b32 s51, s52, 15
    s_add_u32 s68, s68, s51
    s_lshr_b32 s53, s59, 1
    s_lshl_b32 s51, s53, 14
    s_add_u32 s68, s68, s51
    s_add_u32 s68, s68, 7340032
    v_lshlrev_b32 v8, 8, v1
    s_lshl_b32 s50, s40, 3
    s_add_u32 s50, s50, s41
    s_lshl_b32 s50, s50, 12
    s_lshl_b32 s51, s53, 10
    s_add_u32 s50, s50, s51
    s_lshl_b32 s51, s52, 7
    s_add_u32 s50, s50, s51
    s_add_u32 s50, s50, 13699072
    s_mul_i32 s51, s59, 24576
    s_add_u32 s51, s51, 16384
    v_add_u32 v16, s51, v2
    s_xor_b32 s51, s59, 2
    s_mul_i32 s51, s51, 24576
    s_add_u32 s51, s51, 16384
    v_add_u32 v17, s51, v2
    ds_read_b32 v12, v0 offset:368
    s_waitcnt lgkmcnt(0)
    v_readfirstlane_b32 s58, v12
    s_nop 0
    s_cmp_ge_u32 s58, 4
    s_cbranch_scc0 L_ck85
L_ck84:
    s_mov_b64 exec, 0xf
    s_mov_b32 s58, 0
L_pl86:
    buffer_load_dword v9, v8, s[16:19], s50 offen sc1
    s_waitcnt vmcnt(0)
    v_cmp_ne_u32 vcc, s43, v9
    s_add_u32 s58, s58, 1
    s_cbranch_vccz L_pl87
    s_cmp_gt_u32 s58, 0x400000
    s_cbranch_scc1 L_pl87
    s_sleep 6
    s_branch L_pl86
L_pl87:
    s_mov_b64 exec, -1
    s_add_u32 s52, s68, 0
    buffer_load_dwordx4 v[32:35], v2, s[16:19], s52 offen offset:0 sc1
    buffer_load_dwordx4 v[36:39], v2, s[16:19], s52 offen offset:1024 sc1
    buffer_load_dwordx4 v[40:43], v2, s[16:19], s52 offen offset:2048 sc1
    buffer_load_dwordx4 v[44:47], v2, s[16:19], s52 offen offset:3072 sc1
    s_add_u32 s52, s68, 4096
    buffer_load_dwordx4 v[48:51], v2, s[16:19], s52 offen offset:0 sc1
    buffer_load_dwordx4 v[52:55], v2, s[16:19], s52 offen offset:1024 sc1
    buffer_load_dwordx4 v[56:59], v2, s[16:19], s52 offen offset:2048 sc1
    buffer_load_dwordx4 v[60:63], v2, s[16:19], s52 offen offset:3072 sc1
    s_add_u32 s52, s68, 8192
    buffer_load_dwordx4 v[64:67], v2, s[16:19], s52 offen offset:0 sc1
    buffer_load_dwordx4 v[68:71], v2, s[16:19], s52 offen offset:1024 sc1
    buffer_load_dwordx4 v[72:75], v2, s[16:19], s52 offen offset:2048 sc1
    buffer_load_dwordx4 v[76:79], v2, s[16:19], s52 offen offset:3072 sc1
    s_add_u32 s52, s68, 12288
    buffer_load_dwordx4 v[80:83], v2, s[16:19], s52 offen offset:0 sc1
    buffer_load_dwordx4 v[84:87], v2, s[16:19], s52 offen offset:1024 sc1
    buffer_load_dwordx4 v[88:91], v2, s[16:19], s52 offen offset:2048 sc1
    buffer_load_dwordx4 v[92:95], v2, s[16:19], s52 offen offset:3072 sc1
    ds_read_b32 v12, v0 offset:240
    s_waitcnt lgkmcnt(0)
    v_readfirstlane_b32 s58, v12
    s_nop 0
    s_cmp_ge_u32 s58, 4
    s_cbranch_scc0 L_ck90
L_ck89:
    ds_read_b64_tr_b16 v[96:97], v6 offset:0
    ds_read_b64_tr_b16 v[98:99], v6 offset:1024
    ds_read_b64_tr_b16 v[100:101], v7 offset:0
    ds_read_b64_tr_b16 v[102:103], v7 offset:1024
    ds_read_b64_tr_b16 v[104:105], v6 offset:2048
    ds_read_b64_tr_b16 v[106:107], v6 offset:3072
    ds_read_b64_tr_b16 v[108:109], v7 offset:2048
    ds_read_b64_tr_b16 v[110:111], v7 offset:3072
    ds_read_b64_tr_b16 v[112:113], v6 offset:4096
    ds_read_b64_tr_b16 v[114:115], v6 offset:5120
    ds_read_b64_tr_b16 v[116:117], v7 offset:4096
    ds_read_b64_tr_b16 v[118:119], v7 offset:5120
    ds_read_b64_tr_b16 v[120:121], v6 offset:6144
    ds_read_b64_tr_b16 v[122:123], v6 offset:7168
    ds_read_b64_tr_b16 v[124:125], v7 offset:6144
    ds_read_b64_tr_b16 v[126:127], v7 offset:7168
    ds_read_b64_tr_b16 v[128:129], v6 offset:8192
    ds_read_b64_tr_b16 v[130:131], v6 offset:9216
    ds_read_b64_tr_b16 v[132:133], v7 offset:8192
    ds_read_b64_tr_b16 v[134:135], v7 offset:9216
    s_waitcnt vmcnt(15) lgkmcnt(15)
    v_mfma_f32_32x32x16_bf16 v[144:159], v[96:99], v[32:35], 0
    ds_read_b64_tr_b16 v[136:137], v6 offset:10240
    ds_read_b64_tr_b16 v[138:139], v6 offset:11264
    ds_read_b64_tr_b16 v[140:141], v7 offset:10240
    ds_read_b64_tr_b16 v[142:143], v7 offset:11264
    v_mfma_f32_32x32x16_bf16 v[160:175], v[100:103], v[32:35], 0
    s_waitcnt vmcnt(14) lgkmcnt(15)
    v_mfma_f32_32x32x16_bf16 v[144:159], v[104:107], v[36:39], v[144:159]
    ds_read_b64_tr_b16 v[96:97], v6 offset:12288
    ds_read_b64_tr_b16 v[98:99], v6 offset:13312
    ds_read_b64_tr_b16 v[100:101], v7 offset:12288
    ds_read_b64_tr_b16 v[102:103], v7 offset:13312
    v_mfma_f32_32x32x16_bf16 v[160:175], v[108:111], v[36:39], v[160:175]
    s_waitcnt vmcnt(13) lgkmcnt(15)
    v_mfma_f32_32x32x16_bf16 v[144:159], v[112:115], v[40:43], v[144:159]
    ds_read_b64_tr_b16 v[104:105], v6 offset:14336
    ds_read_b64_tr_b16 v[106:107], v6 offset:15360
    ds_read_b64_tr_b16 v[108:109], v7 offset:14336
    ds_read_b64_tr_b16 v[110:111], v7 offset:15360
    v_mfma_f32_32x32x16_bf16 v[160:175], v[116:119], v[40:43], v[160:175]
    s_waitcnt vmcnt(12) lgkmcnt(15)
    v_mfma_f32_32x32x16_bf16 v[144:159], v[120:123], v[44:47], v[144:159]
    ds_read_b64_tr_b16 v[112:113], v6 offset:16384
    ds_read_b64_tr_b16 v[114:115], v6 offset:17408
    ds_read_b64_tr_b16 v[116:117], v7 offset:16384
    ds_read_b64_tr_b16 v[118:119], v7 offset:17408
    v_mfma_f32_32x32x16_bf16 v[160:175], v[124:127], v[44:47], v[160:175]
    s_waitcnt vmcnt(11) lgkmcnt(15)
    v_mfma_f32_32x32x16_bf16 v[144:159], v[128:131], v[48:51], v[144:159]
    ds_read_b64_tr_b16 v[120:121], v6 offset:18432
    ds_read_b64_tr_b16 v[122:123], v6 offset:19456
    ds_read_b64_tr_b16 v[124:125], v7 offset:18432
    ds_read_b64_tr_b16 v[126:127], v7 offset:19456
    v_mfma_f32_32x32x16_bf16 v[160:175], v[132:135], v[48:51], v[160:175]
    s_waitcnt vmcnt(10) lgkmcnt(15)
    v_mfma_f32_32x32x16_bf16 v[144:159], v[136:139], v[52:55], v[144:159]
    ds_read_b64_tr_b16 v[128:129], v6 offset:20480
    ds_read_b64_tr_b16 v[130:131], v6 offset:21504
    ds_read_b64_tr_b16 v[132:133], v7 offset:20480
    ds_read_b64_tr_b16 v[134:135], v7 offset:21504
    v_mfma_f32_32x32x16_bf16 v[160:175], v[140:143], v[52:55], v[160:175]
    s_waitcnt vmcnt(9) lgkmcnt(15)
    v_mfma_f32_32x32x16_bf16 v[144:159], v[96:99], v[56:59], v[144:159]
    ds_read_b64_tr_b16 v[136:137], v6 offset:22528
    ds_read_b64_tr_b16 v[138:139], v6 offset:23552
    ds_read_b64_tr_b16 v[140:141], v7 offset:22528
    ds_read_b64_tr_b16 v[142:143], v7 offset:23552
    v_mfma_f32_32x32x16_bf16 v[160:175], v[100:103], v[56:59], v[160:175]
    s_waitcnt vmcnt(8) lgkmcnt(15)
    v_mfma_f32_32x32x16_bf16 v[144:159], v[104:107], v[60:63], v[144:159]
    ds_read_b64_tr_b16 v[96:97], v6 offset:24576
    ds_read_b64_tr_b16 v[98:99], v6 offset:25600
    ds_read_b64_tr_b16 v[100:101], v7 offset:24576
    ds_read_b64_tr_b16 v[102:103], v7 offset:25600
    v_mfma_f32_32x32x16_bf16 v[160:175], v[108:111], v[60:63], v[160:175]
    s_waitcnt vmcnt(7) lgkmcnt(15)
    v_mfma_f32_32x32x16_bf16 v[144:159], v[112:115], v[64:67], v[144:159]
    ds_read_b64_tr_b16 v[104:105], v6 offset:26624
    ds_read_b64_tr_b16 v[106:107], v6 offset:27648
    ds_read_b64_tr_b16 v[108:109], v7 offset:26624
    ds_read_b64_tr_b16 v[110:111], v7 offset:27648
    v_mfma_f32_32x32x16_bf16 v[160:175], v[116:119], v[64:67], v[160:175]
    s_waitcnt vmcnt(6) lgkmcnt(15)
    v_mfma_f32_32x32x16_bf16 v[144:159], v[120:123], v[68:71], v[144:159]
    ds_read_b64_tr_b16 v[112:113], v6 offset:28672
    ds_read_b64_tr_b16 v[114:115], v6 offset:29696
    ds_read_b64_tr_b16 v[116:117], v7 offset:28672
    ds_read_b64_tr_b16 v[118:119], v7 offset:29696
    v_mfma_f32_32x32x16_bf16 v[160:175], v[124:127], v[68:71], v[160:175]
    s_waitcnt vmcnt(5) lgkmcnt(15)
    v_mfma_f32_32x32x16_bf16 v[144:159], v[128:131], v[72:75], v[144:159]
    ds_read_b64_tr_b16 v[120:121], v6 offset:30720
    ds_read_b64_tr_b16 v[122:123], v6 offset:31744
    ds_read_b64_tr_b16 v[124:125], v7 offset:30720
    ds_read_b64_tr_b16 v[126:127], v7 offset:31744
    v_mfma_f32_32x32x16_bf16 v[160:175], v[132:135], v[72:75], v[160:175]
    s_waitcnt vmcnt(4) lgkmcnt(15)
    v_mfma_f32_32x32x16_bf16 v[144:159], v[136:139], v[76:79], v[144:159]
    v_mfma_f32_32x32x16_bf16 v[160:175], v[140:143], v[76:79], v[160:175]
    s_waitcnt vmcnt(3) lgkmcnt(14)
    v_mfma_f32_32x32x16_bf16 v[144:159], v[96:99], v[80:83], v[144:159]
    s_waitcnt lgkmcnt(12)
    v_mfma_f32_32x32x16_bf16 v[160:175], v[100:103], v[80:83], v[160:175]
    s_waitcnt vmcnt(2) lgkmcnt(10)
    v_mfma_f32_32x32x16_bf16 v[144:159], v[104:107], v[84:87], v[144:159]
    s_waitcnt lgkmcnt(8)
    v_mfma_f32_32x32x16_bf16 v[160:175], v[108:111], v[84:87], v[160:175]
    s_waitcnt vmcnt(1) lgkmcnt(6)
    v_mfma_f32_32x32x16_bf16 v[144:159], v[112:115], v[88:91], v[144:159]
    s_waitcnt lgkmcnt(4)
    v_mfma_f32_32x32x16_bf16 v[160:175], v[116:119], v[88:91], v[160:175]
    s_waitcnt vmcnt(0) lgkmcnt(2)
    v_mfma_f32_32x32x16_bf16 v[144:159], v[120:123], v[92:95], v[144:159]
    s_waitcnt lgkmcnt(0)
    v_mfma_f32_32x32x16_bf16 v[160:175], v[124:127], v[92:95], v[160:175]
    v_permlane32_swap_b32 v236, v238
    v_permlane32_swap_b32 v237, v239
    v_lshlrev_b32 v20, 16, v236
    v_and_b32 v21, 0xffff0000, v236
    v_lshlrev_b32 v22, 16, v237
    v_and_b32 v23, 0xffff0000, v237
    v_lshlrev_b32 v24, 16, v238
    v_and_b32 v25, 0xffff0000, v238
    v_lshlrev_b32 v26, 16, v239
    v_and_b32 v27, 0xffff0000, v239
    ds_read_b32 v12, v0 offset:400
    s_waitcnt lgkmcnt(0)
    v_readfirstlane_b32 s58, v12
    s_nop 0
    s_cmp_ge_u32 s58, 4
    s_cbranch_scc0 L_ck93
L_ck92:
    ds_write_b128 v17, v[144:147] offset:0
    ds_write_b128 v17, v[148:151] offset:1024
    ds_write_b128 v17, v[152:155] offset:2048
    ds_write_b128 v17, v[156:159] offset:3072
    ds_write_b128 v16, v[160:163] offset:4096
    ds_write_b128 v16, v[164:167] offset:5120
    s_waitcnt lgkmcnt(0)
    s_barrier
    ds_read_b128 v[32:35], v16 offset:2048
    ds_read_b128 v[36:39], v16 offset:3072
    ds_read_b128 v[40:43], v16 offset:6144
    ds_read_b128 v[44:47], v16 offset:7168
    s_waitcnt lgkmcnt(3)
    v_add_f32 v32, v32, v168
    v_add_f32 v33, v33, v169
    v_add_f32 v34, v34, v170
    v_add_f32 v35, v35, v171
    s_waitcnt lgkmcnt(2)
    v_add_f32 v36, v36, v172
    v_add_f32 v37, v37, v173
    v_add_f32 v38, v38, v174
    v_add_f32 v39, v39, v175
    s_waitcnt lgkmcnt(1)
    v_fmac_f32 v20, v32, v40
    v_fmac_f32 v21, v33, v41
    v_fmac_f32 v22, v34, v42
    v_fmac_f32 v23, v35, v43
    s_waitcnt lgkmcnt(0)
    v_fmac_f32 v24, v36, v44
    v_fmac_f32 v25, v37, v45
    v_fmac_f32 v26, v38, v46
    v_fmac_f32 v27, v39, v47
    v_cvt_pk_bf16_f32 v236, v20, v21
    v_cvt_pk_bf16_f32 v237, v22, v23
    v_cvt_pk_bf16_f32 v238, v24, v25
    v_cvt_pk_bf16_f32 v239, v26, v27
    s_nop 0
    v_permlane32_swap_b32 v236, v238
    v_permlane32_swap_b32 v237, v239
    buffer_store_dwordx4 v[236:239], v3, s[28:31], s60 offen offset:32
    s_branch L_fin
L_lwave:
    v_lshlrev_b32 v4, 3, v1
    v_add_u32 v4, 163328, v4
    v_mov_b32 v6, 0
    v_mov_b32 v7, 0
    ds_write_b64 v4, v[6:7]
    s_mov_b32 s41, s1
    s_lshl_b32 s40, s4, 2
    s_add_u32 s40, s40, s53
    s_and_b32 s42, s4, 1
    s_lshl_b32 s42, s42, 2
    s_and_b32 s50, s52, 3
    s_add_u32 s42, s42, s50
    s_and_b32 s50, s52, 4
    s_lshl_b32 s50, s50, 1
    s_add_u32 s7, s42, s50
    s_mul_i32 s57, s53, 7
    s_lshl_b32 s50, s41, 2
    s_add_u32 s57, s57, s50
    s_sub_u32 s50, s57, 28
    s_cmp_ge_u32 s57, 28
    s_cselect_b32 s57, s50, s57
    s_lshl_b32 s50, s59, 2
    s_add_u32 s50, s50, 163328
    v_mov_b32 v0, s50
    s_mov_b32 s54, 0
    s_mov_b32 s55, -1
    s_mov_b32 s62, 0x3fb8aa3b
    s_movk_i32 s56, 0x70
    s_mul_i32 s50, s42, 448
    s_and_b32 s51, s42, 1
    s_lshl_b32 s52, s51, 6
    s_add_u32 s52, s52, s50
    s_mul_i32 s51, s51, 384
    s_sub_u32 s48, s50, s51
    s_add_u32 s48, s48, 384
    s_mul_i32 s50, s42, 112
    s_add_u32 s51, s50, 896
    s_add_u32 s53, s50, 1792
    s_add_u32 s46, s52, 128
    s_add_u32 s47, s52, 256
    s_movk_i32 s44, 3584
    s_cmp_ge_u32 s7, 8
    s_cselect_b32 s45, s51, s52
    s_cselect_b32 s44, 2688, s44
    s_cselect_b32 s46, s53, s46
    s_cselect_b32 s47, s50, s47
    s_mul_i32 s14, s44, 448
    s_mov_b32 s15, 0x20000
    v_lshrrev_b32 v8, 3, v1
    v_mul_lo_u32 v3, v8, s44
    v_bfe_u32 v8, v1, 4, 1
    v_lshlrev_b32 v8, 2, v8
    v_and_b32 v9, 7, v1
    v_xor_b32 v8, v8, v9
    v_lshl_add_u32 v3, v8, 4, v3
    s_waitcnt lgkmcnt(0)
    s_cmp_ge_u32 s7, 8
    s_cselect_b64 s[12:13], s[66:67], s[74:75]
    s_mov_b64 s[8:9], s[64:65]
    s_mov_b32 s10, 1835008
    s_mov_b32 s11, 0x20000
    s_mov_b64 s[16:17], s[82:83]
    s_mov_b32 s18, 14979072
    s_mov_b32 s19, 0x20000
    s_mov_b64 s[20:21], s[76:77]
    s_mov_b32 s22, 1605632
    s_mov_b32 s23, 0x20000
    s_mov_b64 s[24:25], s[70:71]
    s_mov_b32 s26, 401408
    s_mov_b32 s27, 0x20000
    s_mov_b64 s[28:29], s[78:79]
    s_mov_b32 s30, 1835008
    s_mov_b32 s31, 0x20000
    s_mov_b64 s[32:33], s[80:81]
    s_mov_b32 s34, 256
    s_mov_b32 s35, 0x20000
    s_mov_b64 s[36:37], s[68:69]
    s_mov_b32 s38, 25088
    s_mov_b32 s39, 0x20000
    s_mov_b64 s[80:81], s[66:67]
    s_mov_b64 s[82:83], s[74:75]
    s_cmp_ge_u32 s7, 8
    s_cbranch_scc1 L_lattn
    s_mul_i32 s61, s59, s44
    s_lshl_b32 s61, s61, 3
    s_lshl_b32 s53, s59, 10
    s_lshl_b32 s65, s44, 6
    s_lshl_b32 s67, s44, 5
    s_mul_i32 s66, s44, 448
    s_mul_i32 s64, s65, s1
    s_getpc_b64 s[72:73]
L_pc94:
    s_sub_u32 s72, s72, L_pc94 - recurrent_scan__linear_kernel_hedgehog__dense_activation_silu__prompt_kernel
    s_subb_u32 s73, s73, 0
    s_lshl_b32 s50, s5, 2
    s_add_u32 s50, s50, s59
    s_lshl_b32 s50, s50, 2
    v_add_u32 v8, s50, v1
    v_lshlrev_b32 v8, 7, v8
    v_min_u32 v8, L_end - recurrent_scan__linear_kernel_hedgehog__dense_activation_silu__prompt_kernel, v8
    v_mov_b32 v9, s73
    v_add_co_u32 v8, vcc, s72, v8
    s_nop 1
    v_addc_co_u32 v9, vcc, 0, v9, vcc
    s_mov_b64 exec, 15
    global_load_dword v200, v[8:9], off
    s_mov_b64 exec, -1
    s_barrier
    s_add_u32 m0, s53, 114688
    s_add_u32 s50, s64, s61
    s_add_u32 s50, s50, s45
    buffer_load_dwordx4 v3, s[12:15], s50 offen lds
    s_add_u32 m0, s53, 118784
    s_add_u32 s50, s50, s67
    s_add_u32 s64, s64, s65
    s_cmp_eq_u32 s64, s66
    s_cselect_b32 s64, 0, s64
    buffer_load_dwordx4 v3, s[12:15], s50 offen lds
    s_add_u32 m0, s53, 122880
    s_add_u32 s50, s64, s61
    s_add_u32 s50, s50, s45
    buffer_load_dwordx4 v3, s[12:15], s50 offen lds
    s_add_u32 m0, s53, 126976
    s_add_u32 s50, s50, s67
    s_add_u32 s64, s64, s65
    s_cmp_eq_u32 s64, s66
    s_cselect_b32 s64, 0, s64
    buffer_load_dwordx4 v3, s[12:15], s50 offen lds
    s_add_u32 m0, s53, 131072
    s_add_u32 s50, s64, s61
    s_add_u32 s50, s50, s45
    buffer_load_dwordx4 v3, s[12:15], s50 offen lds
    s_add_u32 m0, s53, 135168
    s_add_u32 s50, s50, s67
    s_add_u32 s64, s64, s65
    s_cmp_eq_u32 s64, s66
    s_cselect_b32 s64, 0, s64
    buffer_load_dwordx4 v3, s[12:15], s50 offen lds
    s_add_u32 m0, s53, 139264
    s_add_u32 s50, s64, s61
    s_add_u32 s50, s50, s45
    buffer_load_dwordx4 v3, s[12:15], s50 offen lds
    s_add_u32 m0, s53, 143360
    s_add_u32 s50, s64, s61
    s_add_u32 s50, s50, s45
    s_add_u32 s50, s50, s67
    s_add_u32 s64, s64, s65
    s_cmp_eq_u32 s64, s66
    s_cselect_b32 s64, 0, s64
    buffer_load_dwordx4 v3, s[12:15], s50 offen lds
    s_add_u32 m0, s53, 147456
    s_add_u32 s50, s64, s61
    s_add_u32 s50, s50, s45
    buffer_load_dwordx4 v3, s[12:15], s50 offen lds
    s_add_u32 m0, s53, 151552
    s_add_u32 s50, s50, s67
    s_add_u32 s64, s64, s65
    s_cmp_eq_u32 s64, s66
    s_cselect_b32 s64, 0, s64
    buffer_load_dwordx4 v3, s[12:15], s50 offen lds
    s_add_u32 m0, s53, 155648
    s_add_u32 s50, s64, s61
    s_add_u32 s50, s50, s45
    buffer_load_dwordx4 v3, s[12:15], s50 offen lds
    s_or_b32 s50, s2, s59
    s_cmp_lg_u32 s50, 0
    s_cbranch_scc1 L_nt95
    s_mov_b32 s50, 14843904
    v_mov_b32 v9, 0
    s_mov_b64 exec, 1
    buffer_load_dword v8, v9, s[16:19], s50 offen sc1
    s_waitcnt vmcnt(0)
    v_or_b32 v8, 0x40004000, v8
    v_add_u32 v8, 1, v8
    v_and_b32 v8, 0xbfffbfff, v8
    v_max_u32 v8, 1, v8
    s_nop 1
    buffer_store_dword v8, v9, s[16:19], s50 offen sc1
    buffer_store_dword v8, v9, s[32:35], 0 offen sc1
    s_waitcnt vmcnt(0)
    s_mov_b64 exec, -1
L_nt95:
    v_lshlrev_b32 v11, 2, v1
    v_add_u32 v11, 163328, v11
    v_mov_b32 v12, 1
    v_mov_b32 v192, 163328
    v_lshrrev_b32 v8, 2, v1
    v_mul_u32_u24 v4, 3584, v8
    v_and_b32 v8, 3, v1
    v_lshl_add_u32 v4, v8, 4, v4
    s_lshl_b32 s50, s59, 12
    s_add_u32 s50, s50, 143360
    v_add_u32 v187, s50, v2
    s_mov_b32 s51, 896
    v_lshrrev_b32 v8, 3, v1
    v_mul_lo_u32 v5, v8, s51
    v_bfe_u32 v8, v1, 4, 1
    v_lshlrev_b32 v8, 2, v8
    v_and_b32 v9, 7, v1
    v_xor_b32 v8, v8, v9
    v_lshl_add_u32 v5, v8, 4, v5
    v_bfe_u32 v8, v1, 2, 2
    v_lshrrev_b32 v9, 5, v1
    v_lshlrev_b32 v9, 9, v9
    v_lshl_add_u32 v9, v8, 7, v9
    v_bfe_u32 v8, v1, 3, 1
    v_lshlrev_b32 v8, 6, v8
    v_bfe_u32 v10, v1, 4, 1
    v_lshlrev_b32 v10, 5, v10
    v_and_b32 v6, 3, v1
    v_lshl_add_u32 v10, v6, 3, v10
    v_xor_b32 v6, v10, v8
    v_add_u32 v6, v6, v9
    v_add_u32 v10, 64, v10
    v_xor_b32 v7, v10, v8
    v_add_u32 v7, v7, v9
    s_xor_b32 s51, s59, 3
    s_lshr_b32 s51, s51, 1
    s_lshl_b32 s51, s51, 6
    v_xor_b32 v6, s51, v6
    v_xor_b32 v7, 64, v6
    s_mul_i32 s68, s59, 401408
    s_lshl_b32 s52, s41, 7
    s_add_u32 s68, s68, s52
    s_mul_i32 s69, s57, 14336
    v_add_u32 v13, 7168, v5
    s_waitcnt lgkmcnt(0)
    s_mov_b32 s70, 0
L_lw96:
    ds_read_b128 v[188:191], v192 offset:0
    s_add_u32 s70, s70, 1
    s_cmp_gt_u32 s70, 0x1000000
    s_cbranch_scc1 L_lw97
    s_sleep 1
    s_waitcnt lgkmcnt(0)
    v_min3_u32 v188, v188, v189, v190
    v_min_u32 v188, v188, v191
    s_nop 0
    v_readfirstlane_b32 s58, v188
    s_nop 0
    s_cmp_eq_u32 s58, 0
    s_cbranch_scc1 L_lw96
L_lw97:
    s_waitcnt lgkmcnt(0)
    s_add_u32 s50, s64, s61
    s_add_u32 s50, s50, s45
    s_add_u32 m0, s53, 0
    s_add_u32 s50, s50, s67
    s_add_u32 s64, s64, s65
    s_cmp_eq_u32 s64, s66
    s_cselect_b32 s64, 0, s64
    buffer_load_dwordx4 v3, s[12:15], s50 offen lds
    s_add_u32 m0, s53, 4096
    s_add_u32 s50, s64, s61
    s_add_u32 s50, s50, s45
    buffer_load_dwordx4 v3, s[12:15], s50 offen lds
    s_add_u32 m0, s53, 8192
    s_add_u32 s50, s50, s67
    s_add_u32 s64, s64, s65
    s_cmp_eq_u32 s64, s66
    s_cselect_b32 s64, 0, s64
    buffer_load_dwordx4 v3, s[12:15], s50 offen lds
    s_waitcnt vmcnt(7)
    s_mov_b64 exec, 15
    ds_add_u32 v11, v12 offset:128
    s_mov_b64 exec, -1
    s_add_u32 m0, s53, 28672
    s_add_u32 s50, s64, s61
    s_add_u32 s50, s50, s46
    buffer_load_dwordx4 v3, s[12:15], s50 offen lds
    s_add_u32 m0, s53, 32768
    s_add_u32 s50, s50, s67
    s_add_u32 s64, s64, s65
    s_cmp_eq_u32 s64, s66
    s_cselect_b32 s64, 0, s64
    buffer_load_dwordx4 v3, s[12:15], s50 offen lds
    s_add_u32 m0, s53, 36864
    s_add_u32 s50, s64, s61
    s_add_u32 s50, s50, s46
    buffer_load_dwordx4 v3, s[12:15], s50 offen lds
    s_waitcnt vmcnt(6)
    s_mov_b64 exec, 15
    ds_add_u32 v11, v12 offset:144
    s_mov_b64 exec, -1
    s_add_u32 m0, s53, 40960
    s_add_u32 s50, s50, s67
    s_add_u32 s64, s64, s65
    s_cmp_eq_u32 s64, s66
    s_cselect_b32 s64, 0, s64
    buffer_load_dwordx4 v3, s[12:15], s50 offen lds
    s_add_u32 m0, s53, 45056
    s_add_u32 s50, s64, s61
    s_add_u32 s50, s50, s46
    buffer_load_dwordx4 v3, s[12:15], s50 offen lds
    s_waitcnt vmcnt(5)
    s_mov_b64 exec, 15
    ds_add_u32 v11, v12 offset:352
    s_mov_b64 exec, -1
    s_add_u32 m0, s53, 49152
    s_add_u32 s50, s50, s67
    s_add_u32 s64, s64, s65
    s_cmp_eq_u32 s64, s66
    s_cselect_b32 s64, 0, s64
    buffer_load_dwordx4 v3, s[12:15], s50 offen lds
    s_add_u32 m0, s53, 53248
    s_add_u32 s50, s64, s61
    s_add_u32 s50, s50, s46
    buffer_load_dwordx4 v3, s[12:15], s50 offen lds
    s_add_u32 m0, s53, 57344
    s_add_u32 s50, s64, s61
    s_add_u32 s50, s50, s46
    s_add_u32 s50, s50, s67
    s_add_u32 s64, s64, s65
    s_cmp_eq_u32 s64, s66
    s_cselect_b32 s64, 0, s64
    buffer_load_dwordx4 v3, s[12:15], s50 offen lds
    s_add_u32 m0, s53, 61440
    s_add_u32 s50, s64, s61
    s_add_u32 s50, s50, s46
    buffer_load_dwordx4 v3, s[12:15], s50 offen lds
    s_add_u32 m0, s53, 65536
    s_add_u32 s50, s50, s67
    s_add_u32 s64, s64, s65
    s_cmp_eq_u32 s64, s66
    s_cselect_b32 s64, 0, s64
    buffer_load_dwordx4 v3, s[12:15], s50 offen lds
    s_waitcnt vmcnt(3)
    s_mov_b64 exec, 15
    ds_add_u32 v11, v12 offset:160
    s_mov_b64 exec, -1
    s_add_u32 m0, s53, 69632
    s_add_u32 s50, s64, s61
    s_add_u32 s50, s50, s46
    buffer_load_dwordx4 v3, s[12:15], s50 offen lds
    s_add_u32 m0, s53, 73728
    s_add_u32 s50, s50, s67
    s_add_u32 s64, s64, s65
    s_cmp_eq_u32 s64, s66
    s_cselect_b32 s64, 0, s64
    buffer_load_dwordx4 v3, s[12:15], s50 offen lds
    s_add_u32 m0, s53, 77824
    s_add_u32 s50, s64, s61
    s_add_u32 s50, s50, s46
    buffer_load_dwordx4 v3, s[12:15], s50 offen lds
    s_add_u32 m0, s53, 81920
    s_add_u32 s50, s50, s67
    s_add_u32 s64, s64, s65
    s_cmp_eq_u32 s64, s66
    s_cselect_b32 s64, 0, s64
    buffer_load_dwordx4 v3, s[12:15], s50 offen lds
    v_mov_b32 v197, 0
    buffer_load_dword v198, v197, s[32:35], 0 offen sc1
    s_add_u32 m0, s53, 86016
    s_add_u32 s50, s64, s61
    s_add_u32 s50, s50, s47
    buffer_load_dwordx4 v3, s[12:15], s50 offen lds
    s_add_u32 m0, s53, 90112
    s_add_u32 s50, s50, s67
    s_add_u32 s64, s64, s65
    s_cmp_eq_u32 s64, s66
    s_cselect_b32 s64, 0, s64
    buffer_load_dwordx4 v3, s[12:15], s50 offen lds
    s_add_u32 m0, s53, 94208
    s_add_u32 s50, s64, s61
    s_add_u32 s50, s50, s47
    buffer_load_dwordx4 v3, s[12:15], s50 offen lds
    s_waitcnt vmcnt(4)
    s_mov_b64 exec, 15
    ds_add_u32 v11, v12 offset:176
    s_mov_b64 exec, -1
    s_add_u32 m0, s53, 98304
    s_add_u32 s50, s50, s67
    s_add_u32 s64, s64, s65
    s_cmp_eq_u32 s64, s66
    s_cselect_b32 s64, 0, s64
    buffer_load_dwordx4 v3, s[12:15], s50 offen lds
    s_add_u32 m0, s53, 102400
    s_add_u32 s50, s64, s61
    s_add_u32 s50, s50, s47
    buffer_load_dwordx4 v3, s[12:15], s50 offen lds
    s_add_u32 m0, s53, 106496
    s_add_u32 s50, s50, s67
    s_add_u32 s64, s64, s65
    s_cmp_eq_u32 s64, s66
    s_cselect_b32 s64, 0, s64
    buffer_load_dwordx4 v3, s[12:15], s50 offen lds
    s_add_u32 m0, s53, 110592
    s_add_u32 s50, s64, s61
    s_add_u32 s50, s50, s47
    buffer_load_dwordx4 v3, s[12:15], s50 offen lds
    s_waitcnt vmcnt(0)
    s_mov_b64 exec, 15
    ds_add_u32 v11, v12 offset:192
    s_mov_b64 exec, -1
    s_waitcnt lgkmcnt(0)
    s_mov_b32 s70, 0
L_lw98:
    ds_read_b128 v[188:191], v192 offset:16
    s_add_u32 s70, s70, 1
    s_cmp_gt_u32 s70, 0x1000000
    s_cbranch_scc1 L_lw99
    s_sleep 1
    s_waitcnt lgkmcnt(0)
    v_min3_u32 v188, v188, v189, v190
    v_min_u32 v188, v188, v191
    s_nop 0
    v_readfirstlane_b32 s58, v188
    s_nop 0
    s_cmp_eq_u32 s58, 0
    s_cbranch_scc1 L_lw98
L_lw99:
    s_waitcnt lgkmcnt(0)
    s_add_u32 m0, s53, 114688
    s_add_u32 s50, s64, s61
    s_add_u32 s50, s50, s47
    s_add_u32 s50, s50, s67
    s_add_u32 s64, s64, s65
    s_cmp_eq_u32 s64, s66
    s_cselect_b32 s64, 0, s64
    buffer_load_dwordx4 v3, s[12:15], s50 offen lds
    s_add_u32 m0, s53, 118784
    s_add_u32 s50, s64, s61
    s_add_u32 s50, s50, s47
    buffer_load_dwordx4 v3, s[12:15], s50 offen lds
    s_add_u32 m0, s53, 122880
    s_add_u32 s50, s50, s67
    s_add_u32 s64, s64, s65
    s_cmp_eq_u32 s64, s66
    s_cselect_b32 s64, 0, s64
    buffer_load_dwordx4 v3, s[12:15], s50 offen lds
    s_add_u32 m0, s53, 126976
    s_add_u32 s50, s64, s61
    s_add_u32 s50, s50, s47
    buffer_load_dwordx4 v3, s[12:15], s50 offen lds
    s_add_u32 m0, s53, 131072
    s_add_u32 s50, s50, s67
    s_add_u32 s64, s64, s65
    s_cmp_eq_u32 s64, s66
    s_cselect_b32 s64, 0, s64
    buffer_load_dwordx4 v3, s[12:15], s50 offen lds
    s_add_u32 m0, s53, 135168
    s_add_u32 s50, s64, s61
    s_add_u32 s50, s50, s47
    buffer_load_dwordx4 v3, s[12:15], s50 offen lds
    s_add_u32 m0, s53, 139264
    s_add_u32 s50, s50, s67
    s_add_u32 s64, s64, s65
    s_cmp_eq_u32 s64, s66
    s_cselect_b32 s64, 0, s64
    buffer_load_dwordx4 v3, s[12:15], s50 offen lds
    s_waitcnt vmcnt(0)
    s_mov_b64 exec, 15
    ds_add_u32 v11, v12 offset:208
    s_mov_b64 exec, -1
    v_readfirstlane_b32 s43, v198
    s_nop 0
    s_cmp_lg_u32 s43, 0
    s_cbranch_scc1 L_tf101
    s_mov_b32 s70, 0
L_tf100:
    buffer_load_dword v198, v197, s[32:35], 0 offen sc1
    s_waitcnt vmcnt(0)
    v_readfirstlane_b32 s43, v198
    s_add_u32 s70, s70, 1
    s_max_u32 s58, s70, 0x400000
    s_sub_u32 s58, s58, 0x400000
    s_or_b32 s43, s43, s58
    s_cmp_eq_u32 s43, 0
    s_cbranch_scc1 L_tf100
L_tf101:
    v_mov_b32 v198, s43
    ds_write_b32 v0, v198 offset:320
    s_waitcnt lgkmcnt(0)
    s_mov_b32 s70, 0
L_lw102:
    ds_read_b128 v[188:191], v192 offset:32
    s_add_u32 s70, s70, 1
    s_cmp_gt_u32 s70, 0x1000000
    s_cbranch_scc1 L_lw103
    s_sleep 1
    s_waitcnt lgkmcnt(0)
    v_min3_u32 v188, v188, v189, v190
    v_min_u32 v188, v188, v191
    s_nop 0
    v_readfirstlane_b32 s58, v188
    s_nop 0
    s_cmp_eq_u32 s58, 0
    s_cbranch_scc1 L_lw102
L_lw103:
    s_waitcnt lgkmcnt(0)
    s_lshl_b32 s61, s61, 1
    s_add_u32 s61, s61, s48
    s_add_u32 m0, s53, 0
    s_add_u32 s50, s64, s61
    s_add_u32 s64, s64, s65
    s_cmp_eq_u32 s64, s66
    s_cselect_b32 s64, 0, s64
    buffer_load_dwordx4 v4, s[12:15], s50 offen lds
    s_add_u32 m0, s53, 4096
    s_add_u32 s50, s64, s61
    s_add_u32 s64, s64, s65
    s_cmp_eq_u32 s64, s66
    s_cselect_b32 s64, 0, s64
    buffer_load_dwordx4 v4, s[12:15], s50 offen lds
    s_add_u32 m0, s53, 8192
    s_add_u32 s50, s64, s61
    s_add_u32 s64, s64, s65
    s_cmp_eq_u32 s64, s66
    s_cselect_b32 s64, 0, s64
    buffer_load_dwordx4 v4, s[12:15], s50 offen lds
    s_add_u32 m0, s53, 12288
    s_add_u32 s50, s64, s61
    s_add_u32 s64, s64, s65
    s_cmp_eq_u32 s64, s66
    s_cselect_b32 s64, 0, s64
    buffer_load_dwordx4 v4, s[12:15], s50 offen lds
    s_add_u32 m0, s53, 16384
    s_add_u32 s50, s64, s61
    s_add_u32 s64, s64, s65
    s_cmp_eq_u32 s64, s66
    s_cselect_b32 s64, 0, s64
    buffer_load_dwordx4 v4, s[12:15], s50 offen lds
    s_add_u32 m0, s53, 20480
    s_add_u32 s50, s64, s61
    s_add_u32 s64, s64, s65
    s_cmp_eq_u32 s64, s66
    s_cselect_b32 s64, 0, s64
    buffer_load_dwordx4 v4, s[12:15], s50 offen lds
    s_add_u32 m0, s53, 24576
    s_add_u32 s50, s64, s61
    s_add_u32 s64, s64, s65
    s_cmp_eq_u32 s64, s66
    s_cselect_b32 s64, 0, s64
    buffer_load_dwordx4 v4, s[12:15], s50 offen lds
    s_waitcnt vmcnt(0)
    s_mov_b64 exec, 15
    ds_add_u32 v11, v12 offset:224
    s_mov_b64 exec, -1
    v_lshlrev_b32 v14, 7, v1
    s_lshl_b32 s50, s5, 2
    s_add_u32 s50, s50, s59
    s_mul_i32 s51, s50, 3200
    s_mov_b64 exec, 0x1ffffff
    buffer_load_dword v200, v14, s[24:27], s51 offen
    s_mov_b64 exec, -1
    s_waitcnt lgkmcnt(0)
    s_mov_b32 s70, 0
L_lw104:
    ds_read_b128 v[188:191], v192 offset:64
    s_add_u32 s70, s70, 1
    s_cmp_gt_u32 s70, 0x1000000
    s_cbranch_scc1 L_lw105
    s_sleep 1
    s_waitcnt lgkmcnt(0)
    v_min3_u32 v188, v188, v189, v190
    v_min_u32 v188, v188, v191
    s_nop 0
    v_readfirstlane_b32 s58, v188
    s_nop 0
    s_cmp_eq_u32 s58, 0
    s_cbranch_scc1 L_lw104
L_lw105:
    s_waitcnt lgkmcnt(0)
    s_mul_i32 s52, s59, 14336
    s_add_u32 s52, s52, 28672
    v_add_u32 v9, s52, v6
    v_add_u32 v10, s52, v7
    s_add_u32 m0, s52, 0
    s_add_u32 s51, s68, s69
    buffer_load_dwordx4 v5, s[20:23], s51 offen lds
    s_add_u32 m0, s52, 1024
    s_add_u32 s69, s69, 14336
    s_cmp_eq_u32 s69, 401408
    s_cselect_b32 s69, 0, s69
    buffer_load_dwordx4 v13, s[20:23], s51 offen lds
    s_add_u32 m0, s52, 2048
    s_add_u32 s51, s68, s69
    buffer_load_dwordx4 v5, s[20:23], s51 offen lds
    s_add_u32 m0, s52, 3072
    s_add_u32 s69, s69, 14336
    s_cmp_eq_u32 s69, 401408
    s_cselect_b32 s69, 0, s69
    buffer_load_dwordx4 v13, s[20:23], s51 offen lds
    s_add_u32 m0, s52, 4096
    s_add_u32 s51, s68, s69
    buffer_load_dwordx4 v5, s[20:23], s51 offen lds
    s_add_u32 m0, s52, 5120
    s_add_u32 s69, s69, 14336
    s_cmp_eq_u32 s69, 401408
    s_cselect_b32 s69, 0, s69
    buffer_load_dwordx4 v13, s[20:23], s51 offen lds
    s_add_u32 m0, s52, 6144
    s_add_u32 s51, s68, s69
    buffer_load_dwordx4 v5, s[20:23], s51 offen lds
    s_add_u32 m0, s52, 7168
    s_add_u32 s69, s69, 14336
    s_cmp_eq_u32 s69, 401408
    s_cselect_b32 s69, 0, s69
    buffer_load_dwordx4 v13, s[20:23], s51 offen lds
    s_add_u32 m0, s52, 8192
    s_add_u32 s51, s68, s69
    buffer_load_dwordx4 v5, s[20:23], s51 offen lds
    s_add_u32 m0, s52, 9216
    s_add_u32 s69, s69, 14336
    s_cmp_eq_u32 s69, 401408
    s_cselect_b32 s69, 0, s69
    buffer_load_dwordx4 v13, s[20:23], s51 offen lds
    s_waitcnt vmcnt(8)
    ds_read_b64_tr_b16 v[16:17], v9 offset:0
    ds_read_b64_tr_b16 v[18:19], v9 offset:1024
    ds_read_b64_tr_b16 v[20:21], v10 offset:0
    ds_read_b64_tr_b16 v[22:23], v10 offset:1024
    s_add_u32 m0, s52, 0
    s_add_u32 s51, s68, s69
    s_waitcnt lgkmcnt(0)
    buffer_load_dwordx4 v5, s[20:23], s51 offen lds
    s_add_u32 m0, s52, 1024
    s_add_u32 s69, s69, 14336
    s_cmp_eq_u32 s69, 401408
    s_cselect_b32 s69, 0, s69
    buffer_load_dwordx4 v13, s[20:23], s51 offen lds
    s_waitcnt vmcnt(8)
    ds_read_b64_tr_b16 v[24:25], v9 offset:2048
    ds_read_b64_tr_b16 v[26:27], v9 offset:3072
    ds_read_b64_tr_b16 v[28:29], v10 offset:2048
    ds_read_b64_tr_b16 v[30:31], v10 offset:3072
    s_add_u32 m0, s52, 2048
    s_add_u32 s51, s68, s69
    s_waitcnt lgkmcnt(0)
    buffer_load_dwordx4 v5, s[20:23], s51 offen lds
    s_add_u32 m0, s52, 3072
    s_add_u32 s69, s69, 14336
    s_cmp_eq_u32 s69, 401408
    s_cselect_b32 s69, 0, s69
    buffer_load_dwordx4 v13, s[20:23], s51 offen lds
    s_waitcnt vmcnt(8)
    ds_read_b64_tr_b16 v[32:33], v9 offset:4096
    ds_read_b64_tr_b16 v[34:35], v9 offset:5120
    ds_read_b64_tr_b16 v[36:37], v10 offset:4096
    ds_read_b64_tr_b16 v[38:39], v10 offset:5120
    s_add_u32 m0, s52, 4096
    s_add_u32 s51, s68, s69
    s_waitcnt lgkmcnt(0)
    buffer_load_dwordx4 v5, s[20:23], s51 offen lds
    s_add_u32 m0, s52, 5120
    s_add_u32 s69, s69, 14336
    s_cmp_eq_u32 s69, 401408
    s_cselect_b32 s69, 0, s69
    buffer_load_dwordx4 v13, s[20:23], s51 offen lds
    s_waitcnt vmcnt(8)
    ds_read_b64_tr_b16 v[40:41], v9 offset:6144
    ds_read_b64_tr_b16 v[42:43], v9 offset:7168
    ds_read_b64_tr_b16 v[44:45], v10 offset:6144
    ds_read_b64_tr_b16 v[46:47], v10 offset:7168
    s_add_u32 m0, s52, 6144
    s_add_u32 s51, s68, s69
    s_waitcnt lgkmcnt(0)
    buffer_load_dwordx4 v5, s[20:23], s51 offen lds
    s_add_u32 m0, s52, 7168
    s_add_u32 s69, s69, 14336
    s_cmp_eq_u32 s69, 401408
    s_cselect_b32 s69, 0, s69
    buffer_load_dwordx4 v13, s[20:23], s51 offen lds
    s_waitcnt vmcnt(8)
    ds_read_b64_tr_b16 v[48:49], v9 offset:8192
    ds_read_b64_tr_b16 v[50:51], v9 offset:9216
    ds_read_b64_tr_b16 v[52:53], v10 offset:8192
    ds_read_b64_tr_b16 v[54:55], v10 offset:9216
    s_add_u32 m0, s52, 8192
    s_add_u32 s51, s68, s69
    s_waitcnt lgkmcnt(0)
    buffer_load_dwordx4 v5, s[20:23], s51 offen lds
    s_add_u32 m0, s52, 9216
    s_add_u32 s69, s69, 14336
    s_cmp_eq_u32 s69, 401408
    s_cselect_b32 s69, 0, s69
    buffer_load_dwordx4 v13, s[20:23], s51 offen lds
    s_waitcnt vmcnt(8)
    ds_read_b64_tr_b16 v[56:57], v9 offset:0
    ds_read_b64_tr_b16 v[58:59], v9 offset:1024
    ds_read_b64_tr_b16 v[60:61], v10 offset:0
    ds_read_b64_tr_b16 v[62:63], v10 offset:1024
    s_add_u32 m0, s52, 0
    s_add_u32 s51, s68, s69
    s_waitcnt lgkmcnt(0)
    buffer_load_dwordx4 v5, s[20:23], s51 offen lds
    s_add_u32 m0, s52, 1024
    s_add_u32 s69, s69, 14336
    s_cmp_eq_u32 s69, 401408
    s_cselect_b32 s69, 0, s69
    buffer_load_dwordx4 v13, s[20:23], s51 offen lds
    s_waitcnt vmcnt(8)
    ds_read_b64_tr_b16 v[64:65], v9 offset:2048
    ds_read_b64_tr_b16 v[66:67], v9 offset:3072
    ds_read_b64_tr_b16 v[68:69], v10 offset:2048
    ds_read_b64_tr_b16 v[70:71], v10 offset:3072
    s_add_u32 m0, s52, 2048
    s_add_u32 s51, s68, s69
    s_waitcnt lgkmcnt(0)
    buffer_load_dwordx4 v5, s[20:23], s51 offen lds
    s_add_u32 m0, s52, 3072
    s_add_u32 s69, s69, 14336
    s_cmp_eq_u32 s69, 401408
    s_cselect_b32 s69, 0, s69
    buffer_load_dwordx4 v13, s[20:23], s51 offen lds
    s_waitcnt vmcnt(8)
    ds_read_b64_tr_b16 v[72:73], v9 offset:4096
    ds_read_b64_tr_b16 v[74:75], v9 offset:5120
    ds_read_b64_tr_b16 v[76:77], v10 offset:4096
    ds_read_b64_tr_b16 v[78:79], v10 offset:5120
    s_waitcnt vmcnt(6)
    ds_read_b64_tr_b16 v[80:81], v9 offset:6144
    ds_read_b64_tr_b16 v[82:83], v9 offset:7168
    ds_read_b64_tr_b16 v[84:85], v10 offset:6144
    ds_read_b64_tr_b16 v[86:87], v10 offset:7168
    s_waitcnt vmcnt(4)
    ds_read_b64_tr_b16 v[88:89], v9 offset:8192
    ds_read_b64_tr_b16 v[90:91], v9 offset:9216
    ds_read_b64_tr_b16 v[92:93], v10 offset:8192
    ds_read_b64_tr_b16 v[94:95], v10 offset:9216
    s_waitcnt vmcnt(2)
    ds_read_b64_tr_b16 v[96:97], v9 offset:0
    ds_read_b64_tr_b16 v[98:99], v9 offset:1024
    ds_read_b64_tr_b16 v[100:101], v10 offset:0
    ds_read_b64_tr_b16 v[102:103], v10 offset:1024
    s_waitcnt vmcnt(0)
    ds_read_b64_tr_b16 v[104:105], v9 offset:2048
    ds_read_b64_tr_b16 v[106:107], v9 offset:3072
    ds_read_b64_tr_b16 v[108:109], v10 offset:2048
    ds_read_b64_tr_b16 v[110:111], v10 offset:3072
    s_mov_b64 exec, 15
    ds_add_u32 v11, v12 offset:256
    s_mov_b64 exec, -1
    s_waitcnt lgkmcnt(0)
    s_mov_b32 s70, 0
L_lw106:
    ds_read_b128 v[188:191], v192 offset:96
    s_add_u32 s70, s70, 1
    s_cmp_gt_u32 s70, 0x1000000
    s_cbranch_scc1 L_lw107
    s_sleep 1
    s_waitcnt lgkmcnt(0)
    v_min3_u32 v188, v188, v189, v190
    v_min_u32 v188, v188, v191
    s_nop 0
    v_readfirstlane_b32 s58, v188
    s_nop 0
    s_cmp_eq_u32 s58, 0
    s_cbranch_scc1 L_lw106
L_lw107:
    s_waitcnt lgkmcnt(0)
    ds_read_b32 v188, v0 offset:256
    s_waitcnt lgkmcnt(0)
    v_readfirstlane_b32 s58, v188
    s_nop 0
    s_cmp_ge_u32 s58, 4
    s_cbranch_scc0 L_ck110
L_ck109:
    s_mul_i32 s53, s59, 24576
    s_add_u32 m0, s53, 0
    s_add_u32 s51, s68, s69
    s_waitcnt vmcnt(20)
    buffer_load_dwordx4 v5, s[20:23], s51 offen lds
    s_add_u32 m0, s53, 1024
    s_add_u32 s69, s69, 14336
    s_cmp_eq_u32 s69, 401408
    s_cselect_b32 s69, 0, s69
    buffer_load_dwordx4 v13, s[20:23], s51 offen lds
    s_add_u32 m0, s53, 2048
    s_add_u32 s51, s68, s69
    s_waitcnt vmcnt(20)
    buffer_load_dwordx4 v5, s[20:23], s51 offen lds
    s_add_u32 m0, s53, 3072
    s_add_u32 s69, s69, 14336
    s_cmp_eq_u32 s69, 401408
    s_cselect_b32 s69, 0, s69
    buffer_load_dwordx4 v13, s[20:23], s51 offen lds
    s_add_u32 m0, s53, 4096
    s_add_u32 s51, s68, s69
    s_waitcnt vmcnt(20)
    buffer_load_dwordx4 v5, s[20:23], s51 offen lds
    s_add_u32 m0, s53, 5120
    s_add_u32 s69, s69, 14336
    s_cmp_eq_u32 s69, 401408
    s_cselect_b32 s69, 0, s69
    buffer_load_dwordx4 v13, s[20:23], s51 offen lds
    s_add_u32 m0, s53, 6144
    s_add_u32 s51, s68, s69
    s_waitcnt vmcnt(20)
    buffer_load_dwordx4 v5, s[20:23], s51 offen lds
    s_add_u32 m0, s53, 7168
    s_add_u32 s69, s69, 14336
    s_cmp_eq_u32 s69, 401408
    s_cselect_b32 s69, 0, s69
    buffer_load_dwordx4 v13, s[20:23], s51 offen lds
    s_add_u32 m0, s53, 8192
    s_add_u32 s51, s68, s69
    s_waitcnt vmcnt(20)
    buffer_load_dwordx4 v5, s[20:23], s51 offen lds
    s_add_u32 m0, s53, 9216
    s_add_u32 s69, s69, 14336
    s_cmp_eq_u32 s69, 401408
    s_cselect_b32 s69, 0, s69
    buffer_load_dwordx4 v13, s[20:23], s51 offen lds
    s_add_u32 m0, s53, 10240
    s_add_u32 s51, s68, s69
    s_waitcnt vmcnt(20)
    buffer_load_dwordx4 v5, s[20:23], s51 offen lds
    s_add_u32 m0, s53, 11264
    s_add_u32 s69, s69, 14336
    s_cmp_eq_u32 s69, 401408
    s_cselect_b32 s69, 0, s69
    buffer_load_dwordx4 v13, s[20:23], s51 offen lds
    s_add_u32 m0, s53, 12288
    s_add_u32 s51, s68, s69
    s_waitcnt vmcnt(20)
    buffer_load_dwordx4 v5, s[20:23], s51 offen lds
    s_add_u32 m0, s53, 13312
    s_add_u32 s69, s69, 14336
    s_cmp_eq_u32 s69, 401408
    s_cselect_b32 s69, 0, s69
    buffer_load_dwordx4 v13, s[20:23], s51 offen lds
    s_add_u32 m0, s53, 14336
    s_add_u32 s51, s68, s69
    s_waitcnt vmcnt(20)
    buffer_load_dwordx4 v5, s[20:23], s51 offen lds
    s_add_u32 m0, s53, 15360
    s_add_u32 s69, s69, 14336
    s_cmp_eq_u32 s69, 401408
    s_cselect_b32 s69, 0, s69
    buffer_load_dwordx4 v13, s[20:23], s51 offen lds
    s_add_u32 m0, s53, 16384
    s_add_u32 s51, s68, s69
    s_waitcnt vmcnt(20)
    buffer_load_dwordx4 v5, s[20:23], s51 offen lds
    s_add_u32 m0, s53, 17408
    s_add_u32 s69, s69, 14336
    s_cmp_eq_u32 s69, 401408
    s_cselect_b32 s69, 0, s69
    buffer_load_dwordx4 v13, s[20:23], s51 offen lds
    s_add_u32 m0, s53, 18432
    s_add_u32 s51, s68, s69
    s_waitcnt vmcnt(20)
    buffer_load_dwordx4 v5, s[20:23], s51 offen lds
    s_add_u32 m0, s53, 19456
    s_add_u32 s69, s69, 14336
    s_cmp_eq_u32 s69, 401408
    s_cselect_b32 s69, 0, s69
    buffer_load_dwordx4 v13, s[20:23], s51 offen lds
    s_add_u32 m0, s53, 20480
    s_add_u32 s51, s68, s69
    s_waitcnt vmcnt(20)
    buffer_load_dwordx4 v5, s[20:23], s51 offen lds
    s_add_u32 m0, s53, 21504
    s_add_u32 s69, s69, 14336
    s_cmp_eq_u32 s69, 401408
    s_cselect_b32 s69, 0, s69
    buffer_load_dwordx4 v13, s[20:23], s51 offen lds
    s_add_u32 m0, s53, 22528
    s_add_u32 s51, s68, s69
    s_waitcnt vmcnt(20)
    buffer_load_dwordx4 v5, s[20:23], s51 offen lds
    s_add_u32 m0, s53, 23552
    s_add_u32 s69, s69, 14336
    s_cmp_eq_u32 s69, 401408
    s_cselect_b32 s69, 0, s69
    buffer_load_dwordx4 v13, s[20:23], s51 offen lds
    s_lshl_b32 s52, s59, 14
    s_add_u32 s52, s52, 98304
    s_lshl_b32 s51, s59, 2
    s_add_u32 s51, s51, 0
    s_mul_i32 s51, s51, 25088
    s_lshl_b32 s58, s41, 7
    s_add_u32 s51, s51, s58
    s_add_u32 m0, s52, 0
    s_waitcnt vmcnt(20)
    s_nop 0
    buffer_load_dwordx4 v5, s[24:27], s51 offen lds
    s_add_u32 m0, s52, 1024
    s_waitcnt vmcnt(20)
    s_nop 0
    buffer_load_dwordx4 v13, s[24:27], s51 offen lds
    s_lshl_b32 s52, s59, 14
    s_add_u32 s52, s52, 98304
    s_lshl_b32 s51, s59, 2
    s_add_u32 s51, s51, 0
    s_mul_i32 s51, s51, 25088
    s_lshl_b32 s58, s41, 7
    s_add_u32 s51, s51, s58
    s_add_u32 s51, s51, 14336
    s_add_u32 m0, s52, 2048
    s_waitcnt vmcnt(20)
    s_nop 0
    buffer_load_dwordx4 v5, s[24:27], s51 offen lds
    s_add_u32 m0, s52, 3072
    s_waitcnt vmcnt(20)
    s_nop 0
    buffer_load_dwordx4 v13, s[24:27], s51 offen lds
    s_lshl_b32 s52, s59, 14
    s_add_u32 s52, s52, 98304
    s_lshl_b32 s51, s59, 2
    s_add_u32 s51, s51, 1
    s_mul_i32 s51, s51, 25088
    s_lshl_b32 s58, s41, 7
    s_add_u32 s51, s51, s58
    s_add_u32 m0, s52, 4096
    s_waitcnt vmcnt(20)
    s_nop 0
    buffer_load_dwordx4 v5, s[24:27], s51 offen lds
    s_add_u32 m0, s52, 5120
    s_waitcnt vmcnt(20)
    s_nop 0
    buffer_load_dwordx4 v13, s[24:27], s51 offen lds
    s_lshl_b32 s52, s59, 14
    s_add_u32 s52, s52, 98304
    s_lshl_b32 s51, s59, 2
    s_add_u32 s51, s51, 1
    s_mul_i32 s51, s51, 25088
    s_lshl_b32 s58, s41, 7
    s_add_u32 s51, s51, s58
    s_add_u32 s51, s51, 14336
    s_add_u32 m0, s52, 6144
    s_waitcnt vmcnt(20)
    s_nop 0
    buffer_load_dwordx4 v5, s[24:27], s51 offen lds
    s_add_u32 m0, s52, 7168
    s_waitcnt vmcnt(20)
    s_nop 0
    buffer_load_dwordx4 v13, s[24:27], s51 offen lds
    s_lshl_b32 s52, s59, 14
    s_add_u32 s52, s52, 98304
    s_lshl_b32 s51, s59, 2
    s_add_u32 s51, s51, 2
    s_mul_i32 s51, s51, 25088
    s_lshl_b32 s58, s41, 7
    s_add_u32 s51, s51, s58
    s_add_u32 m0, s52, 8192
    s_waitcnt vmcnt(20)
    s_nop 0
    buffer_load_dwordx4 v5, s[24:27], s51 offen lds
    s_add_u32 m0, s52, 9216
    s_waitcnt vmcnt(20)
    s_nop 0
    buffer_load_dwordx4 v13, s[24:27], s51 offen lds
    s_lshl_b32 s52, s59, 14
    s_add_u32 s52, s52, 98304
    s_lshl_b32 s51, s59, 2
    s_add_u32 s51, s51, 2
    s_mul_i32 s51, s51, 25088
    s_lshl_b32 s58, s41, 7
    s_add_u32 s51, s51, s58
    s_add_u32 s51, s51, 14336
    s_add_u32 m0, s52, 10240
    s_waitcnt vmcnt(20)
    s_nop 0
    buffer_load_dwordx4 v5, s[24:27], s51 offen lds
    s_add_u32 m0, s52, 11264
    s_waitcnt vmcnt(20)
    s_nop 0
    buffer_load_dwordx4 v13, s[24:27], s51 offen lds
    s_lshl_b32 s52, s59, 14
    s_add_u32 s52, s52, 98304
    s_lshl_b32 s51, s59, 2
    s_add_u32 s51, s51, 3
    s_mul_i32 s51, s51, 25088
    s_lshl_b32 s58, s41, 7
    s_add_u32 s51, s51, s58
    s_add_u32 m0, s52, 12288
    s_waitcnt vmcnt(20)
    s_nop 0
    buffer_load_dwordx4 v5, s[24:27], s51 offen lds
    s_add_u32 m0, s52, 13312
    s_waitcnt vmcnt(20)
    s_nop 0
    buffer_load_dwordx4 v13, s[24:27], s51 offen lds
    s_lshl_b32 s52, s59, 14
    s_add_u32 s52, s52, 98304
    s_lshl_b32 s51, s59, 2
    s_add_u32 s51, s51, 3
    s_mul_i32 s51, s51, 25088
    s_lshl_b32 s58, s41, 7
    s_add_u32 s51, s51, s58
    s_add_u32 s51, s51, 14336
    s_add_u32 m0, s52, 14336
    s_waitcnt vmcnt(20)
    s_nop 0
    buffer_load_dwordx4 v5, s[24:27], s51 offen lds
    s_add_u32 m0, s52, 15360
    s_waitcnt vmcnt(20)
    s_cmp_eq_u32 s59, 3
    s_cselect_b32 exec_hi, 0, -1
    buffer_load_dwordx4 v13, s[24:27], s51 offen lds
    s_mov_b64 exec, -1
    s_mov_b64 exec, 15
    ds_add_u32 v11, v12 offset:384
    s_mov_b64 exec, -1
    s_setprio 1
    s_mul_i32 s53, s59, 24576
    v_add_u32 v10, s53, v7
    v_add_u32 v11, s53, v6
    s_mul_i32 s66, s40, 229376
    s_mul_i32 s52, s59, 28672
    s_add_u32 s66, s66, s52
    s_add_u32 s66, s66, 0
    s_lshl_b32 s65, s57, 10
    s_and_b32 s52, s59, 1
    s_mul_i32 s52, s52, 114688
    v_add_u32 v15, s52, v2
    s_sub_u32 s52, 114688, s52
    v_add_u32 v14, s52, v2
    v_mov_b32 v12, v11
    v_mov_b32 v11, v5
    v_and_b32 v8, 31, v1
    v_mul_u32_u24 v3, 896, v8
    v_lshrrev_b32 v8, 5, v1
    v_lshl_add_u32 v3, v8, 4, v3
    s_and_b32 s50, s59, 1
    s_lshl_b32 s51, s40, 1
    s_add_u32 s50, s50, s51
    s_mul_i32 s60, s50, 28672
    s_lshr_b32 s50, s59, 1
    s_lshl_b32 s50, s50, 6
    s_add_u32 s60, s60, s50
    s_lshl_b32 s50, s41, 7
    s_add_u32 s60, s60, s50
    buffer_load_dwordx4 v[4:7], v3, s[8:11], s60 offen offset:0
    s_waitcnt lgkmcnt(0)
    v_lshlrev_b32 v8, 7, v1
    s_lshl_b32 s50, s40, 3
    s_add_u32 s50, s50, s41
    s_lshl_b32 s50, s50, 12
    s_lshl_b32 s51, s59, 9
    s_add_u32 s50, s50, s51
    s_add_u32 s50, s50, 13697024
    s_mov_b64 exec, 0xf
    s_mov_b32 s58, 0
L_pl111:
    buffer_load_dword v9, v8, s[16:19], s50 offen sc1
    s_waitcnt vmcnt(0)
    v_cmp_ne_u32 vcc, s43, v9
    s_add_u32 s58, s58, 1
    s_cbranch_vccz L_pl112
    s_cmp_gt_u32 s58, 0x400000
    s_cbranch_scc1 L_pl112
    s_sleep 12
    s_branch L_pl111
L_pl112:
    s_mov_b64 exec, -1
    v_mov_b32 v9, v12
    v_mov_b32 v12, 4
    v_lshlrev_b32 v8, 2, v1
    v_add_u32 v8, 163328, v8
    v_mov_b32 v255, 1
    s_mov_b64 exec, 15
    ds_add_u32 v8, v255 offset:240
    s_mov_b64 exec, -1
    s_waitcnt lgkmcnt(0)
    s_add_u32 s50, s66, s65
    buffer_load_dwordx4 v[112:115], v14, s[16:19], s50 offen sc1
    buffer_load_dwordx4 v[116:119], v15, s[16:19], s50 offen sc1
    s_add_u32 s65, s65, 1024
    s_cmp_eq_u32 s65, 28672
    s_cselect_b32 s65, 0, s65
    s_add_u32 s50, s66, s65
    buffer_load_dwordx4 v[120:123], v14, s[16:19], s50 offen sc1
    buffer_load_dwordx4 v[124:127], v15, s[16:19], s50 offen sc1
    s_add_u32 s65, s65, 1024
    s_cmp_eq_u32 s65, 28672
    s_cselect_b32 s65, 0, s65
    s_add_u32 s50, s66, s65
    buffer_load_dwordx4 v[128:131], v14, s[16:19], s50 offen sc1
    buffer_load_dwordx4 v[132:135], v15, s[16:19], s50 offen sc1
    s_add_u32 s65, s65, 1024
    s_cmp_eq_u32 s65, 28672
    s_cselect_b32 s65, 0, s65
    s_add_u32 s50, s66, s65
    buffer_load_dwordx4 v[136:139], v14, s[16:19], s50 offen sc1
    buffer_load_dwordx4 v[140:143], v15, s[16:19], s50 offen sc1
    s_add_u32 s65, s65, 1024
    s_cmp_eq_u32 s65, 28672
    s_cselect_b32 s65, 0, s65
    s_add_u32 s50, s66, s65
    buffer_load_dwordx4 v[208:211], v14, s[16:19], s50 offen sc1
    buffer_load_dwordx4 v[212:215], v15, s[16:19], s50 offen sc1
    s_add_u32 s65, s65, 1024
    s_cmp_eq_u32 s65, 28672
    s_cselect_b32 s65, 0, s65
    s_add_u32 s50, s66, s65
    buffer_load_dwordx4 v[216:219], v14, s[16:19], s50 offen sc1
    buffer_load_dwordx4 v[220:223], v15, s[16:19], s50 offen sc1
    s_add_u32 s65, s65, 1024
    s_cmp_eq_u32 s65, 28672
    s_cselect_b32 s65, 0, s65
    s_add_u32 s50, s66, s65
    buffer_load_dwordx4 v[224:227], v14, s[16:19], s50 offen sc1
    buffer_load_dwordx4 v[228:231], v15, s[16:19], s50 offen sc1
    s_add_u32 s65, s65, 1024
    s_cmp_eq_u32 s65, 28672
    s_cselect_b32 s65, 0, s65
    s_add_u32 s50, s66, s65
    buffer_load_dwordx4 v[232:235], v14, s[16:19], s50 offen sc1
    buffer_load_dwordx4 v[236:239], v15, s[16:19], s50 offen sc1
    s_add_u32 s65, s65, 1024
    s_cmp_eq_u32 s65, 28672
    s_cselect_b32 s65, 0, s65
    s_add_u32 s50, s66, s65
    buffer_load_dwordx4 v[240:243], v14, s[16:19], s50 offen sc1
    buffer_load_dwordx4 v[244:247], v15, s[16:19], s50 offen sc1
    s_add_u32 s65, s65, 1024
    s_cmp_eq_u32 s65, 28672
    s_cselect_b32 s65, 0, s65
    s_add_u32 s50, s66, s65
    buffer_load_dwordx4 v[248:251], v14, s[16:19], s50 offen sc1
    buffer_load_dwordx4 v[252:255], v15, s[16:19], s50 offen sc1
    s_add_u32 s65, s65, 1024
    s_cmp_eq_u32 s65, 28672
    s_cselect_b32 s65, 0, s65
    s_waitcnt vmcnt(19)
    v_mfma_f32_32x32x16_bf16 v[144:159], v[16:19], v[112:115], 0
    s_waitcnt vmcnt(18)
    v_mfma_f32_32x32x16_bf16 v[160:175], v[16:19], v[116:119], 0
    v_mfma_f32_32x32x16_bf16 v[176:191], v[20:23], v[112:115], 0
    v_mfma_f32_32x32x16_bf16 v[192:207], v[20:23], v[116:119], 0
    s_add_u32 s50, s66, s65
    buffer_load_dwordx4 v[16:19], v14, s[16:19], s50 offen sc1
    buffer_load_dwordx4 v[20:23], v15, s[16:19], s50 offen sc1
    s_add_u32 s65, s65, 1024
    s_cmp_eq_u32 s65, 28672
    s_cselect_b32 s65, 0, s65
    s_add_u32 s50, s66, s65
    buffer_load_dwordx4 v[112:115], v14, s[16:19], s50 offen sc1
    buffer_load_dwordx4 v[116:119], v15, s[16:19], s50 offen sc1
    s_add_u32 s65, s65, 1024
    s_cmp_eq_u32 s65, 28672
    s_cselect_b32 s65, 0, s65
    s_waitcnt vmcnt(21)
    v_mfma_f32_32x32x16_bf16 v[144:159], v[24:27], v[120:123], v[144:159]
    s_waitcnt vmcnt(20)
    v_mfma_f32_32x32x16_bf16 v[160:175], v[24:27], v[124:127], v[160:175]
    v_mfma_f32_32x32x16_bf16 v[176:191], v[28:31], v[120:123], v[176:191]
    v_mfma_f32_32x32x16_bf16 v[192:207], v[28:31], v[124:127], v[192:207]
    s_add_u32 s50, s66, s65
    buffer_load_dwordx4 v[24:27], v14, s[16:19], s50 offen sc1
    buffer_load_dwordx4 v[28:31], v15, s[16:19], s50 offen sc1
    s_add_u32 s65, s65, 1024
    s_cmp_eq_u32 s65, 28672
    s_cselect_b32 s65, 0, s65
    s_add_u32 s50, s66, s65
    buffer_load_dwordx4 v[120:123], v14, s[16:19], s50 offen sc1
    buffer_load_dwordx4 v[124:127], v15, s[16:19], s50 offen sc1
    s_add_u32 s65, s65, 1024
    s_cmp_eq_u32 s65, 28672
    s_cselect_b32 s65, 0, s65
    s_waitcnt vmcnt(23)
    v_mfma_f32_32x32x16_bf16 v[144:159], v[32:35], v[128:131], v[144:159]
    s_waitcnt vmcnt(22)
    v_mfma_f32_32x32x16_bf16 v[160:175], v[32:35], v[132:135], v[160:175]
    v_mfma_f32_32x32x16_bf16 v[176:191], v[36:39], v[128:131], v[176:191]
    v_mfma_f32_32x32x16_bf16 v[192:207], v[36:39], v[132:135], v[192:207]
    s_add_u32 s50, s66, s65
    buffer_load_dwordx4 v[32:35], v14, s[16:19], s50 offen sc1
    buffer_load_dwordx4 v[36:39], v15, s[16:19], s50 offen sc1
    s_add_u32 s65, s65, 1024
    s_cmp_eq_u32 s65, 28672
    s_cselect_b32 s65, 0, s65
    s_add_u32 s50, s66, s65
    buffer_load_dwordx4 v[128:131], v14, s[16:19], s50 offen sc1
    buffer_load_dwordx4 v[132:135], v15, s[16:19], s50 offen sc1
    s_add_u32 s65, s65, 1024
    s_cmp_eq_u32 s65, 28672
    s_cselect_b32 s65, 0, s65
    s_waitcnt vmcnt(25)
    v_mfma_f32_32x32x16_bf16 v[144:159], v[40:43], v[136:139], v[144:159]
    s_waitcnt vmcnt(24)
    v_mfma_f32_32x32x16_bf16 v[160:175], v[40:43], v[140:143], v[160:175]
    v_mfma_f32_32x32x16_bf16 v[176:191], v[44:47], v[136:139], v[176:191]
    v_mfma_f32_32x32x16_bf16 v[192:207], v[44:47], v[140:143], v[192:207]
    s_add_u32 s50, s66, s65
    buffer_load_dwordx4 v[40:43], v14, s[16:19], s50 offen sc1
    buffer_load_dwordx4 v[44:47], v15, s[16:19], s50 offen sc1
    s_add_u32 s65, s65, 1024
    s_cmp_eq_u32 s65, 28672
    s_cselect_b32 s65, 0, s65
    s_add_u32 s50, s66, s65
    buffer_load_dwordx4 v[136:139], v14, s[16:19], s50 offen sc1
    buffer_load_dwordx4 v[140:143], v15, s[16:19], s50 offen sc1
    s_add_u32 s65, s65, 1024
    s_cmp_eq_u32 s65, 28672
    s_cselect_b32 s65, 0, s65
    s_waitcnt vmcnt(27)
    v_mfma_f32_32x32x16_bf16 v[144:159], v[48:51], v[208:211], v[144:159]
    s_waitcnt vmcnt(26)
    v_mfma_f32_32x32x16_bf16 v[160:175], v[48:51], v[212:215], v[160:175]
    v_mfma_f32_32x32x16_bf16 v[176:191], v[52:55], v[208:211], v[176:191]
    v_mfma_f32_32x32x16_bf16 v[192:207], v[52:55], v[212:215], v[192:207]
    s_add_u32 s50, s66, s65
    buffer_load_dwordx4 v[48:51], v14, s[16:19], s50 offen sc1
    buffer_load_dwordx4 v[52:55], v15, s[16:19], s50 offen sc1
    s_add_u32 s65, s65, 1024
    s_cmp_eq_u32 s65, 28672
    s_cselect_b32 s65, 0, s65
    s_add_u32 s50, s66, s65
    buffer_load_dwordx4 v[208:211], v14, s[16:19], s50 offen sc1
    buffer_load_dwordx4 v[212:215], v15, s[16:19], s50 offen sc1
    s_add_u32 s65, s65, 1024
    s_cmp_eq_u32 s65, 28672
    s_cselect_b32 s65, 0, s65
    s_waitcnt vmcnt(29)
    v_mfma_f32_32x32x16_bf16 v[144:159], v[56:59], v[216:219], v[144:159]
    s_waitcnt vmcnt(28)
    v_mfma_f32_32x32x16_bf16 v[160:175], v[56:59], v[220:223], v[160:175]
    v_mfma_f32_32x32x16_bf16 v[176:191], v[60:63], v[216:219], v[176:191]
    v_mfma_f32_32x32x16_bf16 v[192:207], v[60:63], v[220:223], v[192:207]
    s_add_u32 s50, s66, s65
    buffer_load_dwordx4 v[56:59], v14, s[16:19], s50 offen sc1
    buffer_load_dwordx4 v[60:63], v15, s[16:19], s50 offen sc1
    s_add_u32 s65, s65, 1024
    s_cmp_eq_u32 s65, 28672
    s_cselect_b32 s65, 0, s65
    s_add_u32 s50, s66, s65
    buffer_load_dwordx4 v[216:219], v14, s[16:19], s50 offen sc1
    buffer_load_dwordx4 v[220:223], v15, s[16:19], s50 offen sc1
    s_add_u32 s65, s65, 1024
    s_cmp_eq_u32 s65, 28672
    s_cselect_b32 s65, 0, s65
    s_waitcnt vmcnt(31)
    v_mfma_f32_32x32x16_bf16 v[144:159], v[64:67], v[224:227], v[144:159]
    s_waitcnt vmcnt(30)
    v_mfma_f32_32x32x16_bf16 v[160:175], v[64:67], v[228:231], v[160:175]
    v_mfma_f32_32x32x16_bf16 v[176:191], v[68:71], v[224:227], v[176:191]
    v_mfma_f32_32x32x16_bf16 v[192:207], v[68:71], v[228:231], v[192:207]
    s_add_u32 s50, s66, s65
    buffer_load_dwordx4 v[224:227], v14, s[16:19], s50 offen sc1
    buffer_load_dwordx4 v[228:231], v15, s[16:19], s50 offen sc1
    s_add_u32 s65, s65, 1024
    s_cmp_eq_u32 s65, 28672
    s_cselect_b32 s65, 0, s65
    s_waitcnt vmcnt(31)
    v_mfma_f32_32x32x16_bf16 v[144:159], v[72:75], v[232:235], v[144:159]
    s_waitcnt vmcnt(30)
    v_mfma_f32_32x32x16_bf16 v[160:175], v[72:75], v[236:239], v[160:175]
    v_mfma_f32_32x32x16_bf16 v[176:191], v[76:79], v[232:235], v[176:191]
    v_mfma_f32_32x32x16_bf16 v[192:207], v[76:79], v[236:239], v[192:207]
    s_add_u32 s50, s66, s65
    buffer_load_dwordx4 v[232:235], v14, s[16:19], s50 offen sc1
    buffer_load_dwordx4 v[236:239], v15, s[16:19], s50 offen sc1
    s_add_u32 s65, s65, 1024
    s_cmp_eq_u32 s65, 28672
    s_cselect_b32 s65, 0, s65
    s_waitcnt vmcnt(31)
    v_mfma_f32_32x32x16_bf16 v[144:159], v[80:83], v[240:243], v[144:159]
    s_waitcnt vmcnt(30)
    v_mfma_f32_32x32x16_bf16 v[160:175], v[80:83], v[244:247], v[160:175]
    v_mfma_f32_32x32x16_bf16 v[176:191], v[84:87], v[240:243], v[176:191]
    v_mfma_f32_32x32x16_bf16 v[192:207], v[84:87], v[244:247], v[192:207]
    s_add_u32 s50, s66, s65
    buffer_load_dwordx4 v[240:243], v14, s[16:19], s50 offen sc1
    buffer_load_dwordx4 v[244:247], v15, s[16:19], s50 offen sc1
    s_add_u32 s65, s65, 1024
    s_cmp_eq_u32 s65, 28672
    s_cselect_b32 s65, 0, s65
    s_waitcnt vmcnt(31)
    v_mfma_f32_32x32x16_bf16 v[144:159], v[88:91], v[248:251], v[144:159]
    s_waitcnt vmcnt(30)
    v_mfma_f32_32x32x16_bf16 v[160:175], v[88:91], v[252:255], v[160:175]
    v_mfma_f32_32x32x16_bf16 v[176:191], v[92:95], v[248:251], v[176:191]
    v_mfma_f32_32x32x16_bf16 v[192:207], v[92:95], v[252:255], v[192:207]
    s_add_u32 s50, s66, s65
    buffer_load_dwordx4 v[88:91], v14, s[16:19], s50 offen sc1
    buffer_load_dwordx4 v[92:95], v15, s[16:19], s50 offen sc1
    s_add_u32 s65, s65, 1024
    s_cmp_eq_u32 s65, 28672
    s_cselect_b32 s65, 0, s65
    s_add_u32 s50, s66, s65
    buffer_load_dwordx4 v[248:251], v14, s[16:19], s50 offen sc1
    buffer_load_dwordx4 v[252:255], v15, s[16:19], s50 offen sc1
    s_add_u32 s65, s65, 1024
    s_cmp_eq_u32 s65, 28672
    s_cselect_b32 s65, 0, s65
    s_waitcnt vmcnt(33)
    v_mfma_f32_32x32x16_bf16 v[144:159], v[96:99], v[16:19], v[144:159]
    ds_read_b64_tr_b16 v[64:65], v9 offset:0
    ds_read_b64_tr_b16 v[66:67], v9 offset:1024
    ds_read_b64_tr_b16 v[68:69], v10 offset:0
    ds_read_b64_tr_b16 v[70:71], v10 offset:1024
    s_waitcnt vmcnt(32)
    v_mfma_f32_32x32x16_bf16 v[160:175], v[96:99], v[20:23], v[160:175]
    v_mfma_f32_32x32x16_bf16 v[176:191], v[100:103], v[16:19], v[176:191]
    v_mfma_f32_32x32x16_bf16 v[192:207], v[100:103], v[20:23], v[192:207]
    s_add_u32 s50, s66, s65
    buffer_load_dwordx4 v[96:99], v14, s[16:19], s50 offen sc1
    buffer_load_dwordx4 v[100:103], v15, s[16:19], s50 offen sc1
    s_waitcnt vmcnt(33)
    v_mfma_f32_32x32x16_bf16 v[144:159], v[104:107], v[112:115], v[144:159]
    ds_read_b64_tr_b16 v[72:73], v9 offset:2048
    ds_read_b64_tr_b16 v[74:75], v9 offset:3072
    ds_read_b64_tr_b16 v[76:77], v10 offset:2048
    ds_read_b64_tr_b16 v[78:79], v10 offset:3072
    s_waitcnt vmcnt(32)
    v_mfma_f32_32x32x16_bf16 v[160:175], v[104:107], v[116:119], v[160:175]
    v_mfma_f32_32x32x16_bf16 v[176:191], v[108:111], v[112:115], v[176:191]
    v_mfma_f32_32x32x16_bf16 v[192:207], v[108:111], v[116:119], v[192:207]
    s_waitcnt vmcnt(31) lgkmcnt(6)
    v_mfma_f32_32x32x16_bf16 v[144:159], v[64:67], v[24:27], v[144:159]
    ds_read_b64_tr_b16 v[80:81], v9 offset:4096
    ds_read_b64_tr_b16 v[82:83], v9 offset:5120
    ds_read_b64_tr_b16 v[84:85], v10 offset:4096
    ds_read_b64_tr_b16 v[86:87], v10 offset:5120
    s_waitcnt vmcnt(30)
    v_mfma_f32_32x32x16_bf16 v[160:175], v[64:67], v[28:31], v[160:175]
    s_waitcnt lgkmcnt(8)
    v_mfma_f32_32x32x16_bf16 v[176:191], v[68:71], v[24:27], v[176:191]
    v_mfma_f32_32x32x16_bf16 v[192:207], v[68:71], v[28:31], v[192:207]
    s_add_u32 m0, s53, 0
    s_add_u32 s51, s68, s69
    buffer_load_dwordx4 v11, s[20:23], s51 offen lds
    s_add_u32 m0, s53, 1024
    s_add_u32 s69, s69, 14336
    s_cmp_eq_u32 s69, 401408
    s_cselect_b32 s69, 0, s69
    buffer_load_dwordx4 v13, s[20:23], s51 offen lds
    s_waitcnt vmcnt(31) lgkmcnt(6)
    v_mfma_f32_32x32x16_bf16 v[144:159], v[72:75], v[120:123], v[144:159]
    ds_read_b64_tr_b16 v[64:65], v9 offset:6144
    ds_read_b64_tr_b16 v[66:67], v9 offset:7168
    ds_read_b64_tr_b16 v[68:69], v10 offset:6144
    ds_read_b64_tr_b16 v[70:71], v10 offset:7168
    s_waitcnt vmcnt(30)
    v_mfma_f32_32x32x16_bf16 v[160:175], v[72:75], v[124:127], v[160:175]
    s_waitcnt lgkmcnt(8)
    v_mfma_f32_32x32x16_bf16 v[176:191], v[76:79], v[120:123], v[176:191]
    v_mfma_f32_32x32x16_bf16 v[192:207], v[76:79], v[124:127], v[192:207]
    s_add_u32 m0, s53, 2048
    s_add_u32 s51, s68, s69
    buffer_load_dwordx4 v11, s[20:23], s51 offen lds
    s_add_u32 m0, s53, 3072
    s_add_u32 s69, s69, 14336
    s_cmp_eq_u32 s69, 401408
    s_cselect_b32 s69, 0, s69
    buffer_load_dwordx4 v13, s[20:23], s51 offen lds
    s_waitcnt vmcnt(31) lgkmcnt(6)
    v_mfma_f32_32x32x16_bf16 v[144:159], v[80:83], v[32:35], v[144:159]
    ds_read_b64_tr_b16 v[72:73], v9 offset:8192
    ds_read_b64_tr_b16 v[74:75], v9 offset:9216
    ds_read_b64_tr_b16 v[76:77], v10 offset:8192
    ds_read_b64_tr_b16 v[78:79], v10 offset:9216
    s_waitcnt vmcnt(30)
    v_mfma_f32_32x32x16_bf16 v[160:175], v[80:83], v[36:39], v[160:175]
    s_waitcnt lgkmcnt(8)
    v_mfma_f32_32x32x16_bf16 v[176:191], v[84:87], v[32:35], v[176:191]
    v_mfma_f32_32x32x16_bf16 v[192:207], v[84:87], v[36:39], v[192:207]
    s_add_u32 m0, s53, 4096
    s_add_u32 s51, s68, s69
    buffer_load_dwordx4 v11, s[20:23], s51 offen lds
    s_add_u32 m0, s53, 5120
    s_add_u32 s69, s69, 14336
    s_cmp_eq_u32 s69, 401408
    s_cselect_b32 s69, 0, s69
    buffer_load_dwordx4 v13, s[20:23], s51 offen lds
    s_waitcnt vmcnt(31) lgkmcnt(6)
    v_mfma_f32_32x32x16_bf16 v[144:159], v[64:67], v[128:131], v[144:159]
    ds_read_b64_tr_b16 v[80:81], v9 offset:10240
    ds_read_b64_tr_b16 v[82:83], v9 offset:11264
    ds_read_b64_tr_b16 v[84:85], v10 offset:10240
    ds_read_b64_tr_b16 v[86:87], v10 offset:11264
    s_waitcnt vmcnt(30)
    v_mfma_f32_32x32x16_bf16 v[160:175], v[64:67], v[132:135], v[160:175]
    s_waitcnt lgkmcnt(8)
    v_mfma_f32_32x32x16_bf16 v[176:191], v[68:71], v[128:131], v[176:191]
    v_mfma_f32_32x32x16_bf16 v[192:207], v[68:71], v[132:135], v[192:207]
    s_add_u32 m0, s53, 6144
    s_add_u32 s51, s68, s69
    buffer_load_dwordx4 v11, s[20:23], s51 offen lds
    s_add_u32 m0, s53, 7168
    s_add_u32 s69, s69, 14336
    s_cmp_eq_u32 s69, 401408
    s_cselect_b32 s69, 0, s69
    buffer_load_dwordx4 v13, s[20:23], s51 offen lds
    s_waitcnt vmcnt(31) lgkmcnt(6)
    v_mfma_f32_32x32x16_bf16 v[144:159], v[72:75], v[40:43], v[144:159]
    ds_read_b64_tr_b16 v[64:65], v9 offset:12288
    ds_read_b64_tr_b16 v[66:67], v9 offset:13312
    ds_read_b64_tr_b16 v[68:69], v10 offset:12288
    ds_read_b64_tr_b16 v[70:71], v10 offset:13312
    s_waitcnt vmcnt(30)
    v_mfma_f32_32x32x16_bf16 v[160:175], v[72:75], v[44:47], v[160:175]
    s_waitcnt lgkmcnt(8)
    v_mfma_f32_32x32x16_bf16 v[176:191], v[76:79], v[40:43], v[176:191]
    v_mfma_f32_32x32x16_bf16 v[192:207], v[76:79], v[44:47], v[192:207]
    s_waitcnt vmcnt(29) lgkmcnt(6)
    v_mfma_f32_32x32x16_bf16 v[144:159], v[80:83], v[136:139], v[144:159]
    ds_read_b64_tr_b16 v[72:73], v9 offset:14336
    ds_read_b64_tr_b16 v[74:75], v9 offset:15360
    ds_read_b64_tr_b16 v[76:77], v10 offset:14336
    ds_read_b64_tr_b16 v[78:79], v10 offset:15360
    s_waitcnt vmcnt(28)
    v_mfma_f32_32x32x16_bf16 v[160:175], v[80:83], v[140:143], v[160:175]
    s_waitcnt lgkmcnt(8)
    v_mfma_f32_32x32x16_bf16 v[176:191], v[84:87], v[136:139], v[176:191]
    v_mfma_f32_32x32x16_bf16 v[192:207], v[84:87], v[140:143], v[192:207]
    s_waitcnt vmcnt(27) lgkmcnt(6)
    v_mfma_f32_32x32x16_bf16 v[144:159], v[64:67], v[48:51], v[144:159]
    ds_read_b64_tr_b16 v[80:81], v9 offset:16384
    ds_read_b64_tr_b16 v[82:83], v9 offset:17408
    ds_read_b64_tr_b16 v[84:85], v10 offset:16384
    ds_read_b64_tr_b16 v[86:87], v10 offset:17408
    s_waitcnt vmcnt(26)
    v_mfma_f32_32x32x16_bf16 v[160:175], v[64:67], v[52:55], v[160:175]
    s_waitcnt lgkmcnt(8)
    v_mfma_f32_32x32x16_bf16 v[176:191], v[68:71], v[48:51], v[176:191]
    v_mfma_f32_32x32x16_bf16 v[192:207], v[68:71], v[52:55], v[192:207]
    s_waitcnt vmcnt(25) lgkmcnt(6)
    v_mfma_f32_32x32x16_bf16 v[144:159], v[72:75], v[208:211], v[144:159]
    ds_read_b64_tr_b16 v[64:65], v9 offset:18432
    ds_read_b64_tr_b16 v[66:67], v9 offset:19456
    ds_read_b64_tr_b16 v[68:69], v10 offset:18432
    ds_read_b64_tr_b16 v[70:71], v10 offset:19456
    s_waitcnt vmcnt(24)
    v_mfma_f32_32x32x16_bf16 v[160:175], v[72:75], v[212:215], v[160:175]
    s_waitcnt lgkmcnt(8)
    v_mfma_f32_32x32x16_bf16 v[176:191], v[76:79], v[208:211], v[176:191]
    v_mfma_f32_32x32x16_bf16 v[192:207], v[76:79], v[212:215], v[192:207]
    s_waitcnt vmcnt(23) lgkmcnt(6)
    v_mfma_f32_32x32x16_bf16 v[144:159], v[80:83], v[56:59], v[144:159]
    ds_read_b64_tr_b16 v[72:73], v9 offset:20480
    ds_read_b64_tr_b16 v[74:75], v9 offset:21504
    ds_read_b64_tr_b16 v[76:77], v10 offset:20480
    ds_read_b64_tr_b16 v[78:79], v10 offset:21504
    s_waitcnt vmcnt(22)
    v_mfma_f32_32x32x16_bf16 v[160:175], v[80:83], v[60:63], v[160:175]
    s_waitcnt lgkmcnt(8)
    v_mfma_f32_32x32x16_bf16 v[176:191], v[84:87], v[56:59], v[176:191]
    v_mfma_f32_32x32x16_bf16 v[192:207], v[84:87], v[60:63], v[192:207]
    s_waitcnt vmcnt(21) lgkmcnt(6)
    v_mfma_f32_32x32x16_bf16 v[144:159], v[64:67], v[216:219], v[144:159]
    ds_read_b64_tr_b16 v[80:81], v9 offset:22528
    ds_read_b64_tr_b16 v[82:83], v9 offset:23552
    ds_read_b64_tr_b16 v[84:85], v10 offset:22528
    ds_read_b64_tr_b16 v[86:87], v10 offset:23552
    s_waitcnt vmcnt(20)
    v_mfma_f32_32x32x16_bf16 v[160:175], v[64:67], v[220:223], v[160:175]
    s_waitcnt lgkmcnt(8)
    v_mfma_f32_32x32x16_bf16 v[176:191], v[68:71], v[216:219], v[176:191]
    v_mfma_f32_32x32x16_bf16 v[192:207], v[68:71], v[220:223], v[192:207]
    s_waitcnt vmcnt(19) lgkmcnt(6)
    v_mfma_f32_32x32x16_bf16 v[144:159], v[72:75], v[224:227], v[144:159]
    s_waitcnt vmcnt(6)
    ds_read_b64_tr_b16 v[64:65], v9 offset:0
    ds_read_b64_tr_b16 v[66:67], v9 offset:1024
    ds_read_b64_tr_b16 v[68:69], v10 offset:0
    ds_read_b64_tr_b16 v[70:71], v10 offset:1024
    v_mfma_f32_32x32x16_bf16 v[160:175], v[72:75], v[228:231], v[160:175]
    s_waitcnt lgkmcnt(8)
    v_mfma_f32_32x32x16_bf16 v[176:191], v[76:79], v[224:227], v[176:191]
    v_mfma_f32_32x32x16_bf16 v[192:207], v[76:79], v[228:231], v[192:207]
    s_waitcnt lgkmcnt(6)
    v_mfma_f32_32x32x16_bf16 v[144:159], v[80:83], v[232:235], v[144:159]
    s_waitcnt vmcnt(4)
    ds_read_b64_tr_b16 v[72:73], v9 offset:2048
    ds_read_b64_tr_b16 v[74:75], v9 offset:3072
    ds_read_b64_tr_b16 v[76:77], v10 offset:2048
    ds_read_b64_tr_b16 v[78:79], v10 offset:3072
    v_mfma_f32_32x32x16_bf16 v[160:175], v[80:83], v[236:239], v[160:175]
    s_waitcnt lgkmcnt(8)
    v_mfma_f32_32x32x16_bf16 v[176:191], v[84:87], v[232:235], v[176:191]
    v_mfma_f32_32x32x16_bf16 v[192:207], v[84:87], v[236:239], v[192:207]
    s_waitcnt lgkmcnt(6)
    v_mfma_f32_32x32x16_bf16 v[144:159], v[64:67], v[240:243], v[144:159]
    s_waitcnt vmcnt(2)
    ds_read_b64_tr_b16 v[80:81], v9 offset:4096
    ds_read_b64_tr_b16 v[82:83], v9 offset:5120
    ds_read_b64_tr_b16 v[84:85], v10 offset:4096
    ds_read_b64_tr_b16 v[86:87], v10 offset:5120
    v_mfma_f32_32x32x16_bf16 v[160:175], v[64:67], v[244:247], v[160:175]
    s_waitcnt lgkmcnt(8)
    v_mfma_f32_32x32x16_bf16 v[176:191], v[68:71], v[240:243], v[176:191]
    v_mfma_f32_32x32x16_bf16 v[192:207], v[68:71], v[244:247], v[192:207]
    ds_write_b32 v0, v12 offset:368
    s_waitcnt vmcnt(0)
    ds_read_b64_tr_b16 v[64:65], v9 offset:6144
    ds_read_b64_tr_b16 v[66:67], v9 offset:7168
    ds_read_b64_tr_b16 v[68:69], v10 offset:6144
    ds_read_b64_tr_b16 v[70:71], v10 offset:7168
    s_mul_i32 s53, s59, 24576
    s_xor_b32 s50, s59, 3
    s_lshl_b32 s50, s50, 12
    s_add_u32 s50, s50, s53
    v_add_u32 v16, s50, v2
    s_xor_b32 s50, s59, 2
    s_lshl_b32 s50, s50, 12
    s_add_u32 s50, s50, s53
    v_add_u32 v17, s50, v2
    s_xor_b32 s50, s59, 1
    s_lshl_b32 s50, s50, 12
    s_add_u32 s50, s50, s53
    v_add_u32 v18, s50, v2
    v_lshlrev_b32 v19, 2, v1
    v_add_u32 v19, 163328, v19
    v_mov_b32 v20, 1
    s_waitcnt lgkmcnt(11)
    v_mfma_f32_32x32x16_bf16 v[144:159], v[72:75], v[88:91], v[144:159]
    s_waitcnt lgkmcnt(7)
    v_mfma_f32_32x32x16_bf16 v[144:159], v[80:83], v[248:251], v[144:159]
    s_waitcnt lgkmcnt(2)
    v_mfma_f32_32x32x16_bf16 v[144:159], v[64:67], v[96:99], v[144:159]
    v_mfma_f32_32x32x16_bf16 v[160:175], v[72:75], v[92:95], v[160:175]
    v_mfma_f32_32x32x16_bf16 v[160:175], v[80:83], v[252:255], v[160:175]
    v_mfma_f32_32x32x16_bf16 v[160:175], v[64:67], v[100:103], v[160:175]
    v_mfma_f32_32x32x16_bf16 v[176:191], v[76:79], v[88:91], v[176:191]
    v_mfma_f32_32x32x16_bf16 v[176:191], v[84:87], v[248:251], v[176:191]
    s_waitcnt lgkmcnt(0)
    v_mfma_f32_32x32x16_bf16 v[176:191], v[68:71], v[96:99], v[176:191]
    s_nop 4
    ds_write_b128 v16, v[144:147] offset:0
    ds_write_b128 v16, v[148:151] offset:1024
    ds_write_b128 v16, v[152:155] offset:2048
    ds_write_b128 v16, v[156:159] offset:3072
    v_mfma_f32_32x32x16_bf16 v[192:207], v[76:79], v[92:95], v[192:207]
    v_mfma_f32_32x32x16_bf16 v[192:207], v[84:87], v[252:255], v[192:207]
    v_mfma_f32_32x32x16_bf16 v[192:207], v[68:71], v[100:103], v[192:207]
    ds_write_b128 v17, v[160:163] offset:0
    ds_write_b128 v17, v[164:167] offset:1024
    ds_write_b128 v17, v[168:171] offset:2048
    ds_write_b128 v17, v[172:175] offset:3072
    ds_write_b128 v18, v[176:179] offset:0
    ds_write_b128 v18, v[180:183] offset:1024
    ds_write_b128 v18, v[184:187] offset:2048
    ds_write_b128 v18, v[188:191] offset:3072
    s_mov_b64 exec, 15
    ds_add_u32 v19, v20 offset:400
    s_mov_b64 exec, -1
    s_lshl_b32 s52, s59, 12
    s_xor_b32 s50, s59, 1
    s_mul_i32 s50, s50, 24576
    s_add_u32 s50, s50, s52
    v_add_u32 v20, s50, v2
    s_xor_b32 s50, s59, 2
    s_mul_i32 s50, s50, 24576
    s_add_u32 s50, s50, s52
    v_add_u32 v21, s50, v2
    s_xor_b32 s50, s59, 3
    s_mul_i32 s50, s50, 24576
    s_add_u32 s50, s50, s52
    v_add_u32 v22, s50, v2
    s_add_u32 s53, s53, 16384
    v_add_u32 v23, s53, v2
    v_permlane32_swap_b32 v4, v6
    v_permlane32_swap_b32 v5, v7
    v_lshlrev_b32 v104, 16, v4
    v_and_b32 v105, 0xffff0000, v4
    v_lshlrev_b32 v106, 16, v5
    v_and_b32 v107, 0xffff0000, v5
    v_lshlrev_b32 v108, 16, v6
    v_and_b32 v109, 0xffff0000, v6
    v_lshlrev_b32 v110, 16, v7
    v_and_b32 v111, 0xffff0000, v7
    ds_read_b32 v26, v0 offset:400
    s_waitcnt lgkmcnt(0)
    v_readfirstlane_b32 s58, v26
    s_nop 0
    s_cmp_ge_u32 s58, 4
    s_cbranch_scc0 L_ck115
L_ck114:
    ds_read_b128 v[32:35], v20 offset:0
    ds_read_b128 v[36:39], v20 offset:1024
    ds_read_b128 v[40:43], v20 offset:2048
    ds_read_b128 v[44:47], v20 offset:3072
    ds_read_b128 v[48:51], v21 offset:0
    ds_read_b128 v[52:55], v21 offset:1024
    ds_read_b128 v[56:59], v21 offset:2048
    ds_read_b128 v[60:63], v21 offset:3072
    ds_read_b128 v[64:67], v22 offset:0
    ds_read_b128 v[68:71], v22 offset:1024
    ds_read_b128 v[72:75], v22 offset:2048
    ds_read_b128 v[76:79], v22 offset:3072
    s_waitcnt lgkmcnt(11)
    v_add_f32 v192, v192, v32
    v_add_f32 v193, v193, v33
    v_add_f32 v194, v194, v34
    v_add_f32 v195, v195, v35
    s_waitcnt lgkmcnt(10)
    v_add_f32 v196, v196, v36
    v_add_f32 v197, v197, v37
    v_add_f32 v198, v198, v38
    v_add_f32 v199, v199, v39
    s_waitcnt lgkmcnt(9)
    v_add_f32 v200, v200, v40
    v_add_f32 v201, v201, v41
    v_add_f32 v202, v202, v42
    v_add_f32 v203, v203, v43
    s_waitcnt lgkmcnt(8)
    v_add_f32 v204, v204, v44
    v_add_f32 v205, v205, v45
    v_add_f32 v206, v206, v46
    v_add_f32 v207, v207, v47
    s_waitcnt lgkmcnt(7)
    v_add_f32 v192, v192, v48
    v_add_f32 v193, v193, v49
    v_add_f32 v194, v194, v50
    v_add_f32 v195, v195, v51
    s_waitcnt lgkmcnt(6)
    v_add_f32 v196, v196, v52
    v_add_f32 v197, v197, v53
    v_add_f32 v198, v198, v54
    v_add_f32 v199, v199, v55
    s_waitcnt lgkmcnt(5)
    v_add_f32 v200, v200, v56
    v_add_f32 v201, v201, v57
    v_add_f32 v202, v202, v58
    v_add_f32 v203, v203, v59
    s_waitcnt lgkmcnt(4)
    v_add_f32 v204, v204, v60
    v_add_f32 v205, v205, v61
    v_add_f32 v206, v206, v62
    v_add_f32 v207, v207, v63
    s_waitcnt lgkmcnt(3)
    v_add_f32 v192, v192, v64
    v_add_f32 v193, v193, v65
    v_add_f32 v194, v194, v66
    v_add_f32 v195, v195, v67
    s_waitcnt lgkmcnt(2)
    v_add_f32 v196, v196, v68
    v_add_f32 v197, v197, v69
    v_add_f32 v198, v198, v70
    v_add_f32 v199, v199, v71
    s_waitcnt lgkmcnt(1)
    v_add_f32 v200, v200, v72
    v_add_f32 v201, v201, v73
    v_add_f32 v202, v202, v74
    v_add_f32 v203, v203, v75
    s_waitcnt lgkmcnt(0)
    v_add_f32 v204, v204, v76
    v_add_f32 v205, v205, v77
    v_add_f32 v206, v206, v78
    v_add_f32 v207, v207, v79
    v_mul_f32 v80, 0xbfb8aa3b, v192
    v_mul_f32 v81, 0xbfb8aa3b, v193
    v_mul_f32 v82, 0xbfb8aa3b, v194
    v_mul_f32 v83, 0xbfb8aa3b, v195
    v_mul_f32 v84, 0xbfb8aa3b, v196
    v_mul_f32 v85, 0xbfb8aa3b, v197
    v_mul_f32 v86, 0xbfb8aa3b, v198
    v_mul_f32 v87, 0xbfb8aa3b, v199
    v_mul_f32 v88, 0xbfb8aa3b, v200
    v_mul_f32 v89, 0xbfb8aa3b, v201
    v_mul_f32 v90, 0xbfb8aa3b, v202
    v_mul_f32 v91, 0xbfb8aa3b, v203
    v_mul_f32 v92, 0xbfb8aa3b, v204
    v_mul_f32 v93, 0xbfb8aa3b, v205
    v_mul_f32 v94, 0xbfb8aa3b, v206
    v_mul_f32 v95, 0xbfb8aa3b, v207
    v_exp_f32 v80, v80
    v_exp_f32 v81, v81
    v_exp_f32 v82, v82
    v_exp_f32 v83, v83
    v_exp_f32 v84, v84
    v_exp_f32 v85, v85
    v_exp_f32 v86, v86
    v_exp_f32 v87, v87
    v_exp_f32 v88, v88
    v_exp_f32 v89, v89
    v_exp_f32 v90, v90
    v_exp_f32 v91, v91
    v_exp_f32 v92, v92
    v_exp_f32 v93, v93
    v_exp_f32 v94, v94
    v_exp_f32 v95, v95
    v_add_f32 v80, 1.0, v80
    v_add_f32 v81, 1.0, v81
    v_add_f32 v82, 1.0, v82
    v_add_f32 v83, 1.0, v83
    v_add_f32 v84, 1.0, v84
    v_add_f32 v85, 1.0, v85
    v_add_f32 v86, 1.0, v86
    v_add_f32 v87, 1.0, v87
    v_add_f32 v88, 1.0, v88
    v_add_f32 v89, 1.0, v89
    v_add_f32 v90, 1.0, v90
    v_add_f32 v91, 1.0, v91
    v_add_f32 v92, 1.0, v92
    v_add_f32 v93, 1.0, v93
    v_add_f32 v94, 1.0, v94
    v_add_f32 v95, 1.0, v95
    v_rcp_f32 v80, v80
    v_rcp_f32 v81, v81
    v_rcp_f32 v82, v82
    v_rcp_f32 v83, v83
    v_rcp_f32 v84, v84
    v_rcp_f32 v85, v85
    v_rcp_f32 v86, v86
    v_rcp_f32 v87, v87
    v_rcp_f32 v88, v88
    v_rcp_f32 v89, v89
    v_rcp_f32 v90, v90
    v_rcp_f32 v91, v91
    v_rcp_f32 v92, v92
    v_rcp_f32 v93, v93
    v_rcp_f32 v94, v94
    v_rcp_f32 v95, v95
    v_mul_f32 v192, v192, v80
    v_mul_f32 v193, v193, v81
    v_mul_f32 v194, v194, v82
    v_mul_f32 v195, v195, v83
    v_mul_f32 v196, v196, v84
    v_mul_f32 v197, v197, v85
    v_mul_f32 v198, v198, v86
    v_mul_f32 v199, v199, v87
    v_mul_f32 v200, v200, v88
    v_mul_f32 v201, v201, v89
    v_mul_f32 v202, v202, v90
    v_mul_f32 v203, v203, v91
    v_mul_f32 v204, v204, v92
    v_mul_f32 v205, v205, v93
    v_mul_f32 v206, v206, v94
    v_mul_f32 v207, v207, v95
    ds_write_b128 v23, v[200:203] offset:6144
    ds_write_b128 v23, v[204:207] offset:7168
    s_waitcnt lgkmcnt(0)
    s_barrier
    ds_read_b128 v[32:35], v23 offset:0
    ds_read_b128 v[36:39], v23 offset:1024
    ds_read_b128 v[40:43], v23 offset:4096
    ds_read_b128 v[44:47], v23 offset:5120
    s_waitcnt lgkmcnt(1)
    v_add_f32 v32, v32, v40
    v_add_f32 v33, v33, v41
    v_add_f32 v34, v34, v42
    v_add_f32 v35, v35, v43
    s_waitcnt lgkmcnt(0)
    v_add_f32 v36, v36, v44
    v_add_f32 v37, v37, v45
    v_add_f32 v38, v38, v46
    v_add_f32 v39, v39, v47
    v_fmac_f32 v104, v32, v192
    v_fmac_f32 v105, v33, v193
    v_fmac_f32 v106, v34, v194
    v_fmac_f32 v107, v35, v195
    v_fmac_f32 v108, v36, v196
    v_fmac_f32 v109, v37, v197
    v_fmac_f32 v110, v38, v198
    v_fmac_f32 v111, v39, v199
    v_cvt_pk_bf16_f32 v4, v104, v105
    v_cvt_pk_bf16_f32 v5, v106, v107
    v_cvt_pk_bf16_f32 v6, v108, v109
    v_cvt_pk_bf16_f32 v7, v110, v111
    s_nop 0
    v_permlane32_swap_b32 v4, v6
    v_permlane32_swap_b32 v5, v7
    buffer_store_dwordx4 v[4:7], v3, s[28:31], s60 offen offset:0
    s_branch L_fin
L_lattn:
    s_cmp_ge_u32 s5, 12
    s_cbranch_scc1 L_lspare
    s_mul_i32 s61, s59, s44
    s_lshl_b32 s61, s61, 3
    s_lshl_b32 s53, s59, 10
    s_lshl_b32 s65, s44, 6
    s_lshl_b32 s67, s44, 5
    s_mul_i32 s66, s44, 448
    s_mul_i32 s64, s65, s1
    s_getpc_b64 s[72:73]
L_pc116:
    s_sub_u32 s72, s72, L_pc116 - recurrent_scan__linear_kernel_hedgehog__dense_activation_silu__prompt_kernel
    s_subb_u32 s73, s73, 0
    s_lshl_b32 s50, s5, 2
    s_add_u32 s50, s50, s59
    s_lshl_b32 s50, s50, 2
    v_add_u32 v8, s50, v1
    v_lshlrev_b32 v8, 7, v8
    v_min_u32 v8, L_end - recurrent_scan__linear_kernel_hedgehog__dense_activation_silu__prompt_kernel, v8
    v_mov_b32 v9, s73
    v_add_co_u32 v8, vcc, s72, v8
    s_nop 1
    v_addc_co_u32 v9, vcc, 0, v9, vcc
    s_mov_b64 exec, 15
    global_load_dword v200, v[8:9], off
    s_mov_b64 exec, -1
    s_barrier
    s_add_u32 m0, s53, 114688
    s_add_u32 s50, s64, s61
    s_add_u32 s50, s50, s45
    buffer_load_dwordx4 v3, s[12:15], s50 offen lds
    s_add_u32 m0, s53, 118784
    s_add_u32 s50, s50, s67
    s_add_u32 s64, s64, s65
    s_cmp_eq_u32 s64, s66
    s_cselect_b32 s64, 0, s64
    buffer_load_dwordx4 v3, s[12:15], s50 offen lds
    s_add_u32 m0, s53, 122880
    s_add_u32 s50, s64, s61
    s_add_u32 s50, s50, s45
    buffer_load_dwordx4 v3, s[12:15], s50 offen lds
    s_add_u32 m0, s53, 126976
    s_add_u32 s50, s50, s67
    s_add_u32 s64, s64, s65
    s_cmp_eq_u32 s64, s66
    s_cselect_b32 s64, 0, s64
    buffer_load_dwordx4 v3, s[12:15], s50 offen lds
    s_add_u32 m0, s53, 131072
    s_add_u32 s50, s64, s61
    s_add_u32 s50, s50, s45
    buffer_load_dwordx4 v3, s[12:15], s50 offen lds
    s_add_u32 m0, s53, 135168
    s_add_u32 s50, s50, s67
    s_add_u32 s64, s64, s65
    s_cmp_eq_u32 s64, s66
    s_cselect_b32 s64, 0, s64
    buffer_load_dwordx4 v3, s[12:15], s50 offen lds
    s_add_u32 m0, s53, 139264
    s_add_u32 s50, s64, s61
    s_add_u32 s50, s50, s45
    buffer_load_dwordx4 v3, s[12:15], s50 offen lds
    s_add_u32 m0, s53, 159744
    s_mul_i32 s50, s42, 3136
    s_add_u32 s50, s50, s53
    s_cmp_eq_u32 s59, 3
    s_cselect_b32 exec_hi, 0, -1
    buffer_load_dwordx4 v2, s[36:39], s50 offen lds
    s_mov_b64 exec, -1
    s_add_u32 m0, s53, 143360
    s_add_u32 s50, s64, s61
    s_add_u32 s50, s50, s45
    s_add_u32 s50, s50, s67
    s_add_u32 s64, s64, s65
    s_cmp_eq_u32 s64, s66
    s_cselect_b32 s64, 0, s64
    buffer_load_dwordx4 v3, s[12:15], s50 offen lds
    s_add_u32 m0, s53, 147456
    s_add_u32 s50, s64, s61
    s_add_u32 s50, s50, s45
    buffer_load_dwordx4 v3, s[12:15], s50 offen lds
    s_add_u32 m0, s53, 151552
    s_add_u32 s50, s50, s67
    s_add_u32 s64, s64, s65
    s_cmp_eq_u32 s64, s66
    s_cselect_b32 s64, 0, s64
    buffer_load_dwordx4 v3, s[12:15], s50 offen lds
    s_add_u32 m0, s53, 155648
    s_add_u32 s50, s64, s61
    s_add_u32 s50, s50, s45
    buffer_load_dwordx4 v3, s[12:15], s50 offen lds
    s_or_b32 s50, s2, s59
    s_cmp_lg_u32 s50, 0
    s_cbranch_scc1 L_nt117
    s_mov_b32 s50, 14843904
    v_mov_b32 v9, 0
    s_mov_b64 exec, 1
    buffer_load_dword v8, v9, s[16:19], s50 offen sc1
    s_waitcnt vmcnt(0)
    v_or_b32 v8, 0x40004000, v8
    v_add_u32 v8, 1, v8
    v_and_b32 v8, 0xbfffbfff, v8
    v_max_u32 v8, 1, v8
    s_nop 1
    buffer_store_dword v8, v9, s[16:19], s50 offen sc1
    buffer_store_dword v8, v9, s[32:35], 0 offen sc1
    s_waitcnt vmcnt(0)
    s_mov_b64 exec, -1
L_nt117:
    v_lshlrev_b32 v11, 2, v1
    v_add_u32 v11, 163328, v11
    v_mov_b32 v12, 1
    v_mov_b32 v192, 163328
    v_and_b32 v8, 31, v1
    s_lshl_b32 s50, s59, 5
    v_add_u32 v8, s50, v8
    v_lshrrev_b32 v9, 5, v1
    v_lshlrev_b32 v9, 3, v9
    v_mul_u32_u24 v185, 112, v8
    v_add_u32 v185, v185, v9
    v_cndmask_b32 v184, 1.0, 0, s[54:55]
    v_mov_b32 v186, s62
    v_lshrrev_b32 v8, 5, v1
    v_lshlrev_b32 v8, 2, v8
    v_bfe_u32 v193, v1, 2, 2
    v_add_u32 v8, v8, v193
    v_mul_u32_u24 v193, 56, v8
    v_bfe_u32 v8, v1, 4, 1
    v_lshl_add_u32 v193, v8, 5, v193
    v_and_b32 v8, 3, v1
    v_lshl_add_u32 v193, v8, 3, v193
    v_add_u32 v193, 159744, v193
    s_lshl_b32 s50, s59, 12
    s_add_u32 s50, s50, 143360
    v_add_u32 v187, s50, v2
    s_mov_b32 s51, 896
    v_lshrrev_b32 v8, 3, v1
    v_mul_lo_u32 v5, v8, s51
    v_bfe_u32 v8, v1, 4, 1
    v_lshlrev_b32 v8, 2, v8
    v_and_b32 v9, 7, v1
    v_xor_b32 v8, v8, v9
    v_lshl_add_u32 v5, v8, 4, v5
    v_bfe_u32 v8, v1, 2, 2
    v_lshrrev_b32 v9, 5, v1
    v_lshlrev_b32 v9, 9, v9
    v_lshl_add_u32 v9, v8, 7, v9
    v_bfe_u32 v8, v1, 3, 1
    v_lshlrev_b32 v8, 6, v8
    v_bfe_u32 v10, v1, 4, 1
    v_lshlrev_b32 v10, 5, v10
    v_and_b32 v6, 3, v1
    v_lshl_add_u32 v10, v6, 3, v10
    v_xor_b32 v6, v10, v8
    v_add_u32 v6, v6, v9
    v_add_u32 v10, 64, v10
    v_xor_b32 v7, v10, v8
    v_add_u32 v7, v7, v9
    s_xor_b32 s51, s59, 3
    s_lshr_b32 s51, s51, 1
    s_lshl_b32 s51, s51, 6
    v_xor_b32 v6, s51, v6
    v_xor_b32 v7, 64, v6
    s_mul_i32 s68, s59, 401408
    s_lshl_b32 s52, s41, 7
    s_add_u32 s68, s68, s52
    s_mul_i32 s69, s57, 14336
    v_add_u32 v13, 7168, v5
    s_waitcnt lgkmcnt(0)
    s_mov_b32 s70, 0
L_lw118:
    ds_read_b128 v[188:191], v192 offset:0
    s_add_u32 s70, s70, 1
    s_cmp_gt_u32 s70, 0x1000000
    s_cbranch_scc1 L_lw119
    s_sleep 1
    s_waitcnt lgkmcnt(0)
    v_min3_u32 v188, v188, v189, v190
    v_min_u32 v188, v188, v191
    s_nop 0
    v_readfirstlane_b32 s58, v188
    s_nop 0
    s_cmp_eq_u32 s58, 0
    s_cbranch_scc1 L_lw118
L_lw119:
    s_waitcnt lgkmcnt(0)
    s_add_u32 s50, s64, s61
    s_add_u32 s50, s50, s45
    s_add_u32 m0, s53, 0
    s_add_u32 s50, s50, s67
    s_add_u32 s64, s64, s65
    s_cmp_eq_u32 s64, s66
    s_cselect_b32 s64, 0, s64
    buffer_load_dwordx4 v3, s[12:15], s50 offen lds
    s_add_u32 m0, s53, 4096
    s_add_u32 s50, s64, s61
    s_add_u32 s50, s50, s45
    buffer_load_dwordx4 v3, s[12:15], s50 offen lds
    s_add_u32 m0, s53, 8192
    s_add_u32 s50, s50, s67
    s_add_u32 s64, s64, s65
    s_cmp_eq_u32 s64, s66
    s_cselect_b32 s64, 0, s64
    buffer_load_dwordx4 v3, s[12:15], s50 offen lds
    s_waitcnt vmcnt(7)
    s_mov_b64 exec, 15
    ds_add_u32 v11, v12 offset:128
    s_mov_b64 exec, -1
    s_add_u32 m0, s53, 28672
    s_add_u32 s50, s64, s61
    s_add_u32 s50, s50, s46
    buffer_load_dwordx4 v3, s[12:15], s50 offen lds
    s_add_u32 m0, s53, 32768
    s_add_u32 s50, s50, s67
    s_add_u32 s64, s64, s65
    s_cmp_eq_u32 s64, s66
    s_cselect_b32 s64, 0, s64
    buffer_load_dwordx4 v3, s[12:15], s50 offen lds
    s_add_u32 m0, s53, 36864
    s_add_u32 s50, s64, s61
    s_add_u32 s50, s50, s46
    buffer_load_dwordx4 v3, s[12:15], s50 offen lds
    s_waitcnt vmcnt(6)
    s_mov_b64 exec, 15
    ds_add_u32 v11, v12 offset:144
    s_mov_b64 exec, -1
    s_add_u32 m0, s53, 40960
    s_add_u32 s50, s50, s67
    s_add_u32 s64, s64, s65
    s_cmp_eq_u32 s64, s66
    s_cselect_b32 s64, 0, s64
    buffer_load_dwordx4 v3, s[12:15], s50 offen lds
    s_add_u32 m0, s53, 45056
    s_add_u32 s50, s64, s61
    s_add_u32 s50, s50, s46
    buffer_load_dwordx4 v3, s[12:15], s50 offen lds
    s_waitcnt vmcnt(5)
    s_mov_b64 exec, 15
    ds_add_u32 v11, v12 offset:352
    s_mov_b64 exec, -1
    s_add_u32 m0, s53, 49152
    s_add_u32 s50, s50, s67
    s_add_u32 s64, s64, s65
    s_cmp_eq_u32 s64, s66
    s_cselect_b32 s64, 0, s64
    buffer_load_dwordx4 v3, s[12:15], s50 offen lds
    s_add_u32 m0, s53, 53248
    s_add_u32 s50, s64, s61
    s_add_u32 s50, s50, s46
    buffer_load_dwordx4 v3, s[12:15], s50 offen lds
    s_add_u32 m0, s53, 57344
    s_add_u32 s50, s64, s61
    s_add_u32 s50, s50, s46
    s_add_u32 s50, s50, s67
    s_add_u32 s64, s64, s65
    s_cmp_eq_u32 s64, s66
    s_cselect_b32 s64, 0, s64
    buffer_load_dwordx4 v3, s[12:15], s50 offen lds
    s_add_u32 m0, s53, 61440
    s_add_u32 s50, s64, s61
    s_add_u32 s50, s50, s46
    buffer_load_dwordx4 v3, s[12:15], s50 offen lds
    s_add_u32 m0, s53, 65536
    s_add_u32 s50, s50, s67
    s_add_u32 s64, s64, s65
    s_cmp_eq_u32 s64, s66
    s_cselect_b32 s64, 0, s64
    buffer_load_dwordx4 v3, s[12:15], s50 offen lds
    s_waitcnt vmcnt(3)
    s_mov_b64 exec, 15
    ds_add_u32 v11, v12 offset:160
    s_mov_b64 exec, -1
    s_add_u32 m0, s53, 69632
    s_add_u32 s50, s64, s61
    s_add_u32 s50, s50, s46
    buffer_load_dwordx4 v3, s[12:15], s50 offen lds
    s_add_u32 m0, s53, 73728
    s_add_u32 s50, s50, s67
    s_add_u32 s64, s64, s65
    s_cmp_eq_u32 s64, s66
    s_cselect_b32 s64, 0, s64
    buffer_load_dwordx4 v3, s[12:15], s50 offen lds
    s_add_u32 m0, s53, 77824
    s_add_u32 s50, s64, s61
    s_add_u32 s50, s50, s46
    buffer_load_dwordx4 v3, s[12:15], s50 offen lds
    s_add_u32 m0, s53, 81920
    s_add_u32 s50, s50, s67
    s_add_u32 s64, s64, s65
    s_cmp_eq_u32 s64, s66
    s_cselect_b32 s64, 0, s64
    buffer_load_dwordx4 v3, s[12:15], s50 offen lds
    v_mov_b32 v197, 0
    buffer_load_dword v198, v197, s[32:35], 0 offen sc1
    s_add_u32 m0, s53, 86016
    s_add_u32 s50, s64, s61
    s_add_u32 s50, s50, s47
    buffer_load_dwordx4 v3, s[12:15], s50 offen lds
    s_add_u32 m0, s53, 90112
    s_add_u32 s50, s50, s67
    s_add_u32 s64, s64, s65
    s_cmp_eq_u32 s64, s66
    s_cselect_b32 s64, 0, s64
    buffer_load_dwordx4 v3, s[12:15], s50 offen lds
    s_add_u32 m0, s53, 94208
    s_add_u32 s50, s64, s61
    s_add_u32 s50, s50, s47
    buffer_load_dwordx4 v3, s[12:15], s50 offen lds
    s_waitcnt vmcnt(4)
    s_mov_b64 exec, 15
    ds_add_u32 v11, v12 offset:176
    s_mov_b64 exec, -1
    s_add_u32 m0, s53, 98304
    s_add_u32 s50, s50, s67
    s_add_u32 s64, s64, s65
    s_cmp_eq_u32 s64, s66
    s_cselect_b32 s64, 0, s64
    buffer_load_dwordx4 v3, s[12:15], s50 offen lds
    s_add_u32 m0, s53, 102400
    s_add_u32 s50, s64, s61
    s_add_u32 s50, s50, s47
    buffer_load_dwordx4 v3, s[12:15], s50 offen lds
    s_add_u32 m0, s53, 106496
    s_add_u32 s50, s50, s67
    s_add_u32 s64, s64, s65
    s_cmp_eq_u32 s64, s66
    s_cselect_b32 s64, 0, s64
    buffer_load_dwordx4 v3, s[12:15], s50 offen lds
    s_add_u32 m0, s53, 110592
    s_add_u32 s50, s64, s61
    s_add_u32 s50, s50, s47
    buffer_load_dwordx4 v3, s[12:15], s50 offen lds
    s_waitcnt lgkmcnt(0)
    s_mov_b32 s70, 0
L_lw120:
    ds_read_b128 v[188:191], v192 offset:16
    s_add_u32 s70, s70, 1
    s_cmp_gt_u32 s70, 0x1000000
    s_cbranch_scc1 L_lw121
    s_sleep 1
    s_waitcnt lgkmcnt(0)
    v_min3_u32 v188, v188, v189, v190
    v_min_u32 v188, v188, v191
    s_nop 0
    v_readfirstlane_b32 s58, v188
    s_nop 0
    s_cmp_eq_u32 s58, 0
    s_cbranch_scc1 L_lw120
L_lw121:
    s_waitcnt lgkmcnt(0)
    s_add_u32 m0, s53, 114688
    s_add_u32 s50, s64, s61
    s_add_u32 s50, s50, s47
    s_add_u32 s50, s50, s67
    s_add_u32 s64, s64, s65
    s_cmp_eq_u32 s64, s66
    s_cselect_b32 s64, 0, s64
    buffer_load_dwordx4 v3, s[12:15], s50 offen lds
    s_add_u32 m0, s53, 118784
    s_add_u32 s50, s64, s61
    s_add_u32 s50, s50, s47
    buffer_load_dwordx4 v3, s[12:15], s50 offen lds
    s_add_u32 m0, s53, 122880
    s_add_u32 s50, s50, s67
    s_add_u32 s64, s64, s65
    s_cmp_eq_u32 s64, s66
    s_cselect_b32 s64, 0, s64
    buffer_load_dwordx4 v3, s[12:15], s50 offen lds
    s_add_u32 m0, s53, 126976
    s_add_u32 s50, s64, s61
    s_add_u32 s50, s50, s47
    buffer_load_dwordx4 v3, s[12:15], s50 offen lds
    s_add_u32 m0, s53, 131072
    s_add_u32 s50, s50, s67
    s_add_u32 s64, s64, s65
    s_cmp_eq_u32 s64, s66
    s_cselect_b32 s64, 0, s64
    buffer_load_dwordx4 v3, s[12:15], s50 offen lds
    s_add_u32 m0, s53, 135168
    s_add_u32 s50, s64, s61
    s_add_u32 s50, s50, s47
    buffer_load_dwordx4 v3, s[12:15], s50 offen lds
    s_add_u32 m0, s53, 139264
    s_add_u32 s50, s50, s67
    s_add_u32 s64, s64, s65
    s_cmp_eq_u32 s64, s66
    s_cselect_b32 s64, 0, s64
    buffer_load_dwordx4 v3, s[12:15], s50 offen lds
    v_lshrrev_b32 v8, 5, v1
    v_lshlrev_b32 v8, 3, v8
    v_bfe_u32 v194, v1, 2, 2
    v_add_u32 v8, v8, v194
    v_mul_u32_u24 v194, 112, v8
    v_bfe_u32 v8, v1, 4, 1
    v_lshl_add_u32 v194, v8, 5, v194
    v_and_b32 v8, 3, v1
    v_lshl_add_u32 v194, v8, 3, v194
    v_lshrrev_b32 v8, 5, v1
    v_lshlrev_b32 v8, 3, v8
    v_bfe_u32 v195, v1, 2, 2
    v_add_u32 v8, v8, v195
    v_mul_u32_u24 v195, 72, v8
    v_bfe_u32 v8, v1, 4, 1
    v_lshl_add_u32 v195, v8, 5, v195
    v_and_b32 v8, 3, v1
    v_lshl_add_u32 v195, v8, 3, v195
    s_lshr_b32 s50, s59, 1
    s_and_b32 s51, s59, 1
    s_mul_i32 s52, s50, 14336
    s_mul_i32 s51, s51, 56
    s_add_u32 s52, s52, s51
    v_add_u32 v194, s52, v194
    s_mul_i32 s52, s50, 9216
    s_add_u32 s52, s52, 28672
    v_add_u32 v195, s52, v195
    s_lshl_b32 s74, s42, 2
    s_add_u32 s74, s74, s59
    s_lshl_b32 s75, s74, 11
    s_lshl_b32 s74, s74, 4
    s_add_u32 s74, s74, s6
    s_lshl_b32 s74, s74, 11
    s_add_u32 s74, s74, 11534336
    s_lshl_b32 s50, s6, 7
    s_add_u32 s75, s75, s50
    s_add_u32 s75, s75, 14745600
    s_waitcnt lgkmcnt(0)
    s_mov_b32 s70, 0
L_lw122:
    ds_read_b128 v[188:191], v192 offset:80
    s_add_u32 s70, s70, 1
    s_cmp_gt_u32 s70, 0x1000000
    s_cbranch_scc1 L_lw123
    s_sleep 1
    s_waitcnt lgkmcnt(0)
    v_min3_u32 v188, v188, v189, v190
    v_min_u32 v188, v188, v191
    s_nop 0
    v_readfirstlane_b32 s58, v188
    s_nop 0
    s_cmp_eq_u32 s58, 0
    s_cbranch_scc1 L_lw122
L_lw123:
    s_waitcnt lgkmcnt(0)
    s_setprio 1
    ds_read_b128 v[160:163], v187
    ds_read_b128 v[164:167], v187 offset:1024
    ds_read_b64_tr_b16 v[168:169], v193 offset:0
    ds_read_b64_tr_b16 v[170:171], v193 offset:448
    ds_read_b64_tr_b16 v[172:173], v193 offset:896
    ds_read_b64_tr_b16 v[174:175], v193 offset:1344
    s_waitcnt lgkmcnt(2)
    v_mfma_f32_32x32x16_bf16 v[144:159], v[168:171], v[160:163], 0
    s_waitcnt lgkmcnt(0)
    v_mfma_f32_32x32x16_bf16 v[144:159], v[172:175], v[164:167], v[144:159]
    s_waitcnt vmcnt(7)
    s_mov_b64 exec, 15
    ds_add_u32 v11, v12 offset:192
    s_mov_b64 exec, -1
    s_nop 7
    v_cndmask_b32 v156, v156, v152, s[54:55]
    v_cndmask_b32 v157, v157, v153, s[54:55]
    v_cndmask_b32 v158, v158, v154, s[54:55]
    v_cndmask_b32 v159, v159, v155, s[54:55]
    v_max3_f32 v176, v144, v145, v146
    v_max3_f32 v176, v176, v147, v148
    v_max3_f32 v176, v176, v149, v150
    v_max3_f32 v176, v176, v151, v152
    v_max3_f32 v176, v176, v153, v154
    v_max3_f32 v176, v176, v155, v156
    v_max3_f32 v176, v176, v157, v158
    v_min3_f32 v178, v144, v145, v146
    v_min3_f32 v178, v178, v147, v148
    v_min3_f32 v178, v178, v149, v150
    v_min3_f32 v178, v178, v151, v152
    v_min3_f32 v178, v178, v153, v154
    v_min3_f32 v178, v178, v155, v156
    v_min3_f32 v178, v178, v157, v158
    v_max_f32 v176, v176, v159
    v_min_f32 v178, v178, v159
    v_mov_b32 v177, v176
    v_mov_b32 v179, v178
    s_nop 0
    v_permlane32_swap_b32 v176, v177
    v_permlane32_swap_b32 v178, v179
    v_max_f32 v176, v176, v177
    v_min_f32 v178, v178, v179
    v_mul_f32 v176, 0xbfb8aa3b, v176
    v_mul_f32 v178, 0x3fb8aa3b, v178
    v_fma_f32 v160, v144, v186, v176
    v_fma_f32 v161, v145, v186, v176
    v_fma_f32 v162, v146, v186, v176
    v_fma_f32 v163, v147, v186, v176
    v_fma_f32 v164, v148, v186, v176
    v_fma_f32 v165, v149, v186, v176
    v_fma_f32 v166, v150, v186, v176
    v_fma_f32 v167, v151, v186, v176
    s_waitcnt vmcnt(0)
    s_mov_b64 exec, 15
    ds_add_u32 v11, v12 offset:208
    s_mov_b64 exec, -1
    v_fma_f32 v168, v152, v186, v176
    v_fma_f32 v169, v153, v186, v176
    v_fma_f32 v170, v154, v186, v176
    v_fma_f32 v171, v155, v186, v176
    v_fma_f32 v172, v156, v186, v176
    v_fma_f32 v173, v157, v186, v176
    v_fma_f32 v174, v158, v186, v176
    v_fma_f32 v175, v159, v186, v176
    v_exp_f32 v160, v160
    v_exp_f32 v161, v161
    v_exp_f32 v162, v162
    v_exp_f32 v163, v163
    v_exp_f32 v164, v164
    v_exp_f32 v165, v165
    v_exp_f32 v166, v166
    v_exp_f32 v167, v167
    v_exp_f32 v168, v168
    v_exp_f32 v169, v169
    v_exp_f32 v170, v170
    v_exp_f32 v171, v171
    v_exp_f32 v172, v172
    v_exp_f32 v173, v173
    v_exp_f32 v174, v174
    v_exp_f32 v175, v175
    v_add_f32 v181, v172, v173
    v_add_f32 v180, v160, v161
    v_add_f32 v181, v181, v174
    v_add_f32 v180, v180, v162
    v_add_f32 v181, v181, v175
    v_add_f32 v180, v180, v163
    v_cndmask_b32 v181, v181, 0, s[54:55]
    v_add_f32 v180, v180, v164
    v_add_f32 v181, v181, v165
    v_add_f32 v180, v180, v166
    v_add_f32 v181, v181, v167
    v_add_f32 v180, v180, v168
    v_add_f32 v181, v181, v169
    v_add_f32 v180, v180, v170
    v_add_f32 v181, v181, v171
    v_add_f32 v180, v180, v181
    v_mov_b32 v181, v180
    s_nop 1
    v_permlane32_swap_b32 v180, v181
    v_add_f32 v180, v180, v181
    v_rcp_f32 v180, v180
    s_nop 0
    v_mul_f32 v160, v160, v180
    v_mul_f32 v161, v161, v180
    v_mul_f32 v162, v162, v180
    v_mul_f32 v163, v163, v180
    v_mul_f32 v164, v164, v180
    v_mul_f32 v165, v165, v180
    v_mul_f32 v166, v166, v180
    v_mul_f32 v167, v167, v180
    v_mul_f32 v168, v168, v180
    v_mul_f32 v169, v169, v180
    v_mul_f32 v170, v170, v180
    v_mul_f32 v171, v171, v180
    v_mul_f32 v172, v172, v180
    v_mul_f32 v173, v173, v180
    v_mul_f32 v174, v174, v180
    v_mul_f32 v175, v175, v180
    v_cvt_pk_bf16_f32 v160, v160, v161
    v_cvt_pk_bf16_f32 v161, v162, v163
    v_cvt_pk_bf16_f32 v162, v164, v165
    v_cvt_pk_bf16_f32 v163, v166, v167
    v_cvt_pk_bf16_f32 v164, v168, v169
    v_cvt_pk_bf16_f32 v165, v170, v171
    v_cvt_pk_bf16_f32 v166, v172, v173
    v_cvt_pk_bf16_f32 v167, v174, v175
    ds_write_b64 v185, v[160:161] offset:0
    ds_write_b64 v185, v[162:163] offset:16
    ds_write_b64 v185, v[164:165] offset:32
    s_mov_b64 exec, 0xffffffff
    ds_write_b64 v185, v[166:167] offset:48
    s_mov_b64 exec, -1
    v_fma_f32 v144, -v144, v186, v178
    v_fma_f32 v145, -v145, v186, v178
    v_fma_f32 v146, -v146, v186, v178
    v_fma_f32 v147, -v147, v186, v178
    v_fma_f32 v148, -v148, v186, v178
    v_fma_f32 v149, -v149, v186, v178
    v_fma_f32 v150, -v150, v186, v178
    v_fma_f32 v151, -v151, v186, v178
    v_fma_f32 v152, -v152, v186, v178
    v_fma_f32 v153, -v153, v186, v178
    v_fma_f32 v154, -v154, v186, v178
    v_fma_f32 v155, -v155, v186, v178
    v_fma_f32 v156, -v156, v186, v178
    v_fma_f32 v157, -v157, v186, v178
    v_fma_f32 v158, -v158, v186, v178
    v_fma_f32 v159, -v159, v186, v178
    v_exp_f32 v144, v144
    v_exp_f32 v145, v145
    v_exp_f32 v146, v146
    v_exp_f32 v147, v147
    v_exp_f32 v148, v148
    v_exp_f32 v149, v149
    v_exp_f32 v150, v150
    v_exp_f32 v151, v151
    v_exp_f32 v152, v152
    v_exp_f32 v153, v153
    v_exp_f32 v154, v154
    v_exp_f32 v155, v155
    v_exp_f32 v156, v156
    v_exp_f32 v157, v157
    v_exp_f32 v158, v158
    v_exp_f32 v159, v159
    v_add_f32 v181, v156, v157
    v_add_f32 v180, v144, v145
    v_add_f32 v181, v181, v158
    v_add_f32 v180, v180, v146
    v_add_f32 v181, v181, v159
    v_add_f32 v180, v180, v147
    v_cndmask_b32 v181, v181, 0, s[54:55]
    v_add_f32 v180, v180, v148
    v_add_f32 v181, v181, v149
    v_add_f32 v180, v180, v150
    v_add_f32 v181, v181, v151
    v_add_f32 v180, v180, v152
    v_add_f32 v181, v181, v153
    v_add_f32 v180, v180, v154
    v_add_f32 v181, v181, v155
    v_add_f32 v180, v180, v181
    v_mov_b32 v181, v180
    s_nop 1
    v_permlane32_swap_b32 v180, v181
    v_add_f32 v180, v180, v181
    v_rcp_f32 v180, v180
    s_nop 0
    v_mul_f32 v144, v144, v180
    v_mul_f32 v145, v145, v180
    v_mul_f32 v146, v146, v180
    v_mul_f32 v147, v147, v180
    v_mul_f32 v148, v148, v180
    v_mul_f32 v149, v149, v180
    v_mul_f32 v150, v150, v180
    v_mul_f32 v151, v151, v180
    v_mul_f32 v152, v152, v180
    v_mul_f32 v153, v153, v180
    v_mul_f32 v154, v154, v180
    v_mul_f32 v155, v155, v180
    v_mul_f32 v156, v156, v180
    v_mul_f32 v157, v157, v180
    v_mul_f32 v158, v158, v180
    v_mul_f32 v159, v159, v180
    v_cvt_pk_bf16_f32 v144, v144, v145
    v_cvt_pk_bf16_f32 v145, v146, v147
    v_cvt_pk_bf16_f32 v146, v148, v149
    v_cvt_pk_bf16_f32 v147, v150, v151
    v_cvt_pk_bf16_f32 v148, v152, v153
    v_cvt_pk_bf16_f32 v149, v154, v155
    v_cvt_pk_bf16_f32 v150, v156, v157
    v_cvt_pk_bf16_f32 v151, v158, v159
    ds_write_b64 v185, v[144:145] offset:56
    ds_write_b64 v185, v[146:147] offset:72
    ds_write_b64 v185, v[148:149] offset:88
    s_mov_b64 exec, 0xffffffff
    ds_write_b64 v185, v[150:151] offset:104
    s_mov_b64 exec, -1
    s_mov_b64 exec, 15
    ds_add_u32 v11, v12 offset:272
    s_mov_b64 exec, -1
    v_readfirstlane_b32 s43, v198
    s_nop 0
    s_cmp_lg_u32 s43, 0
    s_cbranch_scc1 L_tf125
    s_mov_b32 s70, 0
L_tf124:
    buffer_load_dword v198, v197, s[32:35], 0 offen sc1
    s_waitcnt vmcnt(0)
    v_readfirstlane_b32 s43, v198
    s_add_u32 s70, s70, 1
    s_max_u32 s58, s70, 0x400000
    s_sub_u32 s58, s58, 0x400000
    s_or_b32 s43, s43, s58
    s_cmp_eq_u32 s43, 0
    s_cbranch_scc1 L_tf124
L_tf125:
    v_mov_b32 v198, s43
    ds_write_b32 v0, v198 offset:320
    s_add_u32 s51, s68, s69
    buffer_load_dwordx4 v[16:19], v5, s[20:23], s51 offen
    buffer_load_dwordx4 v[20:23], v13, s[20:23], s51 offen
    s_add_u32 s69, s69, 14336
    s_cmp_eq_u32 s69, 401408
    s_cselect_b32 s69, 0, s69
    s_add_u32 s51, s68, s69
    buffer_load_dwordx4 v[24:27], v5, s[20:23], s51 offen
    buffer_load_dwordx4 v[28:31], v13, s[20:23], s51 offen
    s_add_u32 s69, s69, 14336
    s_cmp_eq_u32 s69, 401408
    s_cselect_b32 s69, 0, s69
    s_add_u32 s51, s68, s69
    buffer_load_dwordx4 v[32:35], v5, s[20:23], s51 offen
    buffer_load_dwordx4 v[36:39], v13, s[20:23], s51 offen
    s_add_u32 s69, s69, 14336
    s_cmp_eq_u32 s69, 401408
    s_cselect_b32 s69, 0, s69
    s_add_u32 s51, s68, s69
    buffer_load_dwordx4 v[40:43], v5, s[20:23], s51 offen
    buffer_load_dwordx4 v[44:47], v13, s[20:23], s51 offen
    s_add_u32 s69, s69, 14336
    s_cmp_eq_u32 s69, 401408
    s_cselect_b32 s69, 0, s69
    s_add_u32 s51, s68, s69
    buffer_load_dwordx4 v[48:51], v5, s[20:23], s51 offen
    buffer_load_dwordx4 v[52:55], v13, s[20:23], s51 offen
    s_add_u32 s69, s69, 14336
    s_cmp_eq_u32 s69, 401408
    s_cselect_b32 s69, 0, s69
    s_add_u32 s51, s68, s69
    buffer_load_dwordx4 v[56:59], v5, s[20:23], s51 offen
    buffer_load_dwordx4 v[60:63], v13, s[20:23], s51 offen
    s_add_u32 s69, s69, 14336
    s_cmp_eq_u32 s69, 401408
    s_cselect_b32 s69, 0, s69
    s_add_u32 s51, s68, s69
    buffer_load_dwordx4 v[64:67], v5, s[20:23], s51 offen
    buffer_load_dwordx4 v[68:71], v13, s[20:23], s51 offen
    s_add_u32 s69, s69, 14336
    s_cmp_eq_u32 s69, 401408
    s_cselect_b32 s69, 0, s69
    s_add_u32 s51, s68, s69
    buffer_load_dwordx4 v[72:75], v5, s[20:23], s51 offen
    buffer_load_dwordx4 v[76:79], v13, s[20:23], s51 offen
    s_add_u32 s69, s69, 14336
    s_cmp_eq_u32 s69, 401408
    s_cselect_b32 s69, 0, s69
    s_setprio 1
    s_waitcnt lgkmcnt(0)
    s_mov_b32 s70, 0
L_lw126:
    ds_read_b128 v[188:191], v192 offset:112
    s_add_u32 s70, s70, 1
    s_cmp_gt_u32 s70, 0x1000000
    s_cbranch_scc1 L_lw127
    s_sleep 1
    s_waitcnt lgkmcnt(0)
    v_min3_u32 v188, v188, v189, v190
    v_min_u32 v188, v188, v191
    s_nop 0
    v_readfirstlane_b32 s58, v188
    s_nop 0
    s_cmp_eq_u32 s58, 0
    s_cbranch_scc1 L_lw126
L_lw127:
    s_waitcnt lgkmcnt(0)
    ds_read_b32 v188, v0 offset:272
    s_waitcnt lgkmcnt(0)
    v_readfirstlane_b32 s58, v188
    s_nop 0
    s_cmp_ge_u32 s58, 4
    s_cbranch_scc0 L_ck130
L_ck129:
    ds_read_b64_tr_b16 v[208:209], v194 offset:0
    ds_read_b64_tr_b16 v[210:211], v194 offset:448
    ds_read_b64_tr_b16 v[212:213], v195 offset:0
    ds_read_b64_tr_b16 v[214:215], v195 offset:288
    ds_read_b64_tr_b16 v[216:217], v194 offset:1792
    ds_read_b64_tr_b16 v[218:219], v194 offset:2240
    ds_read_b64_tr_b16 v[220:221], v195 offset:1152
    ds_read_b64_tr_b16 v[222:223], v195 offset:1440
    ds_read_b64_tr_b16 v[224:225], v194 offset:3584
    ds_read_b64_tr_b16 v[226:227], v194 offset:4032
    ds_read_b64_tr_b16 v[228:229], v195 offset:2304
    ds_read_b64_tr_b16 v[230:231], v195 offset:2592
    ds_read_b64_tr_b16 v[232:233], v194 offset:5376
    ds_read_b64_tr_b16 v[234:235], v194 offset:5824
    ds_read_b64_tr_b16 v[236:237], v195 offset:3456
    ds_read_b64_tr_b16 v[238:239], v195 offset:3744
    ds_read_b64_tr_b16 v[240:241], v194 offset:7168
    ds_read_b64_tr_b16 v[242:243], v194 offset:7616
    ds_read_b64_tr_b16 v[244:245], v195 offset:4608
    ds_read_b64_tr_b16 v[246:247], v195 offset:4896
    ds_read_b64_tr_b16 v[248:249], v194 offset:8960
    ds_read_b64_tr_b16 v[250:251], v194 offset:9408
    ds_read_b64_tr_b16 v[252:253], v195 offset:5760
    ds_read_b64_tr_b16 v[254:255], v195 offset:6048
    s_waitcnt lgkmcnt(15)
    v_mfma_f32_32x32x16_bf16 v[144:159], v[208:211], v[212:215], 0
    ds_read_b64_tr_b16 v[208:209], v194 offset:10752
    ds_read_b64_tr_b16 v[210:211], v194 offset:11200
    ds_read_b64_tr_b16 v[212:213], v195 offset:6912
    ds_read_b64_tr_b16 v[214:215], v195 offset:7200
    v_mfma_f32_32x32x16_bf16 v[144:159], v[216:219], v[220:223], v[144:159]
    ds_read_b64_tr_b16 v[216:217], v194 offset:12544
    ds_read_b64_tr_b16 v[218:219], v194 offset:12992
    ds_read_b64_tr_b16 v[220:221], v195 offset:8064
    ds_read_b64_tr_b16 v[222:223], v195 offset:8352
    s_waitcnt lgkmcnt(15)
    v_mfma_f32_32x32x16_bf16 v[144:159], v[224:227], v[228:231], v[144:159]
    v_mfma_f32_32x32x16_bf16 v[144:159], v[232:235], v[236:239], v[144:159]
    s_waitcnt lgkmcnt(12)
    v_mfma_f32_32x32x16_bf16 v[144:159], v[240:243], v[244:247], v[144:159]
    s_waitcnt lgkmcnt(8)
    v_mfma_f32_32x32x16_bf16 v[144:159], v[248:251], v[252:255], v[144:159]
    s_waitcnt lgkmcnt(4)
    v_mfma_f32_32x32x16_bf16 v[144:159], v[208:211], v[212:215], v[144:159]
    s_waitcnt lgkmcnt(0)
    v_mfma_f32_32x32x16_bf16 v[144:159], v[216:219], v[220:223], v[144:159]
    s_nop 11
    v_cvt_pk_bf16_f32 v208, v144, v145
    v_cvt_pk_bf16_f32 v209, v146, v147
    v_cvt_pk_bf16_f32 v210, v148, v149
    v_cvt_pk_bf16_f32 v211, v150, v151
    v_cvt_pk_bf16_f32 v212, v152, v153
    v_cvt_pk_bf16_f32 v213, v154, v155
    v_cvt_pk_bf16_f32 v214, v156, v157
    v_cvt_pk_bf16_f32 v215, v158, v159
    buffer_store_dwordx4 v[208:211], v2, s[16:19], s74 offen offset:0 sc1
    buffer_store_dwordx4 v[212:215], v2, s[16:19], s74 offen offset:1024 sc1
    s_lshl_b32 s50, s59, 12
    s_add_u32 s50, s50, 143360
    v_add_u32 v9, s50, v6
    v_add_u32 v10, s50, v7
    s_waitcnt vmcnt(17)
    ds_write_b128 v187, v[16:19] offset:0
    s_waitcnt vmcnt(16)
    ds_write_b128 v187, v[20:23] offset:1024
    ds_read_b64_tr_b16 v[16:17], v9 offset:0
    ds_read_b64_tr_b16 v[18:19], v9 offset:1024
    ds_read_b64_tr_b16 v[20:21], v10 offset:0
    ds_read_b64_tr_b16 v[22:23], v10 offset:1024
    s_waitcnt vmcnt(15)
    ds_write_b128 v187, v[24:27] offset:2048
    s_waitcnt vmcnt(14)
    ds_write_b128 v187, v[28:31] offset:3072
    ds_read_b64_tr_b16 v[24:25], v9 offset:2048
    ds_read_b64_tr_b16 v[26:27], v9 offset:3072
    ds_read_b64_tr_b16 v[28:29], v10 offset:2048
    ds_read_b64_tr_b16 v[30:31], v10 offset:3072
    s_waitcnt vmcnt(13)
    ds_write_b128 v187, v[32:35] offset:0
    s_waitcnt vmcnt(12)
    ds_write_b128 v187, v[36:39] offset:1024
    ds_read_b64_tr_b16 v[32:33], v9 offset:0
    ds_read_b64_tr_b16 v[34:35], v9 offset:1024
    ds_read_b64_tr_b16 v[36:37], v10 offset:0
    ds_read_b64_tr_b16 v[38:39], v10 offset:1024
    s_waitcnt vmcnt(0)
    v_mov_b32 v160, s43
    v_mov_b32 v161, s43
    v_mov_b32 v162, s43
    v_mov_b32 v163, s43
    v_lshrrev_b32 v164, 3, v1
    v_lshlrev_b32 v164, 8, v164
    v_and_or_b32 v164, v2, s56, v164
    s_mov_b32 exec_lo, 0xff
    s_mov_b32 exec_hi, 0x0
    buffer_store_dwordx4 v[160:163], v164, s[16:19], s75 offen sc1
    s_mov_b64 exec, -1
    s_setprio 0
    s_add_u32 s51, s68, s69
    buffer_load_dwordx4 v[80:83], v5, s[20:23], s51 offen
    buffer_load_dwordx4 v[84:87], v13, s[20:23], s51 offen
    s_add_u32 s69, s69, 14336
    s_cmp_eq_u32 s69, 401408
    s_cselect_b32 s69, 0, s69
    s_add_u32 s51, s68, s69
    buffer_load_dwordx4 v[88:91], v5, s[20:23], s51 offen
    buffer_load_dwordx4 v[92:95], v13, s[20:23], s51 offen
    s_add_u32 s69, s69, 14336
    s_cmp_eq_u32 s69, 401408
    s_cselect_b32 s69, 0, s69
    s_add_u32 s51, s68, s69
    buffer_load_dwordx4 v[96:99], v5, s[20:23], s51 offen
    buffer_load_dwordx4 v[100:103], v13, s[20:23], s51 offen
    s_add_u32 s69, s69, 14336
    s_cmp_eq_u32 s69, 401408
    s_cselect_b32 s69, 0, s69
    s_add_u32 s51, s68, s69
    buffer_load_dwordx4 v[104:107], v5, s[20:23], s51 offen
    buffer_load_dwordx4 v[108:111], v13, s[20:23], s51 offen
    s_add_u32 s69, s69, 14336
    s_cmp_eq_u32 s69, 401408
    s_cselect_b32 s69, 0, s69
    v_lshlrev_b32 v14, 7, v1
    s_lshl_b32 s50, s5, 2
    s_add_u32 s50, s50, s59
    s_mul_i32 s51, s50, 3200
    s_mov_b64 exec, 0x1ffffff
    buffer_load_dword v200, v14, s[24:27], s51 offen
    s_mov_b64 exec, -1
    ds_write_b128 v187, v[40:43] offset:2048
    ds_write_b128 v187, v[44:47] offset:3072
    ds_read_b64_tr_b16 v[40:41], v9 offset:2048
    ds_read_b64_tr_b16 v[42:43], v9 offset:3072
    ds_read_b64_tr_b16 v[44:45], v10 offset:2048
    ds_read_b64_tr_b16 v[46:47], v10 offset:3072
    ds_write_b128 v187, v[48:51] offset:0
    ds_write_b128 v187, v[52:55] offset:1024
    ds_read_b64_tr_b16 v[48:49], v9 offset:0
    ds_read_b64_tr_b16 v[50:51], v9 offset:1024
    ds_read_b64_tr_b16 v[52:53], v10 offset:0
    ds_read_b64_tr_b16 v[54:55], v10 offset:1024
    ds_write_b128 v187, v[56:59] offset:2048
    ds_write_b128 v187, v[60:63] offset:3072
    ds_read_b64_tr_b16 v[56:57], v9 offset:2048
    ds_read_b64_tr_b16 v[58:59], v9 offset:3072
    ds_read_b64_tr_b16 v[60:61], v10 offset:2048
    ds_read_b64_tr_b16 v[62:63], v10 offset:3072
    ds_write_b128 v187, v[64:67] offset:0
    ds_write_b128 v187, v[68:71] offset:1024
    ds_read_b64_tr_b16 v[64:65], v9 offset:0
    ds_read_b64_tr_b16 v[66:67], v9 offset:1024
    ds_read_b64_tr_b16 v[68:69], v10 offset:0
    ds_read_b64_tr_b16 v[70:71], v10 offset:1024
    ds_write_b128 v187, v[72:75] offset:2048
    ds_write_b128 v187, v[76:79] offset:3072
    ds_read_b64_tr_b16 v[72:73], v9 offset:2048
    ds_read_b64_tr_b16 v[74:75], v9 offset:3072
    ds_read_b64_tr_b16 v[76:77], v10 offset:2048
    ds_read_b64_tr_b16 v[78:79], v10 offset:3072
    s_waitcnt vmcnt(8)
    ds_write_b128 v187, v[80:83] offset:0
    s_waitcnt vmcnt(7)
    ds_write_b128 v187, v[84:87] offset:1024
    ds_read_b64_tr_b16 v[80:81], v9 offset:0
    ds_read_b64_tr_b16 v[82:83], v9 offset:1024
    ds_read_b64_tr_b16 v[84:85], v10 offset:0
    ds_read_b64_tr_b16 v[86:87], v10 offset:1024
    s_waitcnt vmcnt(6)
    ds_write_b128 v187, v[88:91] offset:2048
    s_waitcnt vmcnt(5)
    ds_write_b128 v187, v[92:95] offset:3072
    ds_read_b64_tr_b16 v[88:89], v9 offset:2048
    ds_read_b64_tr_b16 v[90:91], v9 offset:3072
    ds_read_b64_tr_b16 v[92:93], v10 offset:2048
    ds_read_b64_tr_b16 v[94:95], v10 offset:3072
    s_waitcnt vmcnt(4)
    ds_write_b128 v187, v[96:99] offset:0
    s_waitcnt vmcnt(3)
    ds_write_b128 v187, v[100:103] offset:1024
    ds_read_b64_tr_b16 v[96:97], v9 offset:0
    ds_read_b64_tr_b16 v[98:99], v9 offset:1024
    ds_read_b64_tr_b16 v[100:101], v10 offset:0
    ds_read_b64_tr_b16 v[102:103], v10 offset:1024
    s_waitcnt vmcnt(2)
    ds_write_b128 v187, v[104:107] offset:2048
    s_waitcnt vmcnt(1)
    ds_write_b128 v187, v[108:111] offset:3072
    ds_read_b64_tr_b16 v[104:105], v9 offset:2048
    ds_read_b64_tr_b16 v[106:107], v9 offset:3072
    ds_read_b64_tr_b16 v[108:109], v10 offset:2048
    ds_read_b64_tr_b16 v[110:111], v10 offset:3072
    s_mov_b64 exec, 15
    ds_add_u32 v11, v12 offset:256
    s_mov_b64 exec, -1
    s_waitcnt lgkmcnt(0)
    s_mov_b32 s70, 0
L_lw131:
    ds_read_b128 v[188:191], v192 offset:96
    s_add_u32 s70, s70, 1
    s_cmp_gt_u32 s70, 0x1000000
    s_cbranch_scc1 L_lw132
    s_sleep 1
    s_waitcnt lgkmcnt(0)
    v_min3_u32 v188, v188, v189, v190
    v_min_u32 v188, v188, v191
    s_nop 0
    v_readfirstlane_b32 s58, v188
    s_nop 0
    s_cmp_eq_u32 s58, 0
    s_cbranch_scc1 L_lw131
L_lw132:
    s_waitcnt lgkmcnt(0)
    ds_read_b32 v188, v0 offset:256
    s_waitcnt lgkmcnt(0)
    v_readfirstlane_b32 s58, v188
    s_nop 0
    s_cmp_ge_u32 s58, 4
    s_cbranch_scc0 L_ck135
L_ck134:
    s_mul_i32 s53, s59, 24576
    s_add_u32 m0, s53, 0
    s_add_u32 s51, s68, s69
    s_waitcnt vmcnt(20)
    buffer_load_dwordx4 v5, s[20:23], s51 offen lds
    s_add_u32 m0, s53, 1024
    s_add_u32 s69, s69, 14336
    s_cmp_eq_u32 s69, 401408
    s_cselect_b32 s69, 0, s69
    buffer_load_dwordx4 v13, s[20:23], s51 offen lds
    s_add_u32 m0, s53, 2048
    s_add_u32 s51, s68, s69
    s_waitcnt vmcnt(20)
    buffer_load_dwordx4 v5, s[20:23], s51 offen lds
    s_add_u32 m0, s53, 3072
    s_add_u32 s69, s69, 14336
    s_cmp_eq_u32 s69, 401408
    s_cselect_b32 s69, 0, s69
    buffer_load_dwordx4 v13, s[20:23], s51 offen lds
    s_add_u32 m0, s53, 4096
    s_add_u32 s51, s68, s69
    s_waitcnt vmcnt(20)
    buffer_load_dwordx4 v5, s[20:23], s51 offen lds
    s_add_u32 m0, s53, 5120
    s_add_u32 s69, s69, 14336
    s_cmp_eq_u32 s69, 401408
    s_cselect_b32 s69, 0, s69
    buffer_load_dwordx4 v13, s[20:23], s51 offen lds
    s_add_u32 m0, s53, 6144
    s_add_u32 s51, s68, s69
    s_waitcnt vmcnt(20)
    buffer_load_dwordx4 v5, s[20:23], s51 offen lds
    s_add_u32 m0, s53, 7168
    s_add_u32 s69, s69, 14336
    s_cmp_eq_u32 s69, 401408
    s_cselect_b32 s69, 0, s69
    buffer_load_dwordx4 v13, s[20:23], s51 offen lds
    s_add_u32 m0, s53, 8192
    s_add_u32 s51, s68, s69
    s_waitcnt vmcnt(20)
    buffer_load_dwordx4 v5, s[20:23], s51 offen lds
    s_add_u32 m0, s53, 9216
    s_add_u32 s69, s69, 14336
    s_cmp_eq_u32 s69, 401408
    s_cselect_b32 s69, 0, s69
    buffer_load_dwordx4 v13, s[20:23], s51 offen lds
    s_add_u32 m0, s53, 10240
    s_add_u32 s51, s68, s69
    s_waitcnt vmcnt(20)
    buffer_load_dwordx4 v5, s[20:23], s51 offen lds
    s_add_u32 m0, s53, 11264
    s_add_u32 s69, s69, 14336
    s_cmp_eq_u32 s69, 401408
    s_cselect_b32 s69, 0, s69
    buffer_load_dwordx4 v13, s[20:23], s51 offen lds
    s_add_u32 m0, s53, 12288
    s_add_u32 s51, s68, s69
    s_waitcnt vmcnt(20)
    buffer_load_dwordx4 v5, s[20:23], s51 offen lds
    s_add_u32 m0, s53, 13312
    s_add_u32 s69, s69, 14336
    s_cmp_eq_u32 s69, 401408
    s_cselect_b32 s69, 0, s69
    buffer_load_dwordx4 v13, s[20:23], s51 offen lds
    s_add_u32 m0, s53, 14336
    s_add_u32 s51, s68, s69
    s_waitcnt vmcnt(20)
    buffer_load_dwordx4 v5, s[20:23], s51 offen lds
    s_add_u32 m0, s53, 15360
    s_add_u32 s69, s69, 14336
    s_cmp_eq_u32 s69, 401408
    s_cselect_b32 s69, 0, s69
    buffer_load_dwordx4 v13, s[20:23], s51 offen lds
    s_add_u32 m0, s53, 16384
    s_add_u32 s51, s68, s69
    s_waitcnt vmcnt(20)
    buffer_load_dwordx4 v5, s[20:23], s51 offen lds
    s_add_u32 m0, s53, 17408
    s_add_u32 s69, s69, 14336
    s_cmp_eq_u32 s69, 401408
    s_cselect_b32 s69, 0, s69
    buffer_load_dwordx4 v13, s[20:23], s51 offen lds
    s_add_u32 m0, s53, 18432
    s_add_u32 s51, s68, s69
    s_waitcnt vmcnt(20)
    buffer_load_dwordx4 v5, s[20:23], s51 offen lds
    s_add_u32 m0, s53, 19456
    s_add_u32 s69, s69, 14336
    s_cmp_eq_u32 s69, 401408
    s_cselect_b32 s69, 0, s69
    buffer_load_dwordx4 v13, s[20:23], s51 offen lds
    s_add_u32 m0, s53, 20480
    s_add_u32 s51, s68, s69
    s_waitcnt vmcnt(20)
    buffer_load_dwordx4 v5, s[20:23], s51 offen lds
    s_add_u32 m0, s53, 21504
    s_add_u32 s69, s69, 14336
    s_cmp_eq_u32 s69, 401408
    s_cselect_b32 s69, 0, s69
    buffer_load_dwordx4 v13, s[20:23], s51 offen lds
    s_add_u32 m0, s53, 22528
    s_add_u32 s51, s68, s69
    s_waitcnt vmcnt(20)
    buffer_load_dwordx4 v5, s[20:23], s51 offen lds
    s_add_u32 m0, s53, 23552
    s_add_u32 s69, s69, 14336
    s_cmp_eq_u32 s69, 401408
    s_cselect_b32 s69, 0, s69
    buffer_load_dwordx4 v13, s[20:23], s51 offen lds
    s_lshl_b32 s52, s59, 14
    s_add_u32 s52, s52, 98304
    s_lshl_b32 s51, s59, 2
    s_add_u32 s51, s51, 0
    s_mul_i32 s51, s51, 25088
    s_lshl_b32 s58, s41, 7
    s_add_u32 s51, s51, s58
    s_add_u32 m0, s52, 0
    s_waitcnt vmcnt(20)
    s_nop 0
    buffer_load_dwordx4 v5, s[24:27], s51 offen lds
    s_add_u32 m0, s52, 1024
    s_waitcnt vmcnt(20)
    s_nop 0
    buffer_load_dwordx4 v13, s[24:27], s51 offen lds
    s_lshl_b32 s52, s59, 14
    s_add_u32 s52, s52, 98304
    s_lshl_b32 s51, s59, 2
    s_add_u32 s51, s51, 0
    s_mul_i32 s51, s51, 25088
    s_lshl_b32 s58, s41, 7
    s_add_u32 s51, s51, s58
    s_add_u32 s51, s51, 14336
    s_add_u32 m0, s52, 2048
    s_waitcnt vmcnt(20)
    s_nop 0
    buffer_load_dwordx4 v5, s[24:27], s51 offen lds
    s_add_u32 m0, s52, 3072
    s_waitcnt vmcnt(20)
    s_nop 0
    buffer_load_dwordx4 v13, s[24:27], s51 offen lds
    s_lshl_b32 s52, s59, 14
    s_add_u32 s52, s52, 98304
    s_lshl_b32 s51, s59, 2
    s_add_u32 s51, s51, 1
    s_mul_i32 s51, s51, 25088
    s_lshl_b32 s58, s41, 7
    s_add_u32 s51, s51, s58
    s_add_u32 m0, s52, 4096
    s_waitcnt vmcnt(20)
    s_nop 0
    buffer_load_dwordx4 v5, s[24:27], s51 offen lds
    s_add_u32 m0, s52, 5120
    s_waitcnt vmcnt(20)
    s_nop 0
    buffer_load_dwordx4 v13, s[24:27], s51 offen lds
    s_lshl_b32 s52, s59, 14
    s_add_u32 s52, s52, 98304
    s_lshl_b32 s51, s59, 2
    s_add_u32 s51, s51, 1
    s_mul_i32 s51, s51, 25088
    s_lshl_b32 s58, s41, 7
    s_add_u32 s51, s51, s58
    s_add_u32 s51, s51, 14336
    s_add_u32 m0, s52, 6144
    s_waitcnt vmcnt(20)
    s_nop 0
    buffer_load_dwordx4 v5, s[24:27], s51 offen lds
    s_add_u32 m0, s52, 7168
    s_waitcnt vmcnt(20)
    s_nop 0
    buffer_load_dwordx4 v13, s[24:27], s51 offen lds
    s_lshl_b32 s52, s59, 14
    s_add_u32 s52, s52, 98304
    s_lshl_b32 s51, s59, 2
    s_add_u32 s51, s51, 2
    s_mul_i32 s51, s51, 25088
    s_lshl_b32 s58, s41, 7
    s_add_u32 s51, s51, s58
    s_add_u32 m0, s52, 8192
    s_waitcnt vmcnt(20)
    s_nop 0
    buffer_load_dwordx4 v5, s[24:27], s51 offen lds
    s_add_u32 m0, s52, 9216
    s_waitcnt vmcnt(20)
    s_nop 0
    buffer_load_dwordx4 v13, s[24:27], s51 offen lds
    s_lshl_b32 s52, s59, 14
    s_add_u32 s52, s52, 98304
    s_lshl_b32 s51, s59, 2
    s_add_u32 s51, s51, 2
    s_mul_i32 s51, s51, 25088
    s_lshl_b32 s58, s41, 7
    s_add_u32 s51, s51, s58
    s_add_u32 s51, s51, 14336
    s_add_u32 m0, s52, 10240
    s_waitcnt vmcnt(20)
    s_nop 0
    buffer_load_dwordx4 v5, s[24:27], s51 offen lds
    s_add_u32 m0, s52, 11264
    s_waitcnt vmcnt(20)
    s_nop 0
    buffer_load_dwordx4 v13, s[24:27], s51 offen lds
    s_lshl_b32 s52, s59, 14
    s_add_u32 s52, s52, 98304
    s_lshl_b32 s51, s59, 2
    s_add_u32 s51, s51, 3
    s_mul_i32 s51, s51, 25088
    s_lshl_b32 s58, s41, 7
    s_add_u32 s51, s51, s58
    s_add_u32 m0, s52, 12288
    s_waitcnt vmcnt(20)
    s_nop 0
    buffer_load_dwordx4 v5, s[24:27], s51 offen lds
    s_add_u32 m0, s52, 13312
    s_waitcnt vmcnt(20)
    s_nop 0
    buffer_load_dwordx4 v13, s[24:27], s51 offen lds
    s_lshl_b32 s52, s59, 14
    s_add_u32 s52, s52, 98304
    s_lshl_b32 s51, s59, 2
    s_add_u32 s51, s51, 3
    s_mul_i32 s51, s51, 25088
    s_lshl_b32 s58, s41, 7
    s_add_u32 s51, s51, s58
    s_add_u32 s51, s51, 14336
    s_add_u32 m0, s52, 14336
    s_waitcnt vmcnt(20)
    s_nop 0
    buffer_load_dwordx4 v5, s[24:27], s51 offen lds
    s_add_u32 m0, s52, 15360
    s_waitcnt vmcnt(20)
    s_cmp_eq_u32 s59, 3
    s_cselect_b32 exec_hi, 0, -1
    buffer_load_dwordx4 v13, s[24:27], s51 offen lds
    s_mov_b64 exec, -1
    s_mov_b64 exec, 15
    ds_add_u32 v11, v12 offset:384
    s_mov_b64 exec, -1
    s_setprio 1
    s_mul_i32 s53, s59, 24576
    v_add_u32 v10, s53, v7
    v_add_u32 v11, s53, v6
    s_mul_i32 s66, s40, 229376
    s_mul_i32 s52, s59, 28672
    s_add_u32 s66, s66, s52
    s_add_u32 s66, s66, 0
    s_lshl_b32 s65, s57, 10
    s_and_b32 s52, s59, 1
    s_mul_i32 s52, s52, 114688
    v_add_u32 v15, s52, v2
    s_sub_u32 s52, 114688, s52
    v_add_u32 v14, s52, v2
    v_mov_b32 v12, v11
    v_mov_b32 v11, v5
    v_and_b32 v8, 31, v1
    v_mul_u32_u24 v3, 896, v8
    v_lshrrev_b32 v8, 5, v1
    v_lshl_add_u32 v3, v8, 4, v3
    s_and_b32 s50, s59, 1
    s_lshl_b32 s51, s40, 1
    s_add_u32 s50, s50, s51
    s_mul_i32 s60, s50, 28672
    s_lshr_b32 s50, s59, 1
    s_lshl_b32 s50, s50, 6
    s_add_u32 s60, s60, s50
    s_lshl_b32 s50, s41, 7
    s_add_u32 s60, s60, s50
    buffer_load_dwordx4 v[4:7], v3, s[8:11], s60 offen offset:0
    s_waitcnt lgkmcnt(0)
    v_lshlrev_b32 v8, 7, v1
    s_lshl_b32 s50, s40, 3
    s_add_u32 s50, s50, s41
    s_lshl_b32 s50, s50, 12
    s_lshl_b32 s51, s59, 9
    s_add_u32 s50, s50, s51
    s_add_u32 s50, s50, 13697024
    s_mov_b64 exec, 0xf
    s_mov_b32 s58, 0
L_pl136:
    buffer_load_dword v9, v8, s[16:19], s50 offen sc1
    s_waitcnt vmcnt(0)
    v_cmp_ne_u32 vcc, s43, v9
    s_add_u32 s58, s58, 1
    s_cbranch_vccz L_pl137
    s_cmp_gt_u32 s58, 0x400000
    s_cbranch_scc1 L_pl137
    s_sleep 12
    s_branch L_pl136
L_pl137:
    s_mov_b64 exec, -1
    v_mov_b32 v9, v12
    v_mov_b32 v12, 4
    v_lshlrev_b32 v8, 2, v1
    v_add_u32 v8, 163328, v8
    v_mov_b32 v255, 1
    s_mov_b64 exec, 15
    ds_add_u32 v8, v255 offset:240
    s_mov_b64 exec, -1
    s_waitcnt lgkmcnt(0)
    s_add_u32 s50, s66, s65
    buffer_load_dwordx4 v[112:115], v14, s[16:19], s50 offen sc1
    buffer_load_dwordx4 v[116:119], v15, s[16:19], s50 offen sc1
    s_add_u32 s65, s65, 1024
    s_cmp_eq_u32 s65, 28672
    s_cselect_b32 s65, 0, s65
    s_add_u32 s50, s66, s65
    buffer_load_dwordx4 v[120:123], v14, s[16:19], s50 offen sc1
    buffer_load_dwordx4 v[124:127], v15, s[16:19], s50 offen sc1
    s_add_u32 s65, s65, 1024
    s_cmp_eq_u32 s65, 28672
    s_cselect_b32 s65, 0, s65
    s_add_u32 s50, s66, s65
    buffer_load_dwordx4 v[128:131], v14, s[16:19], s50 offen sc1
    buffer_load_dwordx4 v[132:135], v15, s[16:19], s50 offen sc1
    s_add_u32 s65, s65, 1024
    s_cmp_eq_u32 s65, 28672
    s_cselect_b32 s65, 0, s65
    s_add_u32 s50, s66, s65
    buffer_load_dwordx4 v[136:139], v14, s[16:19], s50 offen sc1
    buffer_load_dwordx4 v[140:143], v15, s[16:19], s50 offen sc1
    s_add_u32 s65, s65, 1024
    s_cmp_eq_u32 s65, 28672
    s_cselect_b32 s65, 0, s65
    s_add_u32 s50, s66, s65
    buffer_load_dwordx4 v[208:211], v14, s[16:19], s50 offen sc1
    buffer_load_dwordx4 v[212:215], v15, s[16:19], s50 offen sc1
    s_add_u32 s65, s65, 1024
    s_cmp_eq_u32 s65, 28672
    s_cselect_b32 s65, 0, s65
    s_add_u32 s50, s66, s65
    buffer_load_dwordx4 v[216:219], v14, s[16:19], s50 offen sc1
    buffer_load_dwordx4 v[220:223], v15, s[16:19], s50 offen sc1
    s_add_u32 s65, s65, 1024
    s_cmp_eq_u32 s65, 28672
    s_cselect_b32 s65, 0, s65
    s_add_u32 s50, s66, s65
    buffer_load_dwordx4 v[224:227], v14, s[16:19], s50 offen sc1
    buffer_load_dwordx4 v[228:231], v15, s[16:19], s50 offen sc1
    s_add_u32 s65, s65, 1024
    s_cmp_eq_u32 s65, 28672
    s_cselect_b32 s65, 0, s65
    s_add_u32 s50, s66, s65
    buffer_load_dwordx4 v[232:235], v14, s[16:19], s50 offen sc1
    buffer_load_dwordx4 v[236:239], v15, s[16:19], s50 offen sc1
    s_add_u32 s65, s65, 1024
    s_cmp_eq_u32 s65, 28672
    s_cselect_b32 s65, 0, s65
    s_add_u32 s50, s66, s65
    buffer_load_dwordx4 v[240:243], v14, s[16:19], s50 offen sc1
    buffer_load_dwordx4 v[244:247], v15, s[16:19], s50 offen sc1
    s_add_u32 s65, s65, 1024
    s_cmp_eq_u32 s65, 28672
    s_cselect_b32 s65, 0, s65
    s_add_u32 s50, s66, s65
    buffer_load_dwordx4 v[248:251], v14, s[16:19], s50 offen sc1
    buffer_load_dwordx4 v[252:255], v15, s[16:19], s50 offen sc1
    s_add_u32 s65, s65, 1024
    s_cmp_eq_u32 s65, 28672
    s_cselect_b32 s65, 0, s65
    s_waitcnt vmcnt(19)
    v_mfma_f32_32x32x16_bf16 v[144:159], v[16:19], v[112:115], 0
    s_waitcnt vmcnt(18)
    v_mfma_f32_32x32x16_bf16 v[160:175], v[16:19], v[116:119], 0
    v_mfma_f32_32x32x16_bf16 v[176:191], v[20:23], v[112:115], 0
    v_mfma_f32_32x32x16_bf16 v[192:207], v[20:23], v[116:119], 0
    s_add_u32 s50, s66, s65
    buffer_load_dwordx4 v[16:19], v14, s[16:19], s50 offen sc1
    buffer_load_dwordx4 v[20:23], v15, s[16:19], s50 offen sc1
    s_add_u32 s65, s65, 1024
    s_cmp_eq_u32 s65, 28672
    s_cselect_b32 s65, 0, s65
    s_add_u32 s50, s66, s65
    buffer_load_dwordx4 v[112:115], v14, s[16:19], s50 offen sc1
    buffer_load_dwordx4 v[116:119], v15, s[16:19], s50 offen sc1
    s_add_u32 s65, s65, 1024
    s_cmp_eq_u32 s65, 28672
    s_cselect_b32 s65, 0, s65
    s_waitcnt vmcnt(21)
    v_mfma_f32_32x32x16_bf16 v[144:159], v[24:27], v[120:123], v[144:159]
    s_waitcnt vmcnt(20)
    v_mfma_f32_32x32x16_bf16 v[160:175], v[24:27], v[124:127], v[160:175]
    v_mfma_f32_32x32x16_bf16 v[176:191], v[28:31], v[120:123], v[176:191]
    v_mfma_f32_32x32x16_bf16 v[192:207], v[28:31], v[124:127], v[192:207]
    s_add_u32 s50, s66, s65
    buffer_load_dwordx4 v[24:27], v14, s[16:19], s50 offen sc1
    buffer_load_dwordx4 v[28:31], v15, s[16:19], s50 offen sc1
    s_add_u32 s65, s65, 1024
    s_cmp_eq_u32 s65, 28672
    s_cselect_b32 s65, 0, s65
    s_add_u32 s50, s66, s65
    buffer_load_dwordx4 v[120:123], v14, s[16:19], s50 offen sc1
    buffer_load_dwordx4 v[124:127], v15, s[16:19], s50 offen sc1
    s_add_u32 s65, s65, 1024
    s_cmp_eq_u32 s65, 28672
    s_cselect_b32 s65, 0, s65
    s_waitcnt vmcnt(23)
    v_mfma_f32_32x32x16_bf16 v[144:159], v[32:35], v[128:131], v[144:159]
    s_waitcnt vmcnt(22)
    v_mfma_f32_32x32x16_bf16 v[160:175], v[32:35], v[132:135], v[160:175]
    v_mfma_f32_32x32x16_bf16 v[176:191], v[36:39], v[128:131], v[176:191]
    v_mfma_f32_32x32x16_bf16 v[192:207], v[36:39], v[132:135], v[192:207]
    s_add_u32 s50, s66, s65
    buffer_load_dwordx4 v[32:35], v14, s[16:19], s50 offen sc1
    buffer_load_dwordx4 v[36:39], v15, s[16:19], s50 offen sc1
    s_add_u32 s65, s65, 1024
    s_cmp_eq_u32 s65, 28672
    s_cselect_b32 s65, 0, s65
    s_add_u32 s50, s66, s65
    buffer_load_dwordx4 v[128:131], v14, s[16:19], s50 offen sc1
    buffer_load_dwordx4 v[132:135], v15, s[16:19], s50 offen sc1
    s_add_u32 s65, s65, 1024
    s_cmp_eq_u32 s65, 28672
    s_cselect_b32 s65, 0, s65
    s_waitcnt vmcnt(25)
    v_mfma_f32_32x32x16_bf16 v[144:159], v[40:43], v[136:139], v[144:159]
    s_waitcnt vmcnt(24)
    v_mfma_f32_32x32x16_bf16 v[160:175], v[40:43], v[140:143], v[160:175]
    v_mfma_f32_32x32x16_bf16 v[176:191], v[44:47], v[136:139], v[176:191]
    v_mfma_f32_32x32x16_bf16 v[192:207], v[44:47], v[140:143], v[192:207]
    s_add_u32 s50, s66, s65
    buffer_load_dwordx4 v[40:43], v14, s[16:19], s50 offen sc1
    buffer_load_dwordx4 v[44:47], v15, s[16:19], s50 offen sc1
    s_add_u32 s65, s65, 1024
    s_cmp_eq_u32 s65, 28672
    s_cselect_b32 s65, 0, s65
    s_add_u32 s50, s66, s65
    buffer_load_dwordx4 v[136:139], v14, s[16:19], s50 offen sc1
    buffer_load_dwordx4 v[140:143], v15, s[16:19], s50 offen sc1
    s_add_u32 s65, s65, 1024
    s_cmp_eq_u32 s65, 28672
    s_cselect_b32 s65, 0, s65
    s_waitcnt vmcnt(27)
    v_mfma_f32_32x32x16_bf16 v[144:159], v[48:51], v[208:211], v[144:159]
    s_waitcnt vmcnt(26)
    v_mfma_f32_32x32x16_bf16 v[160:175], v[48:51], v[212:215], v[160:175]
    v_mfma_f32_32x32x16_bf16 v[176:191], v[52:55], v[208:211], v[176:191]
    v_mfma_f32_32x32x16_bf16 v[192:207], v[52:55], v[212:215], v[192:207]
    s_add_u32 s50, s66, s65
    buffer_load_dwordx4 v[48:51], v14, s[16:19], s50 offen sc1
    buffer_load_dwordx4 v[52:55], v15, s[16:19], s50 offen sc1
    s_add_u32 s65, s65, 1024
    s_cmp_eq_u32 s65, 28672
    s_cselect_b32 s65, 0, s65
    s_add_u32 s50, s66, s65
    buffer_load_dwordx4 v[208:211], v14, s[16:19], s50 offen sc1
    buffer_load_dwordx4 v[212:215], v15, s[16:19], s50 offen sc1
    s_add_u32 s65, s65, 1024
    s_cmp_eq_u32 s65, 28672
    s_cselect_b32 s65, 0, s65
    s_waitcnt vmcnt(29)
    v_mfma_f32_32x32x16_bf16 v[144:159], v[56:59], v[216:219], v[144:159]
    s_waitcnt vmcnt(28)
    v_mfma_f32_32x32x16_bf16 v[160:175], v[56:59], v[220:223], v[160:175]
    v_mfma_f32_32x32x16_bf16 v[176:191], v[60:63], v[216:219], v[176:191]
    v_mfma_f32_32x32x16_bf16 v[192:207], v[60:63], v[220:223], v[192:207]
    s_add_u32 s50, s66, s65
    buffer_load_dwordx4 v[56:59], v14, s[16:19], s50 offen sc1
    buffer_load_dwordx4 v[60:63], v15, s[16:19], s50 offen sc1
    s_add_u32 s65, s65, 1024
    s_cmp_eq_u32 s65, 28672
    s_cselect_b32 s65, 0, s65
    s_add_u32 s50, s66, s65
    buffer_load_dwordx4 v[216:219], v14, s[16:19], s50 offen sc1
    buffer_load_dwordx4 v[220:223], v15, s[16:19], s50 offen sc1
    s_add_u32 s65, s65, 1024
    s_cmp_eq_u32 s65, 28672
    s_cselect_b32 s65, 0, s65
    s_waitcnt vmcnt(31)
    v_mfma_f32_32x32x16_bf16 v[144:159], v[64:67], v[224:227], v[144:159]
    s_waitcnt vmcnt(30)
    v_mfma_f32_32x32x16_bf16 v[160:175], v[64:67], v[228:231], v[160:175]
    v_mfma_f32_32x32x16_bf16 v[176:191], v[68:71], v[224:227], v[176:191]
    v_mfma_f32_32x32x16_bf16 v[192:207], v[68:71], v[228:231], v[192:207]
    s_add_u32 s50, s66, s65
    buffer_load_dwordx4 v[224:227], v14, s[16:19], s50 offen sc1
    buffer_load_dwordx4 v[228:231], v15, s[16:19], s50 offen sc1
    s_add_u32 s65, s65, 1024
    s_cmp_eq_u32 s65, 28672
    s_cselect_b32 s65, 0, s65
    s_waitcnt vmcnt(31)
    v_mfma_f32_32x32x16_bf16 v[144:159], v[72:75], v[232:235], v[144:159]
    s_waitcnt vmcnt(30)
    v_mfma_f32_32x32x16_bf16 v[160:175], v[72:75], v[236:239], v[160:175]
    v_mfma_f32_32x32x16_bf16 v[176:191], v[76:79], v[232:235], v[176:191]
    v_mfma_f32_32x32x16_bf16 v[192:207], v[76:79], v[236:239], v[192:207]
    s_add_u32 s50, s66, s65
    buffer_load_dwordx4 v[232:235], v14, s[16:19], s50 offen sc1
    buffer_load_dwordx4 v[236:239], v15, s[16:19], s50 offen sc1
    s_add_u32 s65, s65, 1024
    s_cmp_eq_u32 s65, 28672
    s_cselect_b32 s65, 0, s65
    s_waitcnt vmcnt(31)
    v_mfma_f32_32x32x16_bf16 v[144:159], v[80:83], v[240:243], v[144:159]
    s_waitcnt vmcnt(30)
    v_mfma_f32_32x32x16_bf16 v[160:175], v[80:83], v[244:247], v[160:175]
    v_mfma_f32_32x32x16_bf16 v[176:191], v[84:87], v[240:243], v[176:191]
    v_mfma_f32_32x32x16_bf16 v[192:207], v[84:87], v[244:247], v[192:207]
    s_add_u32 s50, s66, s65
    buffer_load_dwordx4 v[240:243], v14, s[16:19], s50 offen sc1
    buffer_load_dwordx4 v[244:247], v15, s[16:19], s50 offen sc1
    s_add_u32 s65, s65, 1024
    s_cmp_eq_u32 s65, 28672
    s_cselect_b32 s65, 0, s65
    s_waitcnt vmcnt(31)
    v_mfma_f32_32x32x16_bf16 v[144:159], v[88:91], v[248:251], v[144:159]
    s_waitcnt vmcnt(30)
    v_mfma_f32_32x32x16_bf16 v[160:175], v[88:91], v[252:255], v[160:175]
    v_mfma_f32_32x32x16_bf16 v[176:191], v[92:95], v[248:251], v[176:191]
    v_mfma_f32_32x32x16_bf16 v[192:207], v[92:95], v[252:255], v[192:207]
    s_add_u32 s50, s66, s65
    buffer_load_dwordx4 v[88:91], v14, s[16:19], s50 offen sc1
    buffer_load_dwordx4 v[92:95], v15, s[16:19], s50 offen sc1
    s_add_u32 s65, s65, 1024
    s_cmp_eq_u32 s65, 28672
    s_cselect_b32 s65, 0, s65
    s_add_u32 s50, s66, s65
    buffer_load_dwordx4 v[248:251], v14, s[16:19], s50 offen sc1
    buffer_load_dwordx4 v[252:255], v15, s[16:19], s50 offen sc1
    s_add_u32 s65, s65, 1024
    s_cmp_eq_u32 s65, 28672
    s_cselect_b32 s65, 0, s65
    s_waitcnt vmcnt(33)
    v_mfma_f32_32x32x16_bf16 v[144:159], v[96:99], v[16:19], v[144:159]
    ds_read_b64_tr_b16 v[64:65], v9 offset:0
    ds_read_b64_tr_b16 v[66:67], v9 offset:1024
    ds_read_b64_tr_b16 v[68:69], v10 offset:0
    ds_read_b64_tr_b16 v[70:71], v10 offset:1024
    s_waitcnt vmcnt(32)
    v_mfma_f32_32x32x16_bf16 v[160:175], v[96:99], v[20:23], v[160:175]
    v_mfma_f32_32x32x16_bf16 v[176:191], v[100:103], v[16:19], v[176:191]
    v_mfma_f32_32x32x16_bf16 v[192:207], v[100:103], v[20:23], v[192:207]
    s_add_u32 s50, s66, s65
    buffer_load_dwordx4 v[96:99], v14, s[16:19], s50 offen sc1
    buffer_load_dwordx4 v[100:103], v15, s[16:19], s50 offen sc1
    s_waitcnt vmcnt(33)
    v_mfma_f32_32x32x16_bf16 v[144:159], v[104:107], v[112:115], v[144:159]
    ds_read_b64_tr_b16 v[72:73], v9 offset:2048
    ds_read_b64_tr_b16 v[74:75], v9 offset:3072
    ds_read_b64_tr_b16 v[76:77], v10 offset:2048
    ds_read_b64_tr_b16 v[78:79], v10 offset:3072
    s_waitcnt vmcnt(32)
    v_mfma_f32_32x32x16_bf16 v[160:175], v[104:107], v[116:119], v[160:175]
    v_mfma_f32_32x32x16_bf16 v[176:191], v[108:111], v[112:115], v[176:191]
    v_mfma_f32_32x32x16_bf16 v[192:207], v[108:111], v[116:119], v[192:207]
    s_waitcnt vmcnt(31) lgkmcnt(6)
    v_mfma_f32_32x32x16_bf16 v[144:159], v[64:67], v[24:27], v[144:159]
    ds_read_b64_tr_b16 v[80:81], v9 offset:4096
    ds_read_b64_tr_b16 v[82:83], v9 offset:5120
    ds_read_b64_tr_b16 v[84:85], v10 offset:4096
    ds_read_b64_tr_b16 v[86:87], v10 offset:5120
    s_waitcnt vmcnt(30)
    v_mfma_f32_32x32x16_bf16 v[160:175], v[64:67], v[28:31], v[160:175]
    s_waitcnt lgkmcnt(8)
    v_mfma_f32_32x32x16_bf16 v[176:191], v[68:71], v[24:27], v[176:191]
    v_mfma_f32_32x32x16_bf16 v[192:207], v[68:71], v[28:31], v[192:207]
    s_add_u32 m0, s53, 0
    s_add_u32 s51, s68, s69
    buffer_load_dwordx4 v11, s[20:23], s51 offen lds
    s_add_u32 m0, s53, 1024
    s_add_u32 s69, s69, 14336
    s_cmp_eq_u32 s69, 401408
    s_cselect_b32 s69, 0, s69
    buffer_load_dwordx4 v13, s[20:23], s51 offen lds
    s_waitcnt vmcnt(31) lgkmcnt(6)
    v_mfma_f32_32x32x16_bf16 v[144:159], v[72:75], v[120:123], v[144:159]
    ds_read_b64_tr_b16 v[64:65], v9 offset:6144
    ds_read_b64_tr_b16 v[66:67], v9 offset:7168
    ds_read_b64_tr_b16 v[68:69], v10 offset:6144
    ds_read_b64_tr_b16 v[70:71], v10 offset:7168
    s_waitcnt vmcnt(30)
    v_mfma_f32_32x32x16_bf16 v[160:175], v[72:75], v[124:127], v[160:175]
    s_waitcnt lgkmcnt(8)
    v_mfma_f32_32x32x16_bf16 v[176:191], v[76:79], v[120:123], v[176:191]
    v_mfma_f32_32x32x16_bf16 v[192:207], v[76:79], v[124:127], v[192:207]
    s_add_u32 m0, s53, 2048
    s_add_u32 s51, s68, s69
    buffer_load_dwordx4 v11, s[20:23], s51 offen lds
    s_add_u32 m0, s53, 3072
    s_add_u32 s69, s69, 14336
    s_cmp_eq_u32 s69, 401408
    s_cselect_b32 s69, 0, s69
    buffer_load_dwordx4 v13, s[20:23], s51 offen lds
    s_waitcnt vmcnt(31) lgkmcnt(6)
    v_mfma_f32_32x32x16_bf16 v[144:159], v[80:83], v[32:35], v[144:159]
    ds_read_b64_tr_b16 v[72:73], v9 offset:8192
    ds_read_b64_tr_b16 v[74:75], v9 offset:9216
    ds_read_b64_tr_b16 v[76:77], v10 offset:8192
    ds_read_b64_tr_b16 v[78:79], v10 offset:9216
    s_waitcnt vmcnt(30)
    v_mfma_f32_32x32x16_bf16 v[160:175], v[80:83], v[36:39], v[160:175]
    s_waitcnt lgkmcnt(8)
    v_mfma_f32_32x32x16_bf16 v[176:191], v[84:87], v[32:35], v[176:191]
    v_mfma_f32_32x32x16_bf16 v[192:207], v[84:87], v[36:39], v[192:207]
    ds_write_b32 v0, v12 offset:368
    s_add_u32 m0, s53, 4096
    s_add_u32 s51, s68, s69
    buffer_load_dwordx4 v11, s[20:23], s51 offen lds
    s_add_u32 m0, s53, 5120
    s_add_u32 s69, s69, 14336
    s_cmp_eq_u32 s69, 401408
    s_cselect_b32 s69, 0, s69
    buffer_load_dwordx4 v13, s[20:23], s51 offen lds
    s_waitcnt vmcnt(31) lgkmcnt(7)
    v_mfma_f32_32x32x16_bf16 v[144:159], v[64:67], v[128:131], v[144:159]
    ds_read_b64_tr_b16 v[80:81], v9 offset:10240
    ds_read_b64_tr_b16 v[82:83], v9 offset:11264
    ds_read_b64_tr_b16 v[84:85], v10 offset:10240
    ds_read_b64_tr_b16 v[86:87], v10 offset:11264
    s_waitcnt vmcnt(30)
    v_mfma_f32_32x32x16_bf16 v[160:175], v[64:67], v[132:135], v[160:175]
    s_waitcnt lgkmcnt(9)
    v_mfma_f32_32x32x16_bf16 v[176:191], v[68:71], v[128:131], v[176:191]
    v_mfma_f32_32x32x16_bf16 v[192:207], v[68:71], v[132:135], v[192:207]
    s_add_u32 m0, s53, 6144
    s_add_u32 s51, s68, s69
    buffer_load_dwordx4 v11, s[20:23], s51 offen lds
    s_add_u32 m0, s53, 7168
    s_add_u32 s69, s69, 14336
    s_cmp_eq_u32 s69, 401408
    s_cselect_b32 s69, 0, s69
    buffer_load_dwordx4 v13, s[20:23], s51 offen lds
    s_waitcnt vmcnt(31) lgkmcnt(7)
    v_mfma_f32_32x32x16_bf16 v[144:159], v[72:75], v[40:43], v[144:159]
    ds_read_b64_tr_b16 v[64:65], v9 offset:12288
    ds_read_b64_tr_b16 v[66:67], v9 offset:13312
    ds_read_b64_tr_b16 v[68:69], v10 offset:12288
    ds_read_b64_tr_b16 v[70:71], v10 offset:13312
    s_waitcnt vmcnt(30)
    v_mfma_f32_32x32x16_bf16 v[160:175], v[72:75], v[44:47], v[160:175]
    s_waitcnt lgkmcnt(9)
    v_mfma_f32_32x32x16_bf16 v[176:191], v[76:79], v[40:43], v[176:191]
    v_mfma_f32_32x32x16_bf16 v[192:207], v[76:79], v[44:47], v[192:207]
    s_waitcnt vmcnt(29) lgkmcnt(6)
    v_mfma_f32_32x32x16_bf16 v[144:159], v[80:83], v[136:139], v[144:159]
    ds_read_b64_tr_b16 v[72:73], v9 offset:14336
    ds_read_b64_tr_b16 v[74:75], v9 offset:15360
    ds_read_b64_tr_b16 v[76:77], v10 offset:14336
    ds_read_b64_tr_b16 v[78:79], v10 offset:15360
    s_waitcnt vmcnt(28)
    v_mfma_f32_32x32x16_bf16 v[160:175], v[80:83], v[140:143], v[160:175]
    s_waitcnt lgkmcnt(8)
    v_mfma_f32_32x32x16_bf16 v[176:191], v[84:87], v[136:139], v[176:191]
    v_mfma_f32_32x32x16_bf16 v[192:207], v[84:87], v[140:143], v[192:207]
    s_waitcnt vmcnt(27) lgkmcnt(6)
    v_mfma_f32_32x32x16_bf16 v[144:159], v[64:67], v[48:51], v[144:159]
    ds_read_b64_tr_b16 v[80:81], v9 offset:16384
    ds_read_b64_tr_b16 v[82:83], v9 offset:17408
    ds_read_b64_tr_b16 v[84:85], v10 offset:16384
    ds_read_b64_tr_b16 v[86:87], v10 offset:17408
    s_waitcnt vmcnt(26)
    v_mfma_f32_32x32x16_bf16 v[160:175], v[64:67], v[52:55], v[160:175]
    s_waitcnt lgkmcnt(8)
    v_mfma_f32_32x32x16_bf16 v[176:191], v[68:71], v[48:51], v[176:191]
    v_mfma_f32_32x32x16_bf16 v[192:207], v[68:71], v[52:55], v[192:207]
    s_waitcnt vmcnt(25) lgkmcnt(6)
    v_mfma_f32_32x32x16_bf16 v[144:159], v[72:75], v[208:211], v[144:159]
    ds_read_b64_tr_b16 v[64:65], v9 offset:18432
    ds_read_b64_tr_b16 v[66:67], v9 offset:19456
    ds_read_b64_tr_b16 v[68:69], v10 offset:18432
    ds_read_b64_tr_b16 v[70:71], v10 offset:19456
    s_waitcnt vmcnt(24)
    v_mfma_f32_32x32x16_bf16 v[160:175], v[72:75], v[212:215], v[160:175]
    s_waitcnt lgkmcnt(8)
    v_mfma_f32_32x32x16_bf16 v[176:191], v[76:79], v[208:211], v[176:191]
    v_mfma_f32_32x32x16_bf16 v[192:207], v[76:79], v[212:215], v[192:207]
    s_waitcnt vmcnt(23) lgkmcnt(6)
    v_mfma_f32_32x32x16_bf16 v[144:159], v[80:83], v[56:59], v[144:159]
    ds_read_b64_tr_b16 v[72:73], v9 offset:20480
    ds_read_b64_tr_b16 v[74:75], v9 offset:21504
    ds_read_b64_tr_b16 v[76:77], v10 offset:20480
    ds_read_b64_tr_b16 v[78:79], v10 offset:21504
    s_waitcnt vmcnt(22)
    v_mfma_f32_32x32x16_bf16 v[160:175], v[80:83], v[60:63], v[160:175]
    s_waitcnt lgkmcnt(8)
    v_mfma_f32_32x32x16_bf16 v[176:191], v[84:87], v[56:59], v[176:191]
    v_mfma_f32_32x32x16_bf16 v[192:207], v[84:87], v[60:63], v[192:207]
    s_waitcnt vmcnt(21) lgkmcnt(6)
    v_mfma_f32_32x32x16_bf16 v[144:159], v[64:67], v[216:219], v[144:159]
    ds_read_b64_tr_b16 v[80:81], v9 offset:22528
    ds_read_b64_tr_b16 v[82:83], v9 offset:23552
    ds_read_b64_tr_b16 v[84:85], v10 offset:22528
    ds_read_b64_tr_b16 v[86:87], v10 offset:23552
    s_waitcnt vmcnt(20)
    v_mfma_f32_32x32x16_bf16 v[160:175], v[64:67], v[220:223], v[160:175]
    s_waitcnt lgkmcnt(8)
    v_mfma_f32_32x32x16_bf16 v[176:191], v[68:71], v[216:219], v[176:191]
    v_mfma_f32_32x32x16_bf16 v[192:207], v[68:71], v[220:223], v[192:207]
    s_waitcnt vmcnt(19) lgkmcnt(6)
    v_mfma_f32_32x32x16_bf16 v[144:159], v[72:75], v[224:227], v[144:159]
    s_waitcnt vmcnt(6)
    ds_read_b64_tr_b16 v[64:65], v9 offset:0
    ds_read_b64_tr_b16 v[66:67], v9 offset:1024
    ds_read_b64_tr_b16 v[68:69], v10 offset:0
    ds_read_b64_tr_b16 v[70:71], v10 offset:1024
    v_mfma_f32_32x32x16_bf16 v[160:175], v[72:75], v[228:231], v[160:175]
    s_waitcnt lgkmcnt(8)
    v_mfma_f32_32x32x16_bf16 v[176:191], v[76:79], v[224:227], v[176:191]
    v_mfma_f32_32x32x16_bf16 v[192:207], v[76:79], v[228:231], v[192:207]
    s_waitcnt lgkmcnt(6)
    v_mfma_f32_32x32x16_bf16 v[144:159], v[80:83], v[232:235], v[144:159]
    s_waitcnt vmcnt(4)
    ds_read_b64_tr_b16 v[72:73], v9 offset:2048
    ds_read_b64_tr_b16 v[74:75], v9 offset:3072
    ds_read_b64_tr_b16 v[76:77], v10 offset:2048
    ds_read_b64_tr_b16 v[78:79], v10 offset:3072
    v_mfma_f32_32x32x16_bf16 v[160:175], v[80:83], v[236:239], v[160:175]
    s_waitcnt lgkmcnt(8)
    v_mfma_f32_32x32x16_bf16 v[176:191], v[84:87], v[232:235], v[176:191]
    v_mfma_f32_32x32x16_bf16 v[192:207], v[84:87], v[236:239], v[192:207]
    s_waitcnt lgkmcnt(6)
    v_mfma_f32_32x32x16_bf16 v[144:159], v[64:67], v[240:243], v[144:159]
    s_waitcnt vmcnt(2)
    ds_read_b64_tr_b16 v[80:81], v9 offset:4096
    ds_read_b64_tr_b16 v[82:83], v9 offset:5120
    ds_read_b64_tr_b16 v[84:85], v10 offset:4096
    ds_read_b64_tr_b16 v[86:87], v10 offset:5120
    v_mfma_f32_32x32x16_bf16 v[160:175], v[64:67], v[244:247], v[160:175]
    s_waitcnt lgkmcnt(8)
    v_mfma_f32_32x32x16_bf16 v[176:191], v[68:71], v[240:243], v[176:191]
    v_mfma_f32_32x32x16_bf16 v[192:207], v[68:71], v[244:247], v[192:207]
    s_waitcnt vmcnt(0)
    ds_read_b64_tr_b16 v[64:65], v9 offset:6144
    ds_read_b64_tr_b16 v[66:67], v9 offset:7168
    ds_read_b64_tr_b16 v[68:69], v10 offset:6144
    ds_read_b64_tr_b16 v[70:71], v10 offset:7168
    s_mul_i32 s53, s59, 24576
    s_xor_b32 s50, s59, 3
    s_lshl_b32 s50, s50, 12
    s_add_u32 s50, s50, s53
    v_add_u32 v16, s50, v2
    s_xor_b32 s50, s59, 2
    s_lshl_b32 s50, s50, 12
    s_add_u32 s50, s50, s53
    v_add_u32 v17, s50, v2
    s_xor_b32 s50, s59, 1
    s_lshl_b32 s50, s50, 12
    s_add_u32 s50, s50, s53
    v_add_u32 v18, s50, v2
    v_lshlrev_b32 v19, 2, v1
    v_add_u32 v19, 163328, v19
    v_mov_b32 v20, 1
    s_waitcnt lgkmcnt(10)
    v_mfma_f32_32x32x16_bf16 v[144:159], v[72:75], v[88:91], v[144:159]
    s_waitcnt lgkmcnt(6)
    v_mfma_f32_32x32x16_bf16 v[144:159], v[80:83], v[248:251], v[144:159]
    s_waitcnt lgkmcnt(2)
    v_mfma_f32_32x32x16_bf16 v[144:159], v[64:67], v[96:99], v[144:159]
    v_mfma_f32_32x32x16_bf16 v[160:175], v[72:75], v[92:95], v[160:175]
    v_mfma_f32_32x32x16_bf16 v[160:175], v[80:83], v[252:255], v[160:175]
    v_mfma_f32_32x32x16_bf16 v[160:175], v[64:67], v[100:103], v[160:175]
    v_mfma_f32_32x32x16_bf16 v[176:191], v[76:79], v[88:91], v[176:191]
    v_mfma_f32_32x32x16_bf16 v[176:191], v[84:87], v[248:251], v[176:191]
    s_waitcnt lgkmcnt(0)
    v_mfma_f32_32x32x16_bf16 v[176:191], v[68:71], v[96:99], v[176:191]
    s_nop 4
    ds_write_b128 v16, v[144:147] offset:0
    ds_write_b128 v16, v[148:151] offset:1024
    ds_write_b128 v16, v[152:155] offset:2048
    ds_write_b128 v16, v[156:159] offset:3072
    v_mfma_f32_32x32x16_bf16 v[192:207], v[76:79], v[92:95], v[192:207]
    v_mfma_f32_32x32x16_bf16 v[192:207], v[84:87], v[252:255], v[192:207]
    v_mfma_f32_32x32x16_bf16 v[192:207], v[68:71], v[100:103], v[192:207]
    ds_write_b128 v17, v[160:163] offset:0
    ds_write_b128 v17, v[164:167] offset:1024
    ds_write_b128 v17, v[168:171] offset:2048
    ds_write_b128 v17, v[172:175] offset:3072
    ds_write_b128 v18, v[176:179] offset:0
    ds_write_b128 v18, v[180:183] offset:1024
    ds_write_b128 v18, v[184:187] offset:2048
    ds_write_b128 v18, v[188:191] offset:3072
    s_mov_b64 exec, 15
    ds_add_u32 v19, v20 offset:400
    s_mov_b64 exec, -1
    s_lshl_b32 s52, s59, 12
    s_xor_b32 s50, s59, 1
    s_mul_i32 s50, s50, 24576
    s_add_u32 s50, s50, s52
    v_add_u32 v20, s50, v2
    s_xor_b32 s50, s59, 2
    s_mul_i32 s50, s50, 24576
    s_add_u32 s50, s50, s52
    v_add_u32 v21, s50, v2
    s_xor_b32 s50, s59, 3
    s_mul_i32 s50, s50, 24576
    s_add_u32 s50, s50, s52
    v_add_u32 v22, s50, v2
    s_add_u32 s53, s53, 16384
    v_add_u32 v23, s53, v2
    v_permlane32_swap_b32 v4, v6
    v_permlane32_swap_b32 v5, v7
    v_lshlrev_b32 v104, 16, v4
    v_and_b32 v105, 0xffff0000, v4
    v_lshlrev_b32 v106, 16, v5
    v_and_b32 v107, 0xffff0000, v5
    v_lshlrev_b32 v108, 16, v6
    v_and_b32 v109, 0xffff0000, v6
    v_lshlrev_b32 v110, 16, v7
    v_and_b32 v111, 0xffff0000, v7
    ds_read_b32 v26, v0 offset:400
    s_waitcnt lgkmcnt(0)
    v_readfirstlane_b32 s58, v26
    s_nop 0
    s_cmp_ge_u32 s58, 4
    s_cbranch_scc0 L_ck140
L_ck139:
    ds_read_b128 v[32:35], v20 offset:0
    ds_read_b128 v[36:39], v20 offset:1024
    ds_read_b128 v[40:43], v20 offset:2048
    ds_read_b128 v[44:47], v20 offset:3072
    ds_read_b128 v[48:51], v21 offset:0
    ds_read_b128 v[52:55], v21 offset:1024
    ds_read_b128 v[56:59], v21 offset:2048
    ds_read_b128 v[60:63], v21 offset:3072
    ds_read_b128 v[64:67], v22 offset:0
    ds_read_b128 v[68:71], v22 offset:1024
    ds_read_b128 v[72:75], v22 offset:2048
    ds_read_b128 v[76:79], v22 offset:3072
    s_waitcnt lgkmcnt(11)
    v_add_f32 v192, v192, v32
    v_add_f32 v193, v193, v33
    v_add_f32 v194, v194, v34
    v_add_f32 v195, v195, v35
    s_waitcnt lgkmcnt(10)
    v_add_f32 v196, v196, v36
    v_add_f32 v197, v197, v37
    v_add_f32 v198, v198, v38
    v_add_f32 v199, v199, v39
    s_waitcnt lgkmcnt(9)
    v_add_f32 v200, v200, v40
    v_add_f32 v201, v201, v41
    v_add_f32 v202, v202, v42
    v_add_f32 v203, v203, v43
    s_waitcnt lgkmcnt(8)
    v_add_f32 v204, v204, v44
    v_add_f32 v205, v205, v45
    v_add_f32 v206, v206, v46
    v_add_f32 v207, v207, v47
    s_waitcnt lgkmcnt(7)
    v_add_f32 v192, v192, v48
    v_add_f32 v193, v193, v49
    v_add_f32 v194, v194, v50
    v_add_f32 v195, v195, v51
    s_waitcnt lgkmcnt(6)
    v_add_f32 v196, v196, v52
    v_add_f32 v197, v197, v53
    v_add_f32 v198, v198, v54
    v_add_f32 v199, v199, v55
    s_waitcnt lgkmcnt(5)
    v_add_f32 v200, v200, v56
    v_add_f32 v201, v201, v57
    v_add_f32 v202, v202, v58
    v_add_f32 v203, v203, v59
    s_waitcnt lgkmcnt(4)
    v_add_f32 v204, v204, v60
    v_add_f32 v205, v205, v61
    v_add_f32 v206, v206, v62
    v_add_f32 v207, v207, v63
    s_waitcnt lgkmcnt(3)
    v_add_f32 v192, v192, v64
    v_add_f32 v193, v193, v65
    v_add_f32 v194, v194, v66
    v_add_f32 v195, v195, v67
    s_waitcnt lgkmcnt(2)
    v_add_f32 v196, v196, v68
    v_add_f32 v197, v197, v69
    v_add_f32 v198, v198, v70
    v_add_f32 v199, v199, v71
    s_waitcnt lgkmcnt(1)
    v_add_f32 v200, v200, v72
    v_add_f32 v201, v201, v73
    v_add_f32 v202, v202, v74
    v_add_f32 v203, v203, v75
    s_waitcnt lgkmcnt(0)
    v_add_f32 v204, v204, v76
    v_add_f32 v205, v205, v77
    v_add_f32 v206, v206, v78
    v_add_f32 v207, v207, v79
    v_mul_f32 v80, 0xbfb8aa3b, v192
    v_mul_f32 v81, 0xbfb8aa3b, v193
    v_mul_f32 v82, 0xbfb8aa3b, v194
    v_mul_f32 v83, 0xbfb8aa3b, v195
    v_mul_f32 v84, 0xbfb8aa3b, v196
    v_mul_f32 v85, 0xbfb8aa3b, v197
    v_mul_f32 v86, 0xbfb8aa3b, v198
    v_mul_f32 v87, 0xbfb8aa3b, v199
    v_mul_f32 v88, 0xbfb8aa3b, v200
    v_mul_f32 v89, 0xbfb8aa3b, v201
    v_mul_f32 v90, 0xbfb8aa3b, v202
    v_mul_f32 v91, 0xbfb8aa3b, v203
    v_mul_f32 v92, 0xbfb8aa3b, v204
    v_mul_f32 v93, 0xbfb8aa3b, v205
    v_mul_f32 v94, 0xbfb8aa3b, v206
    v_mul_f32 v95, 0xbfb8aa3b, v207
    v_exp_f32 v80, v80
    v_exp_f32 v81, v81
    v_exp_f32 v82, v82
    v_exp_f32 v83, v83
    v_exp_f32 v84, v84
    v_exp_f32 v85, v85
    v_exp_f32 v86, v86
    v_exp_f32 v87, v87
    v_exp_f32 v88, v88
    v_exp_f32 v89, v89
    v_exp_f32 v90, v90
    v_exp_f32 v91, v91
    v_exp_f32 v92, v92
    v_exp_f32 v93, v93
    v_exp_f32 v94, v94
    v_exp_f32 v95, v95
    v_add_f32 v80, 1.0, v80
    v_add_f32 v81, 1.0, v81
    v_add_f32 v82, 1.0, v82
    v_add_f32 v83, 1.0, v83
    v_add_f32 v84, 1.0, v84
    v_add_f32 v85, 1.0, v85
    v_add_f32 v86, 1.0, v86
    v_add_f32 v87, 1.0, v87
    v_add_f32 v88, 1.0, v88
    v_add_f32 v89, 1.0, v89
    v_add_f32 v90, 1.0, v90
    v_add_f32 v91, 1.0, v91
    v_add_f32 v92, 1.0, v92
    v_add_f32 v93, 1.0, v93
    v_add_f32 v94, 1.0, v94
    v_add_f32 v95, 1.0, v95
    v_rcp_f32 v80, v80
    v_rcp_f32 v81, v81
    v_rcp_f32 v82, v82
    v_rcp_f32 v83, v83
    v_rcp_f32 v84, v84
    v_rcp_f32 v85, v85
    v_rcp_f32 v86, v86
    v_rcp_f32 v87, v87
    v_rcp_f32 v88, v88
    v_rcp_f32 v89, v89
    v_rcp_f32 v90, v90
    v_rcp_f32 v91, v91
    v_rcp_f32 v92, v92
    v_rcp_f32 v93, v93
    v_rcp_f32 v94, v94
    v_rcp_f32 v95, v95
    v_mul_f32 v192, v192, v80
    v_mul_f32 v193, v193, v81
    v_mul_f32 v194, v194, v82
    v_mul_f32 v195, v195, v83
    v_mul_f32 v196, v196, v84
    v_mul_f32 v197, v197, v85
    v_mul_f32 v198, v198, v86
    v_mul_f32 v199, v199, v87
    v_mul_f32 v200, v200, v88
    v_mul_f32 v201, v201, v89
    v_mul_f32 v202, v202, v90
    v_mul_f32 v203, v203, v91
    v_mul_f32 v204, v204, v92
    v_mul_f32 v205, v205, v93
    v_mul_f32 v206, v206, v94
    v_mul_f32 v207, v207, v95
    ds_write_b128 v23, v[200:203] offset:6144
    ds_write_b128 v23, v[204:207] offset:7168
    s_waitcnt lgkmcnt(0)
    s_barrier
    ds_read_b128 v[32:35], v23 offset:0
    ds_read_b128 v[36:39], v23 offset:1024
    ds_read_b128 v[40:43], v23 offset:4096
    ds_read_b128 v[44:47], v23 offset:5120
    s_waitcnt lgkmcnt(1)
    v_add_f32 v32, v32, v40
    v_add_f32 v33, v33, v41
    v_add_f32 v34, v34, v42
    v_add_f32 v35, v35, v43
    s_waitcnt lgkmcnt(0)
    v_add_f32 v36, v36, v44
    v_add_f32 v37, v37, v45
    v_add_f32 v38, v38, v46
    v_add_f32 v39, v39, v47
    v_fmac_f32 v104, v32, v192
    v_fmac_f32 v105, v33, v193
    v_fmac_f32 v106, v34, v194
    v_fmac_f32 v107, v35, v195
    v_fmac_f32 v108, v36, v196
    v_fmac_f32 v109, v37, v197
    v_fmac_f32 v110, v38, v198
    v_fmac_f32 v111, v39, v199
    v_cvt_pk_bf16_f32 v4, v104, v105
    v_cvt_pk_bf16_f32 v5, v106, v107
    v_cvt_pk_bf16_f32 v6, v108, v109
    v_cvt_pk_bf16_f32 v7, v110, v111
    s_nop 0
    v_permlane32_swap_b32 v4, v6
    v_permlane32_swap_b32 v5, v7
    buffer_store_dwordx4 v[4:7], v3, s[28:31], s60 offen offset:0
    s_branch L_fin
L_lspare:
    s_mul_i32 s61, s59, s44
    s_lshl_b32 s61, s61, 3
    s_lshl_b32 s53, s59, 10
    s_lshl_b32 s65, s44, 6
    s_lshl_b32 s67, s44, 5
    s_mul_i32 s66, s44, 448
    s_mul_i32 s64, s65, s1
    s_getpc_b64 s[72:73]
L_pc141:
    s_sub_u32 s72, s72, L_pc141 - recurrent_scan__linear_kernel_hedgehog__dense_activation_silu__prompt_kernel
    s_subb_u32 s73, s73, 0
    s_lshl_b32 s50, s5, 2
    s_add_u32 s50, s50, s59
    s_lshl_b32 s50, s50, 2
    v_add_u32 v8, s50, v1
    v_lshlrev_b32 v8, 7, v8
    v_min_u32 v8, L_end - recurrent_scan__linear_kernel_hedgehog__dense_activation_silu__prompt_kernel, v8
    v_mov_b32 v9, s73
    v_add_co_u32 v8, vcc, s72, v8
    s_nop 1
    v_addc_co_u32 v9, vcc, 0, v9, vcc
    s_mov_b64 exec, 15
    global_load_dword v200, v[8:9], off
    s_mov_b64 exec, -1
    s_barrier
    s_add_u32 m0, s53, 114688
    s_add_u32 s50, s64, s61
    s_add_u32 s50, s50, s45
    buffer_load_dwordx4 v3, s[12:15], s50 offen lds
    s_add_u32 m0, s53, 118784
    s_add_u32 s50, s50, s67
    s_add_u32 s64, s64, s65
    s_cmp_eq_u32 s64, s66
    s_cselect_b32 s64, 0, s64
    buffer_load_dwordx4 v3, s[12:15], s50 offen lds
    s_add_u32 m0, s53, 122880
    s_add_u32 s50, s64, s61
    s_add_u32 s50, s50, s45
    buffer_load_dwordx4 v3, s[12:15], s50 offen lds
    s_add_u32 m0, s53, 126976
    s_add_u32 s50, s50, s67
    s_add_u32 s64, s64, s65
    s_cmp_eq_u32 s64, s66
    s_cselect_b32 s64, 0, s64
    buffer_load_dwordx4 v3, s[12:15], s50 offen lds
    s_add_u32 m0, s53, 131072
    s_add_u32 s50, s64, s61
    s_add_u32 s50, s50, s45
    buffer_load_dwordx4 v3, s[12:15], s50 offen lds
    s_add_u32 m0, s53, 135168
    s_add_u32 s50, s50, s67
    s_add_u32 s64, s64, s65
    s_cmp_eq_u32 s64, s66
    s_cselect_b32 s64, 0, s64
    buffer_load_dwordx4 v3, s[12:15], s50 offen lds
    s_add_u32 m0, s53, 139264
    s_add_u32 s50, s64, s61
    s_add_u32 s50, s50, s45
    buffer_load_dwordx4 v3, s[12:15], s50 offen lds
    s_add_u32 m0, s53, 159744
    s_mul_i32 s50, s42, 3136
    s_add_u32 s50, s50, s53
    s_cmp_eq_u32 s59, 3
    s_cselect_b32 exec_hi, 0, -1
    buffer_load_dwordx4 v2, s[36:39], s50 offen lds
    s_mov_b64 exec, -1
    s_add_u32 m0, s53, 143360
    s_add_u32 s50, s64, s61
    s_add_u32 s50, s50, s45
    s_add_u32 s50, s50, s67
    s_add_u32 s64, s64, s65
    s_cmp_eq_u32 s64, s66
    s_cselect_b32 s64, 0, s64
    buffer_load_dwordx4 v3, s[12:15], s50 offen lds
    s_add_u32 m0, s53, 147456
    s_add_u32 s50, s64, s61
    s_add_u32 s50, s50, s45
    buffer_load_dwordx4 v3, s[12:15], s50 offen lds
    s_add_u32 m0, s53, 151552
    s_add_u32 s50, s50, s67
    s_add_u32 s64, s64, s65
    s_cmp_eq_u32 s64, s66
    s_cselect_b32 s64, 0, s64
    buffer_load_dwordx4 v3, s[12:15], s50 offen lds
    s_add_u32 m0, s53, 155648
    s_add_u32 s50, s64, s61
    s_add_u32 s50, s50, s45
    buffer_load_dwordx4 v3, s[12:15], s50 offen lds
    s_or_b32 s50, s2, s59
    s_cmp_lg_u32 s50, 0
    s_cbranch_scc1 L_nt142
    s_mov_b32 s50, 14843904
    v_mov_b32 v9, 0
    s_mov_b64 exec, 1
    buffer_load_dword v8, v9, s[16:19], s50 offen sc1
    s_waitcnt vmcnt(0)
    v_or_b32 v8, 0x40004000, v8
    v_add_u32 v8, 1, v8
    v_and_b32 v8, 0xbfffbfff, v8
    v_max_u32 v8, 1, v8
    s_nop 1
    buffer_store_dword v8, v9, s[16:19], s50 offen sc1
    buffer_store_dword v8, v9, s[32:35], 0 offen sc1
    s_waitcnt vmcnt(0)
    s_mov_b64 exec, -1
L_nt142:
    v_lshlrev_b32 v11, 2, v1
    v_add_u32 v11, 163328, v11
    v_mov_b32 v12, 1
    v_mov_b32 v192, 163328
    v_and_b32 v8, 31, v1
    s_lshl_b32 s50, s59, 5
    v_add_u32 v8, s50, v8
    v_lshrrev_b32 v9, 5, v1
    v_lshlrev_b32 v9, 3, v9
    v_mul_u32_u24 v185, 112, v8
    v_add_u32 v185, v185, v9
    v_cndmask_b32 v184, 1.0, 0, s[54:55]
    v_mov_b32 v186, s62
    v_lshrrev_b32 v8, 5, v1
    v_lshlrev_b32 v8, 2, v8
    v_bfe_u32 v193, v1, 2, 2
    v_add_u32 v8, v8, v193
    v_mul_u32_u24 v193, 56, v8
    v_bfe_u32 v8, v1, 4, 1
    v_lshl_add_u32 v193, v8, 5, v193
    v_and_b32 v8, 3, v1
    v_lshl_add_u32 v193, v8, 3, v193
    v_add_u32 v193, 159744, v193
    s_lshl_b32 s50, s59, 12
    s_add_u32 s50, s50, 143360
    v_add_u32 v187, s50, v2
    s_waitcnt lgkmcnt(0)
    s_mov_b32 s70, 0
L_lw143:
    ds_read_b128 v[188:191], v192 offset:0
    s_add_u32 s70, s70, 1
    s_cmp_gt_u32 s70, 0x1000000
    s_cbranch_scc1 L_lw144
    s_sleep 1
    s_waitcnt lgkmcnt(0)
    v_min3_u32 v188, v188, v189, v190
    v_min_u32 v188, v188, v191
    s_nop 0
    v_readfirstlane_b32 s58, v188
    s_nop 0
    s_cmp_eq_u32 s58, 0
    s_cbranch_scc1 L_lw143
L_lw144:
    s_waitcnt lgkmcnt(0)
    s_add_u32 s50, s64, s61
    s_add_u32 s50, s50, s45
    s_add_u32 m0, s53, 0
    s_add_u32 s50, s50, s67
    s_add_u32 s64, s64, s65
    s_cmp_eq_u32 s64, s66
    s_cselect_b32 s64, 0, s64
    buffer_load_dwordx4 v3, s[12:15], s50 offen lds
    s_add_u32 m0, s53, 4096
    s_add_u32 s50, s64, s61
    s_add_u32 s50, s50, s45
    buffer_load_dwordx4 v3, s[12:15], s50 offen lds
    s_add_u32 m0, s53, 8192
    s_add_u32 s50, s50, s67
    s_add_u32 s64, s64, s65
    s_cmp_eq_u32 s64, s66
    s_cselect_b32 s64, 0, s64
    buffer_load_dwordx4 v3, s[12:15], s50 offen lds
    s_waitcnt vmcnt(7)
    s_mov_b64 exec, 15
    ds_add_u32 v11, v12 offset:128
    s_mov_b64 exec, -1
    s_add_u32 m0, s53, 28672
    s_add_u32 s50, s64, s61
    s_add_u32 s50, s50, s46
    buffer_load_dwordx4 v3, s[12:15], s50 offen lds
    s_add_u32 m0, s53, 32768
    s_add_u32 s50, s50, s67
    s_add_u32 s64, s64, s65
    s_cmp_eq_u32 s64, s66
    s_cselect_b32 s64, 0, s64
    buffer_load_dwordx4 v3, s[12:15], s50 offen lds
    s_add_u32 m0, s53, 36864
    s_add_u32 s50, s64, s61
    s_add_u32 s50, s50, s46
    buffer_load_dwordx4 v3, s[12:15], s50 offen lds
    s_waitcnt vmcnt(6)
    s_mov_b64 exec, 15
    ds_add_u32 v11, v12 offset:144
    s_mov_b64 exec, -1
    s_add_u32 m0, s53, 40960
    s_add_u32 s50, s50, s67
    s_add_u32 s64, s64, s65
    s_cmp_eq_u32 s64, s66
    s_cselect_b32 s64, 0, s64
    buffer_load_dwordx4 v3, s[12:15], s50 offen lds
    s_add_u32 m0, s53, 45056
    s_add_u32 s50, s64, s61
    s_add_u32 s50, s50, s46
    buffer_load_dwordx4 v3, s[12:15], s50 offen lds
    s_waitcnt vmcnt(5)
    s_mov_b64 exec, 15
    ds_add_u32 v11, v12 offset:352
    s_mov_b64 exec, -1
    s_add_u32 m0, s53, 49152
    s_add_u32 s50, s50, s67
    s_add_u32 s64, s64, s65
    s_cmp_eq_u32 s64, s66
    s_cselect_b32 s64, 0, s64
    buffer_load_dwordx4 v3, s[12:15], s50 offen lds
    s_add_u32 m0, s53, 53248
    s_add_u32 s50, s64, s61
    s_add_u32 s50, s50, s46
    buffer_load_dwordx4 v3, s[12:15], s50 offen lds
    s_add_u32 m0, s53, 57344
    s_add_u32 s50, s64, s61
    s_add_u32 s50, s50, s46
    s_add_u32 s50, s50, s67
    s_add_u32 s64, s64, s65
    s_cmp_eq_u32 s64, s66
    s_cselect_b32 s64, 0, s64
    buffer_load_dwordx4 v3, s[12:15], s50 offen lds
    s_add_u32 m0, s53, 61440
    s_add_u32 s50, s64, s61
    s_add_u32 s50, s50, s46
    buffer_load_dwordx4 v3, s[12:15], s50 offen lds
    s_add_u32 m0, s53, 65536
    s_add_u32 s50, s50, s67
    s_add_u32 s64, s64, s65
    s_cmp_eq_u32 s64, s66
    s_cselect_b32 s64, 0, s64
    buffer_load_dwordx4 v3, s[12:15], s50 offen lds
    s_waitcnt vmcnt(3)
    s_mov_b64 exec, 15
    ds_add_u32 v11, v12 offset:160
    s_mov_b64 exec, -1
    s_add_u32 m0, s53, 69632
    s_add_u32 s50, s64, s61
    s_add_u32 s50, s50, s46
    buffer_load_dwordx4 v3, s[12:15], s50 offen lds
    s_add_u32 m0, s53, 73728
    s_add_u32 s50, s50, s67
    s_add_u32 s64, s64, s65
    s_cmp_eq_u32 s64, s66
    s_cselect_b32 s64, 0, s64
    buffer_load_dwordx4 v3, s[12:15], s50 offen lds
    s_add_u32 m0, s53, 77824
    s_add_u32 s50, s64, s61
    s_add_u32 s50, s50, s46
    buffer_load_dwordx4 v3, s[12:15], s50 offen lds
    s_add_u32 m0, s53, 81920
    s_add_u32 s50, s50, s67
    s_add_u32 s64, s64, s65
    s_cmp_eq_u32 s64, s66
    s_cselect_b32 s64, 0, s64
    buffer_load_dwordx4 v3, s[12:15], s50 offen lds
    v_mov_b32 v197, 0
    buffer_load_dword v198, v197, s[32:35], 0 offen sc1
    s_add_u32 m0, s53, 86016
    s_add_u32 s50, s64, s61
    s_add_u32 s50, s50, s47
    buffer_load_dwordx4 v3, s[12:15], s50 offen lds
    s_add_u32 m0, s53, 90112
    s_add_u32 s50, s50, s67
    s_add_u32 s64, s64, s65
    s_cmp_eq_u32 s64, s66
    s_cselect_b32 s64, 0, s64
    buffer_load_dwordx4 v3, s[12:15], s50 offen lds
    s_add_u32 m0, s53, 94208
    s_add_u32 s50, s64, s61
    s_add_u32 s50, s50, s47
    buffer_load_dwordx4 v3, s[12:15], s50 offen lds
    s_waitcnt vmcnt(4)
    s_mov_b64 exec, 15
    ds_add_u32 v11, v12 offset:176
    s_mov_b64 exec, -1
    s_add_u32 m0, s53, 98304
    s_add_u32 s50, s50, s67
    s_add_u32 s64, s64, s65
    s_cmp_eq_u32 s64, s66
    s_cselect_b32 s64, 0, s64
    buffer_load_dwordx4 v3, s[12:15], s50 offen lds
    s_add_u32 m0, s53, 102400
    s_add_u32 s50, s64, s61
    s_add_u32 s50, s50, s47
    buffer_load_dwordx4 v3, s[12:15], s50 offen lds
    s_add_u32 m0, s53, 106496
    s_add_u32 s50, s50, s67
    s_add_u32 s64, s64, s65
    s_cmp_eq_u32 s64, s66
    s_cselect_b32 s64, 0, s64
    buffer_load_dwordx4 v3, s[12:15], s50 offen lds
    s_add_u32 m0, s53, 110592
    s_add_u32 s50, s64, s61
    s_add_u32 s50, s50, s47
    buffer_load_dwordx4 v3, s[12:15], s50 offen lds
    s_waitcnt lgkmcnt(0)
    s_mov_b32 s70, 0
L_lw145:
    ds_read_b128 v[188:191], v192 offset:16
    s_add_u32 s70, s70, 1
    s_cmp_gt_u32 s70, 0x1000000
    s_cbranch_scc1 L_lw146
    s_sleep 1
    s_waitcnt lgkmcnt(0)
    v_min3_u32 v188, v188, v189, v190
    v_min_u32 v188, v188, v191
    s_nop 0
    v_readfirstlane_b32 s58, v188
    s_nop 0
    s_cmp_eq_u32 s58, 0
    s_cbranch_scc1 L_lw145
L_lw146:
    s_waitcnt lgkmcnt(0)
    s_add_u32 m0, s53, 114688
    s_add_u32 s50, s64, s61
    s_add_u32 s50, s50, s47
    s_add_u32 s50, s50, s67
    s_add_u32 s64, s64, s65
    s_cmp_eq_u32 s64, s66
    s_cselect_b32 s64, 0, s64
    buffer_load_dwordx4 v3, s[12:15], s50 offen lds
    s_add_u32 m0, s53, 118784
    s_add_u32 s50, s64, s61
    s_add_u32 s50, s50, s47
    buffer_load_dwordx4 v3, s[12:15], s50 offen lds
    s_add_u32 m0, s53, 122880
    s_add_u32 s50, s50, s67
    s_add_u32 s64, s64, s65
    s_cmp_eq_u32 s64, s66
    s_cselect_b32 s64, 0, s64
    buffer_load_dwordx4 v3, s[12:15], s50 offen lds
    s_add_u32 m0, s53, 126976
    s_add_u32 s50, s64, s61
    s_add_u32 s50, s50, s47
    buffer_load_dwordx4 v3, s[12:15], s50 offen lds
    s_add_u32 m0, s53, 131072
    s_add_u32 s50, s50, s67
    s_add_u32 s64, s64, s65
    s_cmp_eq_u32 s64, s66
    s_cselect_b32 s64, 0, s64
    buffer_load_dwordx4 v3, s[12:15], s50 offen lds
    s_add_u32 m0, s53, 135168
    s_add_u32 s50, s64, s61
    s_add_u32 s50, s50, s47
    buffer_load_dwordx4 v3, s[12:15], s50 offen lds
    s_add_u32 m0, s53, 139264
    s_add_u32 s50, s50, s67
    s_add_u32 s64, s64, s65
    s_cmp_eq_u32 s64, s66
    s_cselect_b32 s64, 0, s64
    buffer_load_dwordx4 v3, s[12:15], s50 offen lds
    v_lshrrev_b32 v8, 5, v1
    v_lshlrev_b32 v8, 3, v8
    v_bfe_u32 v194, v1, 2, 2
    v_add_u32 v8, v8, v194
    v_mul_u32_u24 v194, 112, v8
    v_bfe_u32 v8, v1, 4, 1
    v_lshl_add_u32 v194, v8, 5, v194
    v_and_b32 v8, 3, v1
    v_lshl_add_u32 v194, v8, 3, v194
    v_lshrrev_b32 v8, 5, v1
    v_lshlrev_b32 v8, 3, v8
    v_bfe_u32 v195, v1, 2, 2
    v_add_u32 v8, v8, v195
    v_mul_u32_u24 v195, 72, v8
    v_bfe_u32 v8, v1, 4, 1
    v_lshl_add_u32 v195, v8, 5, v195
    v_and_b32 v8, 3, v1
    v_lshl_add_u32 v195, v8, 3, v195
    s_lshr_b32 s50, s59, 1
    s_and_b32 s51, s59, 1
    s_mul_i32 s52, s50, 14336
    s_mul_i32 s51, s51, 56
    s_add_u32 s52, s52, s51
    v_add_u32 v194, s52, v194
    s_mul_i32 s52, s50, 9216
    s_add_u32 s52, s52, 28672
    v_add_u32 v195, s52, v195
    s_lshl_b32 s74, s42, 2
    s_add_u32 s74, s74, s59
    s_lshl_b32 s75, s74, 11
    s_lshl_b32 s74, s74, 4
    s_add_u32 s74, s74, s6
    s_lshl_b32 s74, s74, 11
    s_add_u32 s74, s74, 11534336
    s_lshl_b32 s50, s6, 7
    s_add_u32 s75, s75, s50
    s_add_u32 s75, s75, 14745600
    s_waitcnt lgkmcnt(0)
    s_mov_b32 s70, 0
L_lw147:
    ds_read_b128 v[188:191], v192 offset:80
    s_add_u32 s70, s70, 1
    s_cmp_gt_u32 s70, 0x1000000
    s_cbranch_scc1 L_lw148
    s_sleep 1
    s_waitcnt lgkmcnt(0)
    v_min3_u32 v188, v188, v189, v190
    v_min_u32 v188, v188, v191
    s_nop 0
    v_readfirstlane_b32 s58, v188
    s_nop 0
    s_cmp_eq_u32 s58, 0
    s_cbranch_scc1 L_lw147
L_lw148:
    s_waitcnt lgkmcnt(0)
    s_setprio 1
    ds_read_b128 v[160:163], v187
    ds_read_b128 v[164:167], v187 offset:1024
    ds_read_b64_tr_b16 v[168:169], v193 offset:0
    ds_read_b64_tr_b16 v[170:171], v193 offset:448
    ds_read_b64_tr_b16 v[172:173], v193 offset:896
    ds_read_b64_tr_b16 v[174:175], v193 offset:1344
    s_waitcnt lgkmcnt(2)
    v_mfma_f32_32x32x16_bf16 v[144:159], v[168:171], v[160:163], 0
    s_waitcnt lgkmcnt(0)
    v_mfma_f32_32x32x16_bf16 v[144:159], v[172:175], v[164:167], v[144:159]
    s_waitcnt vmcnt(7)
    s_mov_b64 exec, 15
    ds_add_u32 v11, v12 offset:192
    s_mov_b64 exec, -1
    s_nop 7
    v_cndmask_b32 v156, v156, v152, s[54:55]
    v_cndmask_b32 v157, v157, v153, s[54:55]
    v_cndmask_b32 v158, v158, v154, s[54:55]
    v_cndmask_b32 v159, v159, v155, s[54:55]
    v_max3_f32 v176, v144, v145, v146
    v_max3_f32 v176, v176, v147, v148
    v_max3_f32 v176, v176, v149, v150
    v_max3_f32 v176, v176, v151, v152
    v_max3_f32 v176, v176, v153, v154
    v_max3_f32 v176, v176, v155, v156
    v_max3_f32 v176, v176, v157, v158
    v_min3_f32 v178, v144, v145, v146
    v_min3_f32 v178, v178, v147, v148
    v_min3_f32 v178, v178, v149, v150
    v_min3_f32 v178, v178, v151, v152
    v_min3_f32 v178, v178, v153, v154
    v_min3_f32 v178, v178, v155, v156
    v_min3_f32 v178, v178, v157, v158
    v_max_f32 v176, v176, v159
    v_min_f32 v178, v178, v159
    v_mov_b32 v177, v176
    v_mov_b32 v179, v178
    s_nop 0
    v_permlane32_swap_b32 v176, v177
    v_permlane32_swap_b32 v178, v179
    v_max_f32 v176, v176, v177
    v_min_f32 v178, v178, v179
    v_mul_f32 v176, 0xbfb8aa3b, v176
    v_mul_f32 v178, 0x3fb8aa3b, v178
    v_fma_f32 v160, v144, v186, v176
    v_fma_f32 v161, v145, v186, v176
    v_fma_f32 v162, v146, v186, v176
    v_fma_f32 v163, v147, v186, v176
    v_fma_f32 v164, v148, v186, v176
    v_fma_f32 v165, v149, v186, v176
    v_fma_f32 v166, v150, v186, v176
    v_fma_f32 v167, v151, v186, v176
    s_waitcnt vmcnt(0)
    s_mov_b64 exec, 15
    ds_add_u32 v11, v12 offset:208
    s_mov_b64 exec, -1
    v_fma_f32 v168, v152, v186, v176
    v_fma_f32 v169, v153, v186, v176
    v_fma_f32 v170, v154, v186, v176
    v_fma_f32 v171, v155, v186, v176
    v_fma_f32 v172, v156, v186, v176
    v_fma_f32 v173, v157, v186, v176
    v_fma_f32 v174, v158, v186, v176
    v_fma_f32 v175, v159, v186, v176
    v_exp_f32 v160, v160
    v_exp_f32 v161, v161
    v_exp_f32 v162, v162
    v_exp_f32 v163, v163
    v_exp_f32 v164, v164
    v_exp_f32 v165, v165
    v_exp_f32 v166, v166
    v_exp_f32 v167, v167
    v_exp_f32 v168, v168
    v_exp_f32 v169, v169
    v_exp_f32 v170, v170
    v_exp_f32 v171, v171
    v_exp_f32 v172, v172
    v_exp_f32 v173, v173
    v_exp_f32 v174, v174
    v_exp_f32 v175, v175
    v_add_f32 v181, v172, v173
    v_add_f32 v180, v160, v161
    v_add_f32 v181, v181, v174
    v_add_f32 v180, v180, v162
    v_add_f32 v181, v181, v175
    v_add_f32 v180, v180, v163
    v_cndmask_b32 v181, v181, 0, s[54:55]
    v_add_f32 v180, v180, v164
    v_add_f32 v181, v181, v165
    v_add_f32 v180, v180, v166
    v_add_f32 v181, v181, v167
    v_add_f32 v180, v180, v168
    v_add_f32 v181, v181, v169
    v_add_f32 v180, v180, v170
    v_add_f32 v181, v181, v171
    v_add_f32 v180, v180, v181
    v_mov_b32 v181, v180
    s_nop 1
    v_permlane32_swap_b32 v180, v181
    v_add_f32 v180, v180, v181
    v_rcp_f32 v180, v180
    s_nop 0
    v_mul_f32 v160, v160, v180
    v_mul_f32 v161, v161, v180
    v_mul_f32 v162, v162, v180
    v_mul_f32 v163, v163, v180
    v_mul_f32 v164, v164, v180
    v_mul_f32 v165, v165, v180
    v_mul_f32 v166, v166, v180
    v_mul_f32 v167, v167, v180
    v_mul_f32 v168, v168, v180
    v_mul_f32 v169, v169, v180
    v_mul_f32 v170, v170, v180
    v_mul_f32 v171, v171, v180
    v_mul_f32 v172, v172, v180
    v_mul_f32 v173, v173, v180
    v_mul_f32 v174, v174, v180
    v_mul_f32 v175, v175, v180
    v_cvt_pk_bf16_f32 v160, v160, v161
    v_cvt_pk_bf16_f32 v161, v162, v163
    v_cvt_pk_bf16_f32 v162, v164, v165
    v_cvt_pk_bf16_f32 v163, v166, v167
    v_cvt_pk_bf16_f32 v164, v168, v169
    v_cvt_pk_bf16_f32 v165, v170, v171
    v_cvt_pk_bf16_f32 v166, v172, v173
    v_cvt_pk_bf16_f32 v167, v174, v175
    ds_write_b64 v185, v[160:161] offset:0
    ds_write_b64 v185, v[162:163] offset:16
    ds_write_b64 v185, v[164:165] offset:32
    s_mov_b64 exec, 0xffffffff
    ds_write_b64 v185, v[166:167] offset:48
    s_mov_b64 exec, -1
    v_fma_f32 v144, -v144, v186, v178
    v_fma_f32 v145, -v145, v186, v178
    v_fma_f32 v146, -v146, v186, v178
    v_fma_f32 v147, -v147, v186, v178
    v_fma_f32 v148, -v148, v186, v178
    v_fma_f32 v149, -v149, v186, v178
    v_fma_f32 v150, -v150, v186, v178
    v_fma_f32 v151, -v151, v186, v178
    v_fma_f32 v152, -v152, v186, v178
    v_fma_f32 v153, -v153, v186, v178
    v_fma_f32 v154, -v154, v186, v178
    v_fma_f32 v155, -v155, v186, v178
    v_fma_f32 v156, -v156, v186, v178
    v_fma_f32 v157, -v157, v186, v178
    v_fma_f32 v158, -v158, v186, v178
    v_fma_f32 v159, -v159, v186, v178
    v_exp_f32 v144, v144
    v_exp_f32 v145, v145
    v_exp_f32 v146, v146
    v_exp_f32 v147, v147
    v_exp_f32 v148, v148
    v_exp_f32 v149, v149
    v_exp_f32 v150, v150
    v_exp_f32 v151, v151
    v_exp_f32 v152, v152
    v_exp_f32 v153, v153
    v_exp_f32 v154, v154
    v_exp_f32 v155, v155
    v_exp_f32 v156, v156
    v_exp_f32 v157, v157
    v_exp_f32 v158, v158
    v_exp_f32 v159, v159
    v_add_f32 v181, v156, v157
    v_add_f32 v180, v144, v145
    v_add_f32 v181, v181, v158
    v_add_f32 v180, v180, v146
    v_add_f32 v181, v181, v159
    v_add_f32 v180, v180, v147
    v_cndmask_b32 v181, v181, 0, s[54:55]
    v_add_f32 v180, v180, v148
    v_add_f32 v181, v181, v149
    v_add_f32 v180, v180, v150
    v_add_f32 v181, v181, v151
    v_add_f32 v180, v180, v152
    v_add_f32 v181, v181, v153
    v_add_f32 v180, v180, v154
    v_add_f32 v181, v181, v155
    v_add_f32 v180, v180, v181
    v_mov_b32 v181, v180
    s_nop 1
    v_permlane32_swap_b32 v180, v181
    v_add_f32 v180, v180, v181
    v_rcp_f32 v180, v180
    s_nop 0
    v_mul_f32 v144, v144, v180
    v_mul_f32 v145, v145, v180
    v_mul_f32 v146, v146, v180
    v_mul_f32 v147, v147, v180
    v_mul_f32 v148, v148, v180
    v_mul_f32 v149, v149, v180
    v_mul_f32 v150, v150, v180
    v_mul_f32 v151, v151, v180
    v_mul_f32 v152, v152, v180
    v_mul_f32 v153, v153, v180
    v_mul_f32 v154, v154, v180
    v_mul_f32 v155, v155, v180
    v_mul_f32 v156, v156, v180
    v_mul_f32 v157, v157, v180
    v_mul_f32 v158, v158, v180
    v_mul_f32 v159, v159, v180
    v_cvt_pk_bf16_f32 v144, v144, v145
    v_cvt_pk_bf16_f32 v145, v146, v147
    v_cvt_pk_bf16_f32 v146, v148, v149
    v_cvt_pk_bf16_f32 v147, v150, v151
    v_cvt_pk_bf16_f32 v148, v152, v153
    v_cvt_pk_bf16_f32 v149, v154, v155
    v_cvt_pk_bf16_f32 v150, v156, v157
    v_cvt_pk_bf16_f32 v151, v158, v159
    ds_write_b64 v185, v[144:145] offset:56
    ds_write_b64 v185, v[146:147] offset:72
    ds_write_b64 v185, v[148:149] offset:88
    s_mov_b64 exec, 0xffffffff
    ds_write_b64 v185, v[150:151] offset:104
    s_mov_b64 exec, -1
    s_mov_b64 exec, 15
    ds_add_u32 v11, v12 offset:272
    s_mov_b64 exec, -1
    v_readfirstlane_b32 s43, v198
    s_nop 0
    s_cmp_lg_u32 s43, 0
    s_cbranch_scc1 L_tf150
    s_mov_b32 s70, 0
L_tf149:
    buffer_load_dword v198, v197, s[32:35], 0 offen sc1
    s_waitcnt vmcnt(0)
    v_readfirstlane_b32 s43, v198
    s_add_u32 s70, s70, 1
    s_max_u32 s58, s70, 0x400000
    s_sub_u32 s58, s58, 0x400000
    s_or_b32 s43, s43, s58
    s_cmp_eq_u32 s43, 0
    s_cbranch_scc1 L_tf149
L_tf150:
    v_mov_b32 v198, s43
    ds_write_b32 v0, v198 offset:320
    s_setprio 1
    s_waitcnt lgkmcnt(0)
    s_mov_b32 s70, 0
L_lw151:
    ds_read_b128 v[188:191], v192 offset:112
    s_add_u32 s70, s70, 1
    s_cmp_gt_u32 s70, 0x1000000
    s_cbranch_scc1 L_lw152
    s_sleep 1
    s_waitcnt lgkmcnt(0)
    v_min3_u32 v188, v188, v189, v190
    v_min_u32 v188, v188, v191
    s_nop 0
    v_readfirstlane_b32 s58, v188
    s_nop 0
    s_cmp_eq_u32 s58, 0
    s_cbranch_scc1 L_lw151
L_lw152:
    s_waitcnt lgkmcnt(0)
    ds_read_b32 v188, v0 offset:272
    s_waitcnt lgkmcnt(0)
    v_readfirstlane_b32 s58, v188
    s_nop 0
    s_cmp_ge_u32 s58, 4
    s_cbranch_scc0 L_ck155
L_ck154:
    ds_read_b64_tr_b16 v[208:209], v194 offset:0
    ds_read_b64_tr_b16 v[210:211], v194 offset:448
    ds_read_b64_tr_b16 v[212:213], v195 offset:0
    ds_read_b64_tr_b16 v[214:215], v195 offset:288
    ds_read_b64_tr_b16 v[216:217], v194 offset:1792
    ds_read_b64_tr_b16 v[218:219], v194 offset:2240
    ds_read_b64_tr_b16 v[220:221], v195 offset:1152
    ds_read_b64_tr_b16 v[222:223], v195 offset:1440
    ds_read_b64_tr_b16 v[224:225], v194 offset:3584
    ds_read_b64_tr_b16 v[226:227], v194 offset:4032
    ds_read_b64_tr_b16 v[228:229], v195 offset:2304
    ds_read_b64_tr_b16 v[230:231], v195 offset:2592
    ds_read_b64_tr_b16 v[232:233], v194 offset:5376
    ds_read_b64_tr_b16 v[234:235], v194 offset:5824
    ds_read_b64_tr_b16 v[236:237], v195 offset:3456
    ds_read_b64_tr_b16 v[238:239], v195 offset:3744
    ds_read_b64_tr_b16 v[240:241], v194 offset:7168
    ds_read_b64_tr_b16 v[242:243], v194 offset:7616
    ds_read_b64_tr_b16 v[244:245], v195 offset:4608
    ds_read_b64_tr_b16 v[246:247], v195 offset:4896
    ds_read_b64_tr_b16 v[248:249], v194 offset:8960
    ds_read_b64_tr_b16 v[250:251], v194 offset:9408
    ds_read_b64_tr_b16 v[252:253], v195 offset:5760
    ds_read_b64_tr_b16 v[254:255], v195 offset:6048
    s_waitcnt lgkmcnt(15)
    v_mfma_f32_32x32x16_bf16 v[144:159], v[208:211], v[212:215], 0
    ds_read_b64_tr_b16 v[208:209], v194 offset:10752
    ds_read_b64_tr_b16 v[210:211], v194 offset:11200
    ds_read_b64_tr_b16 v[212:213], v195 offset:6912
    ds_read_b64_tr_b16 v[214:215], v195 offset:7200
    v_mfma_f32_32x32x16_bf16 v[144:159], v[216:219], v[220:223], v[144:159]
    ds_read_b64_tr_b16 v[216:217], v194 offset:12544
    ds_read_b64_tr_b16 v[218:219], v194 offset:12992
    ds_read_b64_tr_b16 v[220:221], v195 offset:8064
    ds_read_b64_tr_b16 v[222:223], v195 offset:8352
    s_waitcnt lgkmcnt(15)
    v_mfma_f32_32x32x16_bf16 v[144:159], v[224:227], v[228:231], v[144:159]
    v_mfma_f32_32x32x16_bf16 v[144:159], v[232:235], v[236:239], v[144:159]
    s_waitcnt lgkmcnt(12)
    v_mfma_f32_32x32x16_bf16 v[144:159], v[240:243], v[244:247], v[144:159]
    s_waitcnt lgkmcnt(8)
    v_mfma_f32_32x32x16_bf16 v[144:159], v[248:251], v[252:255], v[144:159]
    s_waitcnt lgkmcnt(4)
    v_mfma_f32_32x32x16_bf16 v[144:159], v[208:211], v[212:215], v[144:159]
    s_waitcnt lgkmcnt(0)
    v_mfma_f32_32x32x16_bf16 v[144:159], v[216:219], v[220:223], v[144:159]
    s_nop 11
    v_cvt_pk_bf16_f32 v208, v144, v145
    v_cvt_pk_bf16_f32 v209, v146, v147
    v_cvt_pk_bf16_f32 v210, v148, v149
    v_cvt_pk_bf16_f32 v211, v150, v151
    v_cvt_pk_bf16_f32 v212, v152, v153
    v_cvt_pk_bf16_f32 v213, v154, v155
    v_cvt_pk_bf16_f32 v214, v156, v157
    v_cvt_pk_bf16_f32 v215, v158, v159
    buffer_store_dwordx4 v[208:211], v2, s[16:19], s74 offen offset:0 sc1
    buffer_store_dwordx4 v[212:215], v2, s[16:19], s74 offen offset:1024 sc1
    s_waitcnt vmcnt(0)
    v_mov_b32 v160, s43
    v_mov_b32 v161, s43
    v_mov_b32 v162, s43
    v_mov_b32 v163, s43
    v_lshrrev_b32 v164, 3, v1
    v_lshlrev_b32 v164, 8, v164
    v_and_or_b32 v164, v2, s56, v164
    s_mov_b32 exec_lo, 0xff
    s_mov_b32 exec_hi, 0x0
    buffer_store_dwordx4 v[160:163], v164, s[16:19], s75 offen sc1
    s_mov_b64 exec, -1
    s_setprio 0
    v_lshlrev_b32 v14, 7, v1
    s_lshl_b32 s50, s5, 2
    s_add_u32 s50, s50, s59
    s_mul_i32 s51, s50, 3200
    s_mov_b64 exec, 0x1ffffff
    buffer_load_dword v200, v14, s[24:27], s51 offen
    s_mov_b64 exec, -1
    s_cmp_ge_u32 s59, 2
    s_cbranch_scc1 L_fin
    v_lshlrev_b32 v8, 7, v1
    s_lshl_b32 s50, s40, 11
    s_add_u32 s50, s50, 14745600
    s_lshl_b32 s66, s40, 15
    s_lshl_b32 s52, s59, 10
    s_add_u32 s66, s66, s52
    s_add_u32 s66, s66, 11534336
    s_lshl_b32 s65, s40, 1
    s_add_u32 s65, s65, s59
    s_lshl_b32 s64, s65, 7
    s_add_u32 s64, s64, 14811136
    s_lshl_b32 s65, s65, 10
    s_add_u32 s65, s65, 13631488
    s_mov_b32 s49, 0x00003f80
    s_mov_b32 s63, 0x3f800000
    v_mov_b32 v16, 0
    v_mov_b32 v17, 0
    v_mov_b32 v18, 0
    v_mov_b32 v19, 0
    v_mov_b32 v20, 0
    v_mov_b32 v21, 0
    v_mov_b32 v22, 0
    v_mov_b32 v23, 0
    s_cmp_eq_u32 s59, 1
    s_cselect_b32 s53, -1, 0
    s_mov_b32 s52, 0
    s_mov_b64 exec, 0xffff
    s_mov_b32 s58, 0
L_pl156:
    buffer_load_dword v9, v8, s[16:19], s50 offen sc1
    s_waitcnt vmcnt(0)
    v_cmp_ne_u32 vcc, s43, v9
    s_add_u32 s58, s58, 1
    s_cbranch_vccz L_pl157
    s_cmp_gt_u32 s58, 0x400000
    s_cbranch_scc1 L_pl157
    s_sleep 3
    s_branch L_pl156
L_pl157:
    s_mov_b64 exec, -1
    s_add_u32 s50, s66, 0
    buffer_load_dwordx4 v[32:35], v2, s[16:19], s50 offen offset:0 sc1
    buffer_load_dwordx4 v[36:39], v2, s[16:19], s50 offen offset:2048 sc1
    s_add_u32 s50, s66, 4096
    buffer_load_dwordx4 v[40:43], v2, s[16:19], s50 offen offset:0 sc1
    buffer_load_dwordx4 v[44:47], v2, s[16:19], s50 offen offset:2048 sc1
    s_add_u32 s50, s66, 8192
    buffer_load_dwordx4 v[48:51], v2, s[16:19], s50 offen offset:0 sc1
    buffer_load_dwordx4 v[52:55], v2, s[16:19], s50 offen offset:2048 sc1
    s_add_u32 s50, s66, 12288
    buffer_load_dwordx4 v[56:59], v2, s[16:19], s50 offen offset:0 sc1
    buffer_load_dwordx4 v[60:63], v2, s[16:19], s50 offen offset:2048 sc1
    s_add_u32 s50, s66, 16384
    buffer_load_dwordx4 v[64:67], v2, s[16:19], s50 offen offset:0 sc1
    buffer_load_dwordx4 v[68:71], v2, s[16:19], s50 offen offset:2048 sc1
    s_add_u32 s50, s66, 20480
    buffer_load_dwordx4 v[72:75], v2, s[16:19], s50 offen offset:0 sc1
    buffer_load_dwordx4 v[76:79], v2, s[16:19], s50 offen offset:2048 sc1
    s_add_u32 s50, s66, 24576
    buffer_load_dwordx4 v[80:83], v2, s[16:19], s50 offen offset:0 sc1
    buffer_load_dwordx4 v[84:87], v2, s[16:19], s50 offen offset:2048 sc1
    s_add_u32 s50, s66, 28672
    buffer_load_dwordx4 v[88:91], v2, s[16:19], s50 offen offset:0 sc1
    buffer_load_dwordx4 v[92:95], v2, s[16:19], s50 offen offset:2048 sc1
    v_and_b32 v8, 31, v1
    v_cmp_eq_u32 vcc, 29, v8
    s_waitcnt vmcnt(15)
    v_dot2c_f32_bf16 v16, s49, v32
    v_dot2c_f32_bf16 v17, s63, v32
    v_dot2c_f32_bf16 v18, s49, v33
    v_dot2c_f32_bf16 v19, s63, v33
    v_dot2c_f32_bf16 v20, s49, v34
    v_dot2c_f32_bf16 v21, s63, v34
    v_dot2c_f32_bf16 v22, s49, v35
    v_dot2c_f32_bf16 v23, s63, v35
    s_waitcnt vmcnt(14)
    v_dot2c_f32_bf16 v16, s49, v36
    v_dot2c_f32_bf16 v17, s63, v36
    v_dot2c_f32_bf16 v18, s49, v37
    v_dot2c_f32_bf16 v19, s63, v37
    v_dot2c_f32_bf16 v20, s49, v38
    v_dot2c_f32_bf16 v21, s63, v38
    v_dot2c_f32_bf16 v22, s49, v39
    v_dot2c_f32_bf16 v23, s63, v39
    s_waitcnt vmcnt(13)
    v_dot2c_f32_bf16 v16, s49, v40
    v_dot2c_f32_bf16 v17, s63, v40
    v_dot2c_f32_bf16 v18, s49, v41
    v_dot2c_f32_bf16 v19, s63, v41
    v_dot2c_f32_bf16 v20, s49, v42
    v_dot2c_f32_bf16 v21, s63, v42
    v_dot2c_f32_bf16 v22, s49, v43
    v_dot2c_f32_bf16 v23, s63, v43
    s_waitcnt vmcnt(12)
    v_dot2c_f32_bf16 v16, s49, v44
    v_dot2c_f32_bf16 v17, s63, v44
    v_dot2c_f32_bf16 v18, s49, v45
    v_dot2c_f32_bf16 v19, s63, v45
    v_dot2c_f32_bf16 v20, s49, v46
    v_dot2c_f32_bf16 v21, s63, v46
    v_dot2c_f32_bf16 v22, s49, v47
    v_dot2c_f32_bf16 v23, s63, v47
    s_waitcnt vmcnt(11)
    v_dot2c_f32_bf16 v16, s49, v48
    v_dot2c_f32_bf16 v17, s63, v48
    v_dot2c_f32_bf16 v18, s49, v49
    v_dot2c_f32_bf16 v19, s63, v49
    v_dot2c_f32_bf16 v20, s49, v50
    v_dot2c_f32_bf16 v21, s63, v50
    v_dot2c_f32_bf16 v22, s49, v51
    v_dot2c_f32_bf16 v23, s63, v51
    s_waitcnt vmcnt(10)
    v_dot2c_f32_bf16 v16, s49, v52
    v_dot2c_f32_bf16 v17, s63, v52
    v_dot2c_f32_bf16 v18, s49, v53
    v_dot2c_f32_bf16 v19, s63, v53
    v_dot2c_f32_bf16 v20, s49, v54
    v_dot2c_f32_bf16 v21, s63, v54
    v_dot2c_f32_bf16 v22, s49, v55
    v_dot2c_f32_bf16 v23, s63, v55
    s_waitcnt vmcnt(9)
    v_dot2c_f32_bf16 v16, s49, v56
    v_dot2c_f32_bf16 v17, s63, v56
    v_dot2c_f32_bf16 v18, s49, v57
    v_dot2c_f32_bf16 v19, s63, v57
    v_dot2c_f32_bf16 v20, s49, v58
    v_dot2c_f32_bf16 v21, s63, v58
    v_dot2c_f32_bf16 v22, s49, v59
    v_dot2c_f32_bf16 v23, s63, v59
    s_waitcnt vmcnt(8)
    v_dot2c_f32_bf16 v16, s49, v60
    v_dot2c_f32_bf16 v17, s63, v60
    v_dot2c_f32_bf16 v18, s49, v61
    v_dot2c_f32_bf16 v19, s63, v61
    v_dot2c_f32_bf16 v20, s49, v62
    v_dot2c_f32_bf16 v21, s63, v62
    v_dot2c_f32_bf16 v22, s49, v63
    v_dot2c_f32_bf16 v23, s63, v63
    s_waitcnt vmcnt(7)
    v_dot2c_f32_bf16 v16, s49, v64
    v_dot2c_f32_bf16 v17, s63, v64
    v_dot2c_f32_bf16 v18, s49, v65
    v_dot2c_f32_bf16 v19, s63, v65
    v_dot2c_f32_bf16 v20, s49, v66
    v_dot2c_f32_bf16 v21, s63, v66
    v_dot2c_f32_bf16 v22, s49, v67
    v_dot2c_f32_bf16 v23, s63, v67
    s_waitcnt vmcnt(6)
    v_dot2c_f32_bf16 v16, s49, v68
    v_dot2c_f32_bf16 v17, s63, v68
    v_dot2c_f32_bf16 v18, s49, v69
    v_dot2c_f32_bf16 v19, s63, v69
    v_dot2c_f32_bf16 v20, s49, v70
    v_dot2c_f32_bf16 v21, s63, v70
    v_dot2c_f32_bf16 v22, s49, v71
    v_dot2c_f32_bf16 v23, s63, v71
    s_waitcnt vmcnt(5)
    v_dot2c_f32_bf16 v16, s49, v72
    v_dot2c_f32_bf16 v17, s63, v72
    v_dot2c_f32_bf16 v18, s49, v73
    v_dot2c_f32_bf16 v19, s63, v73
    v_dot2c_f32_bf16 v20, s49, v74
    v_dot2c_f32_bf16 v21, s63, v74
    v_dot2c_f32_bf16 v22, s49, v75
    v_dot2c_f32_bf16 v23, s63, v75
    s_waitcnt vmcnt(4)
    v_dot2c_f32_bf16 v16, s49, v76
    v_dot2c_f32_bf16 v17, s63, v76
    v_dot2c_f32_bf16 v18, s49, v77
    v_dot2c_f32_bf16 v19, s63, v77
    v_dot2c_f32_bf16 v20, s49, v78
    v_dot2c_f32_bf16 v21, s63, v78
    v_dot2c_f32_bf16 v22, s49, v79
    v_dot2c_f32_bf16 v23, s63, v79
    s_waitcnt vmcnt(3)
    v_dot2c_f32_bf16 v16, s49, v80
    v_dot2c_f32_bf16 v17, s63, v80
    v_dot2c_f32_bf16 v18, s49, v81
    v_dot2c_f32_bf16 v19, s63, v81
    v_dot2c_f32_bf16 v20, s49, v82
    v_dot2c_f32_bf16 v21, s63, v82
    v_dot2c_f32_bf16 v22, s49, v83
    v_dot2c_f32_bf16 v23, s63, v83
    s_waitcnt vmcnt(2)
    v_dot2c_f32_bf16 v16, s49, v84
    v_dot2c_f32_bf16 v17, s63, v84
    v_dot2c_f32_bf16 v18, s49, v85
    v_dot2c_f32_bf16 v19, s63, v85
    v_dot2c_f32_bf16 v20, s49, v86
    v_dot2c_f32_bf16 v21, s63, v86
    v_dot2c_f32_bf16 v22, s49, v87
    v_dot2c_f32_bf16 v23, s63, v87
    s_waitcnt vmcnt(1)
    v_dot2c_f32_bf16 v16, s49, v88
    v_dot2c_f32_bf16 v17, s63, v88
    v_dot2c_f32_bf16 v18, s49, v89
    v_dot2c_f32_bf16 v19, s63, v89
    v_dot2c_f32_bf16 v20, s49, v90
    v_dot2c_f32_bf16 v21, s63, v90
    v_dot2c_f32_bf16 v22, s49, v91
    v_dot2c_f32_bf16 v23, s63, v91
    s_waitcnt vmcnt(0)
    v_dot2c_f32_bf16 v16, s49, v92
    v_dot2c_f32_bf16 v17, s63, v92
    v_dot2c_f32_bf16 v18, s49, v93
    v_dot2c_f32_bf16 v19, s63, v93
    v_dot2c_f32_bf16 v20, s49, v94
    v_dot2c_f32_bf16 v21, s63, v94
    v_dot2c_f32_bf16 v22, s49, v95
    v_dot2c_f32_bf16 v23, s63, v95
    v_cndmask_b32 v16, v16, 1.0, vcc
    v_cndmask_b32 v17, v17, 1.0, vcc
    v_cndmask_b32 v18, v18, 1.0, vcc
    v_cndmask_b32 v19, v19, 1.0, vcc
    v_cndmask_b32 v20, v20, 1.0, vcc
    v_cndmask_b32 v21, v21, 1.0, vcc
    v_cndmask_b32 v22, v22, 1.0, vcc
    v_cndmask_b32 v23, v23, 1.0, vcc
    v_cvt_pk_bf16_f32 v24, v16, v17
    v_cvt_pk_bf16_f32 v25, v18, v19
    v_cvt_pk_bf16_f32 v26, v20, v21
    v_cvt_pk_bf16_f32 v27, v22, v23
    v_cndmask_b32 v26, v26, 0, s[52:53]
    v_cndmask_b32 v27, v27, 0, s[52:53]
    buffer_store_dwordx4 v[24:27], v2, s[16:19], s65 offen sc1
    s_waitcnt vmcnt(0)
    v_mov_b32 v28, s43
    v_mov_b32 v29, s43
    v_mov_b32 v30, s43
    v_mov_b32 v31, s43
    v_lshrrev_b32 v32, 3, v1
    v_lshlrev_b32 v32, 8, v32
    v_and_or_b32 v32, v2, s56, v32
    s_mov_b32 exec_lo, 0xff
    s_mov_b32 exec_hi, 0x0
    buffer_store_dwordx4 v[28:31], v32, s[16:19], s64 offen sc1
    s_mov_b64 exec, -1
    s_mov_b64 exec, 15
    ds_add_u32 v11, v12 offset:384
    s_mov_b64 exec, -1
    s_mov_b64 exec, 15
    ds_add_u32 v11, v12 offset:384
    s_mov_b64 exec, -1
L_fin:
L_end:
    s_endpgm
L_ck3:
    s_mov_b32 s70, 0
L_ck1:
    ds_read_b32 v12, v0 offset:128
    s_add_u32 s70, s70, 1
    s_cmp_gt_u32 s70, 0x1000000
    s_cbranch_scc1 L_ck2
    s_sleep 0
    s_waitcnt lgkmcnt(0)
    v_readfirstlane_b32 s58, v12
    s_nop 0
    s_cmp_lt_u32 s58, 4
    s_cbranch_scc1 L_ck1
    s_branch L_ck2
L_ck6:
    s_mov_b32 s70, 0
L_ck4:
    ds_read_b32 v12, v0 offset:144
    s_add_u32 s70, s70, 1
    s_cmp_gt_u32 s70, 0x1000000
    s_cbranch_scc1 L_ck5
    s_sleep 0
    s_waitcnt lgkmcnt(0)
    v_readfirstlane_b32 s58, v12
    s_nop 0
    s_cmp_lt_u32 s58, 4
    s_cbranch_scc1 L_ck4
    s_branch L_ck5
L_ck12:
    s_mov_b32 s70, 0
L_ck10:
    ds_read_b32 v12, v0 offset:352
    s_add_u32 s70, s70, 1
    s_cmp_gt_u32 s70, 0x1000000
    s_cbranch_scc1 L_ck11
    s_sleep 0
    s_waitcnt lgkmcnt(0)
    v_readfirstlane_b32 s58, v12
    s_nop 0
    s_cmp_lt_u32 s58, 4
    s_cbranch_scc1 L_ck10
    s_branch L_ck11
L_ck18:
    s_mov_b32 s70, 0
L_ck16:
    ds_read_b32 v12, v0 offset:160
    s_add_u32 s70, s70, 1
    s_cmp_gt_u32 s70, 0x1000000
    s_cbranch_scc1 L_ck17
    s_sleep 0
    s_waitcnt lgkmcnt(0)
    v_readfirstlane_b32 s58, v12
    s_nop 0
    s_cmp_lt_u32 s58, 4
    s_cbranch_scc1 L_ck16
    s_branch L_ck17
L_ck24:
    s_mov_b32 s70, 0
L_ck22:
    ds_read_b32 v12, v0 offset:176
    s_add_u32 s70, s70, 1
    s_cmp_gt_u32 s70, 0x1000000
    s_cbranch_scc1 L_ck23
    s_sleep 0
    s_waitcnt lgkmcnt(0)
    v_readfirstlane_b32 s58, v12
    s_nop 0
    s_cmp_lt_u32 s58, 4
    s_cbranch_scc1 L_ck22
    s_branch L_ck23
L_ck30:
    s_mov_b32 s70, 0
L_ck28:
    ds_read_b32 v12, v0 offset:192
    s_add_u32 s70, s70, 1
    s_cmp_gt_u32 s70, 0x1000000
    s_cbranch_scc1 L_ck29
    s_sleep 0
    s_waitcnt lgkmcnt(0)
    v_readfirstlane_b32 s58, v12
    s_nop 0
    s_cmp_lt_u32 s58, 4
    s_cbranch_scc1 L_ck28
    s_branch L_ck29
L_ck36:
    s_mov_b32 s70, 0
L_ck34:
    ds_read_b32 v12, v0 offset:208
    s_add_u32 s70, s70, 1
    s_cmp_gt_u32 s70, 0x1000000
    s_cbranch_scc1 L_ck35
    s_sleep 0
    s_waitcnt lgkmcnt(0)
    v_readfirstlane_b32 s58, v12
    s_nop 0
    s_cmp_lt_u32 s58, 4
    s_cbranch_scc1 L_ck34
    s_branch L_ck35
L_ck42:
    s_mov_b32 s70, 0
L_ck40:
    ds_read_b32 v12, v0 offset:224
    s_add_u32 s70, s70, 1
    s_cmp_gt_u32 s70, 0x1000000
    s_cbranch_scc1 L_ck41
    s_sleep 0
    s_waitcnt lgkmcnt(0)
    v_readfirstlane_b32 s58, v12
    s_nop 0
    s_cmp_lt_u32 s58, 4
    s_cbranch_scc1 L_ck40
    s_branch L_ck41
L_cf50:
    s_mov_b32 s70, 0
L_cf48:
    ds_read_b128 v[240:243], v244 offset:48
    s_add_u32 s70, s70, 1
    s_cmp_gt_u32 s70, 0x1000000
    s_cbranch_scc1 L_cf49
    s_waitcnt lgkmcnt(0)
    v_min3_u32 v240, v240, v241, v242
    v_min_u32 v240, v240, v243
    s_nop 0
    v_readfirstlane_b32 s58, v240
    s_nop 0
    s_cmp_eq_u32 s58, 0
    s_cbranch_scc1 L_cf48
    s_branch L_cf49
L_cf53:
    s_mov_b32 s70, 0
L_cf51:
    ds_read_b128 v[248:251], v252 offset:32
    s_add_u32 s70, s70, 1
    s_cmp_gt_u32 s70, 0x1000000
    s_cbranch_scc1 L_cf52
    s_waitcnt lgkmcnt(0)
    v_min3_u32 v248, v248, v249, v250
    v_min_u32 v248, v248, v251
    s_nop 0
    v_readfirstlane_b32 s58, v248
    s_nop 0
    s_cmp_eq_u32 s58, 0
    s_cbranch_scc1 L_cf51
    s_branch L_cf52
L_ck56:
    s_mov_b32 s70, 0
L_ck54:
    ds_read_b32 v12, v0 offset:176
    s_add_u32 s70, s70, 1
    s_cmp_gt_u32 s70, 0x1000000
    s_cbranch_scc1 L_ck55
    s_sleep 0
    s_waitcnt lgkmcnt(0)
    v_readfirstlane_b32 s58, v12
    s_nop 0
    s_cmp_lt_u32 s58, 4
    s_cbranch_scc1 L_ck54
    s_branch L_ck55
L_ck62:
    s_mov_b32 s70, 0
L_ck60:
    ds_read_b32 v12, v0 offset:192
    s_add_u32 s70, s70, 1
    s_cmp_gt_u32 s70, 0x1000000
    s_cbranch_scc1 L_ck61
    s_sleep 0
    s_waitcnt lgkmcnt(0)
    v_readfirstlane_b32 s58, v12
    s_nop 0
    s_cmp_lt_u32 s58, 4
    s_cbranch_scc1 L_ck60
    s_branch L_ck61
L_ck68:
    s_mov_b32 s70, 0
L_ck66:
    ds_read_b32 v12, v0 offset:208
    s_add_u32 s70, s70, 1
    s_cmp_gt_u32 s70, 0x1000000
    s_cbranch_scc1 L_ck67
    s_sleep 0
    s_waitcnt lgkmcnt(0)
    v_readfirstlane_b32 s58, v12
    s_nop 0
    s_cmp_lt_u32 s58, 4
    s_cbranch_scc1 L_ck66
    s_branch L_ck67
L_ck76:
    s_mov_b32 s70, 0
L_ck74:
    ds_read_b32 v12, v0 offset:384
    s_add_u32 s70, s70, 1
    s_cmp_gt_u32 s70, 0x1000000
    s_cbranch_scc1 L_ck75
    s_sleep 1
    s_waitcnt lgkmcnt(0)
    v_readfirstlane_b32 s58, v12
    s_nop 0
    s_cmp_lt_u32 s58, 4
    s_cbranch_scc1 L_ck74
    s_branch L_ck75
L_ck82:
    s_mov_b32 s70, 0
L_ck80:
    ds_read_b32 v12, v0 offset:288
    s_add_u32 s70, s70, 1
    s_cmp_gt_u32 s70, 0x1000000
    s_cbranch_scc1 L_ck81
    s_sleep 0
    s_waitcnt lgkmcnt(0)
    v_readfirstlane_b32 s58, v12
    s_nop 0
    s_cmp_lt_u32 s58, 4
    s_cbranch_scc1 L_ck80
    s_branch L_ck81
L_ck85:
    s_mov_b32 s70, 0
L_ck83:
    ds_read_b32 v12, v0 offset:368
    s_add_u32 s70, s70, 1
    s_cmp_gt_u32 s70, 0x1000000
    s_cbranch_scc1 L_ck84
    s_sleep 1
    s_waitcnt lgkmcnt(0)
    v_readfirstlane_b32 s58, v12
    s_nop 0
    s_cmp_lt_u32 s58, 4
    s_cbranch_scc1 L_ck83
    s_branch L_ck84
L_ck90:
    s_mov_b32 s70, 0
L_ck88:
    ds_read_b32 v12, v0 offset:240
    s_add_u32 s70, s70, 1
    s_cmp_gt_u32 s70, 0x1000000
    s_cbranch_scc1 L_ck89
    s_sleep 1
    s_waitcnt lgkmcnt(0)
    v_readfirstlane_b32 s58, v12
    s_nop 0
    s_cmp_lt_u32 s58, 4
    s_cbranch_scc1 L_ck88
    s_branch L_ck89
L_ck93:
    s_mov_b32 s70, 0
L_ck91:
    ds_read_b32 v12, v0 offset:400
    s_add_u32 s70, s70, 1
    s_cmp_gt_u32 s70, 0x1000000
    s_cbranch_scc1 L_ck92
    s_sleep 1
    s_waitcnt lgkmcnt(0)
    v_readfirstlane_b32 s58, v12
    s_nop 0
    s_cmp_lt_u32 s58, 4
    s_cbranch_scc1 L_ck91
    s_branch L_ck92
L_ck110:
    s_mov_b32 s70, 0
L_ck108:
    ds_read_b32 v188, v0 offset:256
    s_add_u32 s70, s70, 1
    s_cmp_gt_u32 s70, 0x1000000
    s_cbranch_scc1 L_ck109
    s_sleep 0
    s_waitcnt lgkmcnt(0)
    v_readfirstlane_b32 s58, v188
    s_nop 0
    s_cmp_lt_u32 s58, 4
    s_cbranch_scc1 L_ck108
    s_branch L_ck109
L_ck115:
    s_mov_b32 s70, 0
L_ck113:
    ds_read_b32 v26, v0 offset:400
    s_add_u32 s70, s70, 1
    s_cmp_gt_u32 s70, 0x1000000
    s_cbranch_scc1 L_ck114
    s_sleep 0
    s_waitcnt lgkmcnt(0)
    v_readfirstlane_b32 s58, v26
    s_nop 0
    s_cmp_lt_u32 s58, 4
    s_cbranch_scc1 L_ck113
    s_branch L_ck114
L_ck130:
    s_mov_b32 s70, 0
L_ck128:
    ds_read_b32 v188, v0 offset:272
    s_add_u32 s70, s70, 1
    s_cmp_gt_u32 s70, 0x1000000
    s_cbranch_scc1 L_ck129
    s_sleep 0
    s_waitcnt lgkmcnt(0)
    v_readfirstlane_b32 s58, v188
    s_nop 0
    s_cmp_lt_u32 s58, 4
    s_cbranch_scc1 L_ck128
    s_branch L_ck129
L_ck135:
    s_mov_b32 s70, 0
L_ck133:
    ds_read_b32 v188, v0 offset:256
    s_add_u32 s70, s70, 1
    s_cmp_gt_u32 s70, 0x1000000
    s_cbranch_scc1 L_ck134
    s_sleep 0
    s_waitcnt lgkmcnt(0)
    v_readfirstlane_b32 s58, v188
    s_nop 0
    s_cmp_lt_u32 s58, 4
    s_cbranch_scc1 L_ck133
    s_branch L_ck134
L_ck140:
    s_mov_b32 s70, 0
L_ck138:
    ds_read_b32 v26, v0 offset:400
    s_add_u32 s70, s70, 1
    s_cmp_gt_u32 s70, 0x1000000
    s_cbranch_scc1 L_ck139
    s_sleep 0
    s_waitcnt lgkmcnt(0)
    v_readfirstlane_b32 s58, v26
    s_nop 0
    s_cmp_lt_u32 s58, 4
    s_cbranch_scc1 L_ck138
    s_branch L_ck139
L_ck155:
    s_mov_b32 s70, 0
L_ck153:
    ds_read_b32 v188, v0 offset:272
    s_add_u32 s70, s70, 1
    s_cmp_gt_u32 s70, 0x1000000
    s_cbranch_scc1 L_ck154
    s_sleep 0
    s_waitcnt lgkmcnt(0)
    v_readfirstlane_b32 s58, v188
    s_nop 0
    s_cmp_lt_u32 s58, 4
    s_cbranch_scc1 L_ck153
    s_branch L_ck154
.section .rodata,"a"
.p2align 6
.amdhsa_kernel recurrent_scan__linear_kernel_hedgehog__dense_activation_silu__prompt_kernel
  .amdhsa_next_free_vgpr 256
  .amdhsa_next_free_sgpr 102
  .amdhsa_accum_offset 256
  .amdhsa_group_segment_fixed_size 0
  .amdhsa_kernarg_size 80
  .amdhsa_user_sgpr_count 2
  .amdhsa_user_sgpr_kernarg_segment_ptr 1
  .amdhsa_system_sgpr_workgroup_id_x 1
.end_amdhsa_kernel
```
